```python
import torch

def _softmax(x, axis=-1):
    return torch.softmax(x, dim=axis)
def _gelu(x):
    return torch.nn.functional.gelu(x, approximate="tanh")
def _silu(x):
    return torch.nn.functional.silu(x)
def _sigmoid(x):
    return torch.sigmoid(x)
def _layernorm(x, axis=-1, eps=1e-5):
    m = x.mean(dim=axis, keepdim=True)
    v = x.var(dim=axis, keepdim=True, unbiased=False)
    return (x - m) / torch.sqrt(v + eps)
def _scatter_add(tgt, idx, src, axis=0):
    return tgt.clone().index_add_(axis, idx, src)
def _segment_sum(src, seg, n):
    out = torch.zeros((n,) + src.shape[1:], dtype=src.dtype)
    return out.index_add_(0, seg, src)
def _pad(x, pw):
    flat = tuple(v for pair in reversed(pw) for v in pair)
    return torch.nn.functional.pad(x, flat)

kernel_name = 'parallel_sum__compressed_kv_cla__geglu_ffn__prompt'

def setup_inputs():

    _w = (lambda a: (lambda t: t.to(torch.bfloat16) if t.is_floating_point() else t)(torch.as_tensor(a)))
    def _A_setup():
        B, H, Sq, Sk, D, M = 1, 32, 2048, 2048, 128, 640
        Dc = 4 * D
        return {
            "x": _w((lambda *s: torch.randn(*s, dtype=torch.bfloat16) * 0.05)(B, Sq, M)),
            "c_kv": _w((lambda *s: torch.randn(*s, dtype=torch.bfloat16) * 1.6)(B, Sk, Dc)),
            "w_q": _w((lambda *s: torch.randn(*s, dtype=torch.bfloat16) * 0.8)(M, H, D) * (M ** -0.5)),
            "w_uk": _w((lambda *s: torch.randn(*s, dtype=torch.bfloat16) * 0.8)(Dc, H, D) * (Dc ** -0.5)),
            "w_uv": _w((lambda *s: torch.randn(*s, dtype=torch.bfloat16) * 1.6)(Dc, H, D) * (Dc ** -0.5)),
            "w_o": _w((lambda *s: torch.randn(*s, dtype=torch.bfloat16) * 1.6)(H, D, M) * ((H * D) ** -0.5)),
        }
    _A_in = _A_setup()

    def _B_setup():
        B, S, D, F = 1, 2048, 640, 1728
        return {
            "x": _w((lambda *s: torch.randn(*s, dtype=torch.bfloat16) * 0.05)(B, S, D)),
            "w_gate": _w((lambda *s: torch.randn(*s, dtype=torch.bfloat16) * 0.05)(D, F)),
            "w_up": _w((lambda *s: torch.randn(*s, dtype=torch.bfloat16) * 0.05)(D, F)),
            "w_down": _w((lambda *s: torch.randn(*s, dtype=torch.bfloat16) * 0.05)(F, D)),
        }
    _B_in = _B_setup()

    return {
        "A_x": _A_in["x"],
        "A_c_kv": _A_in["c_kv"],
        "A_w_q": _A_in["w_q"],
        "A_w_uk": _A_in["w_uk"],
        "A_w_uv": _A_in["w_uv"],
        "A_w_o": _A_in["w_o"],
        "B_x": _B_in["x"],
        "B_w_gate": _B_in["w_gate"],
        "B_w_up": _B_in["w_up"],
        "B_w_down": _B_in["w_down"],
    }

def reference(A_x, A_c_kv, A_w_q, A_w_uk, A_w_uv, A_w_o, B_x, B_w_gate, B_w_up, B_w_down):
    def _A_ref(x, c_kv, w_q, w_uk, w_uv, w_o):
        B, Sq, M = x.shape[0], x.shape[1], x.shape[2]
        Sk = c_kv.shape[1]
        H, D = w_q.shape[1], w_q.shape[2]
        q = torch.einsum("bqm,mhd->bhqd", x, w_q)
        k = torch.einsum("bkc,chd->bhkd", c_kv, w_uk)
        v = torch.einsum("bkc,chd->bhkd", c_kv, w_uv)
        scores = torch.einsum("bhqd,bhkd->bhqk", q, k) * (D ** -0.5)
        off = Sk - Sq
        qi = torch.arange(Sq)[:, None]
        kj = torch.arange(Sk)[None, :]
        cmask = kj <= (qi + off)
        scores = torch.where(cmask[None, None], scores, -1e9)
        p = _softmax(scores, axis=-1)
        ctx = torch.einsum("bhqk,bhkd->bhqd", p, v)
        return torch.einsum("bhqd,hdm->bqm", ctx, w_o)

    def _B_ref(x, w_gate, w_up, w_down):
        return (_gelu(x @ w_gate) * (x @ w_up)) @ w_down

    x = A_x
    xn = _layernorm(x, axis=-1)
    return x + _A_ref(xn, A_c_kv, A_w_q, A_w_uk, A_w_uv, A_w_o) + _B_ref(xn, B_w_gate, B_w_up, B_w_down)
```

```asm
; @launch grid=(256,1,1) block=(256,1,1) lds=163840
.amdgcn_target "amdgcn-amd-amdhsa--gfx950"
.text
.p2align 12
.globl parallel_sum__compressed_kv_cla__geglu_ffn__prompt_kernel
.p2align 8
.type parallel_sum__compressed_kv_cla__geglu_ffn__prompt_kernel,@function
parallel_sum__compressed_kv_cla__geglu_ffn__prompt_kernel:

s_cmp_ge_u32 s2, 256
s_cbranch_scc1 Lend
s_load_dwordx16 s[4:19], s[0:1], 0
s_load_dwordx8 s[20:27], s[0:1], 64
s_load_dwordx2 s[28:29], s[0:1], 96
s_getpc_b64 s[52:53]
s_bfe_u32 s54, s2, 0x50003
s_lshl_b32 s54, s54, 11
v_lshrrev_b32 v2, 4, v0
v_lshl_add_u32 v2, v2, 7, s54
v_min_u32 v2, 58788, v2
v_mov_b32 v3, s53
v_add_co_u32 v2, vcc, s52, v2
s_nop 1
v_addc_co_u32 v3, vcc, 0, v3, vcc
global_load_dword v14, v[2:3], off
v_accvgpr_write_b32 a226, v2
v_accvgpr_write_b32 a227, v3
v_lshrrev_b32 v1, 6, v0
v_and_b32 v0, 63, v0
v_readfirstlane_b32 s30, v1
s_and_b32 s31, s2, 1
s_lshl_b32 s31, s31, 2
s_bfe_u32 s3, s2, 0x20001
s_add_u32 s31, s31, s3
s_and_b32 s3, s2, 24
s_add_u32 s31, s31, s3
s_lshr_b32 s3, s2, 5
v_lshrrev_b32 v8, 5, v0
v_mul_u32_u24 v8, 1280, v8
v_and_b32 v9, 31, v0
v_lshl_add_u32 v8, v9, 3, v8
s_lshl_b32 s54, s2, 2
s_add_u32 s54, s54, s30
s_mul_i32 s54, s54, 2560
v_lshrrev_b32 v10, 5, v0
v_bfe_u32 v11, v0, 2, 2
v_lshl_add_u32 v10, v10, 2, v11
v_mul_u32_u24 v4, 0x2000, v10
v_bfe_u32 v10, v0, 4, 1
v_lshl_add_u32 v4, v10, 6, v4
v_and_b32 v10, 3, v0
v_lshl_add_u32 v4, v10, 4, v4
v_lshlrev_b32 v7, 3, v10
v_lshl_add_u32 v7, v11, 6, v7
v_lshrrev_b32 v10, 4, v0
v_mul_u32_u24 v10, 1056, v10
v_add_u32 v7, v7, v10
v_lshlrev_b32 v1, 4, v0
v_lshrrev_b32 v10, 4, v0
v_and_b32 v11, 7, v0
v_xor_b32 v10, v10, v11
v_lshlrev_b32 v10, 4, v10
v_lshrrev_b32 v11, 3, v0
v_lshl_add_u32 v2, v11, 10, v10
v_xor_b32 v3, 64, v2
s_and_b32 s52, s30, 1
s_lshl_b32 s66, s52, 7
s_lshl_b32 s53, s31, 8
s_add_u32 s66, s66, s53
s_mul_i32 s53, s52, 4224
s_add_u32 s53, s53, 67584
v_add_u32 v7, s53, v7
s_lshr_b32 s52, s30, 1
s_mul_i32 s67, s52, 16896
s_add_u32 s67, s67, s53
s_lshl_b32 s52, s52, 18
s_add_u32 s66, s66, s52
s_lshl_b32 s64, s3, 18
s_lshl_b32 s53, s30, 16
s_add_u32 s64, s64, s53
s_lshl_b32 s65, s30, 13
s_waitcnt lgkmcnt(0)
s_add_u32 s48, s28, 0x300000
s_addc_u32 s49, s29, 0
s_mov_b32 s50, 0xa000
s_mov_b32 s51, 0x20000
s_mov_b32 s44, s26
s_mov_b32 s45, s27
s_mov_b32 s46, 0x100
s_mov_b32 s47, 0x20000
s_lshl_b32 s17, s2, 2
s_add_u32 s55, s17, s30
s_cmp_lg_u32 s55, 3
s_cbranch_scc1 Lnoclr
v_mov_b32 v28, 0
v_mov_b32 v29, 0
v_mov_b32 v30, 0
v_mov_b32 v31, 0
s_mov_b32 s52, 4096
buffer_store_dwordx4 v[28:31], v1, s[48:51], 0 offen offset:0 sc1
buffer_store_dwordx4 v[28:31], v1, s[48:51], 0 offen offset:1024 sc1
buffer_store_dwordx4 v[28:31], v1, s[48:51], 0 offen offset:2048 sc1
buffer_store_dwordx4 v[28:31], v1, s[48:51], 0 offen offset:3072 sc1
buffer_store_dwordx4 v[28:31], v1, s[48:51], s52 offen sc1
v_lshlrev_b32 v26, 7, v0
s_mov_b32 s52, 8192
buffer_store_dword v28, v26, s[48:51], s52 offen sc1
s_mov_b32 s52, 16384
buffer_store_dword v28, v26, s[48:51], s52 offen sc1
s_mov_b32 s52, 24576
buffer_store_dword v28, v26, s[48:51], s52 offen sc1
s_mov_b32 s52, 32768
buffer_store_dword v28, v26, s[48:51], s52 offen sc1
Lnoclr:
s_mov_b32 s32, s6
s_mov_b32 s33, s7
s_mov_b32 s34, 0x200000
s_mov_b32 s35, 0x20000
s_mov_b32 s40, s4
s_mov_b32 s41, s5
s_mov_b32 s42, 0x280000
s_mov_b32 s43, 0x20000
buffer_load_dwordx2 v[16:17], v8, s[40:43], s54 offen offset:0
buffer_load_dwordx2 v[18:19], v8, s[40:43], s54 offen offset:256
buffer_load_dwordx2 v[20:21], v8, s[40:43], s54 offen offset:512
buffer_load_dwordx2 v[22:23], v8, s[40:43], s54 offen offset:768
buffer_load_dwordx2 v[24:25], v8, s[40:43], s54 offen offset:1024
s_mov_b32 s36, s10
s_mov_b32 s37, s11
s_mov_b32 s38, 0x400000
s_mov_b32 s39, 0x20000
s_mov_b32 s92, s12
s_mov_b32 s93, s13
s_mov_b32 s94, 0x400000
s_mov_b32 s95, 0x20000
s_add_u32 m0, s67, 0
s_add_u32 s90, s66, 0x0
buffer_load_dwordx4 v4, s[36:39], s90 offen lds
s_add_u32 m0, s67, 1056
s_add_u32 s90, s66, 0x10000
buffer_load_dwordx4 v4, s[36:39], s90 offen lds
s_add_u32 m0, s67, 2112
s_add_u32 s90, s66, 0x20000
buffer_load_dwordx4 v4, s[36:39], s90 offen lds
s_add_u32 m0, s67, 3168
s_add_u32 s90, s66, 0x30000
buffer_load_dwordx4 v4, s[36:39], s90 offen lds
s_add_u32 m0, s65, 0
s_nop 0
buffer_load_dwordx4 v2, s[32:35], s64 offen lds
s_add_u32 m0, s65, 1024
s_add_u32 s64, s64, 0x2000
buffer_load_dwordx4 v3, s[32:35], s64 offen lds
s_add_u32 m0, s65, 2048
s_add_u32 s64, s64, 0x2000
buffer_load_dwordx4 v2, s[32:35], s64 offen lds
s_add_u32 m0, s65, 3072
s_add_u32 s64, s64, 0x2000
buffer_load_dwordx4 v3, s[32:35], s64 offen lds
s_add_u32 m0, s65, 4096
s_add_u32 s64, s64, 0x2000
buffer_load_dwordx4 v2, s[32:35], s64 offen lds
s_add_u32 m0, s65, 5120
s_add_u32 s64, s64, 0x2000
buffer_load_dwordx4 v3, s[32:35], s64 offen lds
s_add_u32 m0, s65, 6144
s_add_u32 s64, s64, 0x2000
buffer_load_dwordx4 v2, s[32:35], s64 offen lds
s_add_u32 m0, s65, 7168
s_add_u32 s64, s64, 0x2000
buffer_load_dwordx4 v3, s[32:35], s64 offen lds
s_sub_u32 s64, s64, 57216
s_xor_b32 s65, s65, 0x8000
v_bfe_u32 v8, v0, 1, 4
v_lshlrev_b32 v8, 7, v8
v_and_b32 v9, 1, v0
v_lshl_add_u32 v8, v9, 3, v8
v_lshrrev_b32 v9, 5, v0
v_lshl_add_u32 v9, s30, 1, v9
v_bfe_u32 v10, v0, 1, 3
v_xor_b32 v9, v9, v10
v_lshl_add_u32 v8, v9, 4, v8
v_add_u32 v8, 135168, v8
v_and_b32 v10, 15, v0
v_lshrrev_b32 v11, 1, v10
v_lshrrev_b32 v12, 4, v0
v_xor_b32 v11, v11, v12
v_lshlrev_b32 v11, 4, v11
v_lshl_add_u32 v11, v10, 7, v11
s_lshr_b32 s53, s30, 1
s_lshl_b32 s53, s53, 14
v_add_u32 v5, s53, v11
v_xor_b32 v6, 64, v5
s_lshl_b32 s52, s30, 10
s_add_u32 s52, s52, 135168
v_add_u32 v10, s52, v1
v_lshrrev_b32 v9, 3, v0
v_and_b32 v11, 7, v0
v_xor_b32 v11, v11, v9
v_lshlrev_b32 v9, 8, v9
v_lshl_add_u32 v9, v11, 4, v9
s_cmp_lt_u32 s30, 2
s_cselect_b32 s52, 0x2000, 0
v_add_u32 v11, s52, v10
s_mov_b32 s68, 33792
s_mov_b64 exec, 0
s_cmp_lt_u32 s30, 2
s_cbranch_scc1 Lhop01
s_cmp_eq_u32 s30, 2
s_cbranch_scc1 Lpad2
s_branch Lpad3
Lhop01:
s_cmp_eq_u32 s30, 0
s_cbranch_scc1 Lpad0
s_branch Lpad1
Lhopback:
s_mov_b64 exec, -1
s_waitcnt vmcnt(12)
s_cmp_lg_u32 s55, 3
s_cbranch_scc1 Lclr
v_mov_b32 v28, 1
s_mov_b64 exec, 1
buffer_store_dword v28, off, s[44:47], 0 sc1
s_mov_b64 exec, -1
Lclr:
s_add_u32 m0, s67, 8448
s_add_u32 s90, s66, 0x0
buffer_load_dwordx4 v4, s[92:95], s90 offen lds
v_lshlrev_b32 v26, 16, v16
v_and_b32 v27, 0xffff0000, v16
v_lshlrev_b32 v28, 16, v17
v_and_b32 v29, 0xffff0000, v17
v_lshlrev_b32 v30, 16, v18
v_and_b32 v31, 0xffff0000, v18
v_lshlrev_b32 v32, 16, v19
v_and_b32 v33, 0xffff0000, v19
v_lshlrev_b32 v34, 16, v20
s_add_u32 m0, s67, 9504
s_add_u32 s90, s66, 0x10000
buffer_load_dwordx4 v4, s[92:95], s90 offen lds
v_and_b32 v35, 0xffff0000, v20
v_lshlrev_b32 v36, 16, v21
v_and_b32 v37, 0xffff0000, v21
v_lshlrev_b32 v38, 16, v22
v_and_b32 v39, 0xffff0000, v22
v_lshlrev_b32 v40, 16, v23
v_and_b32 v41, 0xffff0000, v23
v_lshlrev_b32 v42, 16, v24
v_and_b32 v43, 0xffff0000, v24
v_lshlrev_b32 v44, 16, v25
s_add_u32 m0, s67, 10560
s_add_u32 s90, s66, 0x20000
buffer_load_dwordx4 v4, s[92:95], s90 offen lds
v_and_b32 v45, 0xffff0000, v25
v_pk_add_f32 v[48:49], v[26:27], v[28:29]
v_pk_add_f32 v[50:51], v[30:31], v[32:33]
v_pk_add_f32 v[48:49], v[48:49], v[34:35]
v_pk_add_f32 v[50:51], v[50:51], v[36:37]
v_pk_add_f32 v[48:49], v[48:49], v[38:39]
v_pk_add_f32 v[50:51], v[50:51], v[40:41]
v_pk_add_f32 v[48:49], v[48:49], v[42:43]
v_pk_add_f32 v[50:51], v[50:51], v[44:45]
s_add_u32 m0, s67, 11616
s_add_u32 s90, s66, 0x30000
buffer_load_dwordx4 v4, s[92:95], s90 offen lds
v_pk_add_f32 v[48:49], v[48:49], v[50:51]
s_nop 0
v_add_f32 v48, v48, v49
s_nop 1
v_add_f32_dpp v48, v48, v48 row_ror:8 row_mask:0xf bank_mask:0xf
s_nop 1
v_add_f32_dpp v48, v48, v48 row_ror:4 row_mask:0xf bank_mask:0xf
s_nop 1
v_add_f32_dpp v48, v48, v48 row_ror:2 row_mask:0xf bank_mask:0xf
s_nop 1
s_add_u32 m0, s67, 33792
s_add_u32 s90, s66, 0x80000
buffer_load_dwordx4 v4, s[36:39], s90 offen lds
v_add_f32_dpp v48, v48, v48 row_ror:1 row_mask:0xf bank_mask:0xf
v_mov_b32 v49, v48
s_nop 1
v_permlane16_swap_b32 v48, v49
v_add_f32 v48, v48, v49
v_mul_f32 v48, 0x3acccccd, v48
v_cvt_pk_bf16_f32 v46, v48, v48
v_lshlrev_b32 v46, 16, v46
v_sub_f32 v47, v48, v46
s_add_u32 m0, s67, 34848
s_add_u32 s90, s66, 0x90000
buffer_load_dwordx4 v4, s[36:39], s90 offen lds
v_pk_add_f32 v[26:27], v[26:27], v[46:47] op_sel_hi:[1,0] neg_lo:[0,1] neg_hi:[0,1]
v_pk_add_f32 v[28:29], v[28:29], v[46:47] op_sel_hi:[1,0] neg_lo:[0,1] neg_hi:[0,1]
v_pk_add_f32 v[30:31], v[30:31], v[46:47] op_sel_hi:[1,0] neg_lo:[0,1] neg_hi:[0,1]
v_pk_add_f32 v[32:33], v[32:33], v[46:47] op_sel_hi:[1,0] neg_lo:[0,1] neg_hi:[0,1]
v_pk_add_f32 v[34:35], v[34:35], v[46:47] op_sel_hi:[1,0] neg_lo:[0,1] neg_hi:[0,1]
v_pk_add_f32 v[36:37], v[36:37], v[46:47] op_sel_hi:[1,0] neg_lo:[0,1] neg_hi:[0,1]
v_pk_add_f32 v[38:39], v[38:39], v[46:47] op_sel_hi:[1,0] neg_lo:[0,1] neg_hi:[0,1]
v_pk_add_f32 v[40:41], v[40:41], v[46:47] op_sel_hi:[1,0] neg_lo:[0,1] neg_hi:[0,1]
v_pk_add_f32 v[42:43], v[42:43], v[46:47] op_sel_hi:[1,0] neg_lo:[0,1] neg_hi:[0,1]
v_pk_add_f32 v[44:45], v[44:45], v[46:47] op_sel_hi:[1,0] neg_lo:[0,1] neg_hi:[0,1]
s_add_u32 m0, s67, 35904
s_add_u32 s90, s66, 0xa0000
buffer_load_dwordx4 v4, s[36:39], s90 offen lds
v_pk_mul_f32 v[48:49], v[26:27], v[26:27]
v_pk_mul_f32 v[50:51], v[28:29], v[28:29]
v_pk_fma_f32 v[48:49], v[30:31], v[30:31], v[48:49]
v_pk_fma_f32 v[50:51], v[32:33], v[32:33], v[50:51]
v_pk_fma_f32 v[48:49], v[34:35], v[34:35], v[48:49]
v_pk_fma_f32 v[50:51], v[36:37], v[36:37], v[50:51]
v_pk_fma_f32 v[48:49], v[38:39], v[38:39], v[48:49]
v_pk_fma_f32 v[50:51], v[40:41], v[40:41], v[50:51]
v_pk_fma_f32 v[48:49], v[42:43], v[42:43], v[48:49]
s_add_u32 m0, s67, 36960
s_add_u32 s90, s66, 0xb0000
buffer_load_dwordx4 v4, s[36:39], s90 offen lds
s_add_u32 s66, s66, 0x80000
s_add_u32 s67, s67, 33792
v_pk_fma_f32 v[50:51], v[44:45], v[44:45], v[50:51]
v_pk_add_f32 v[48:49], v[48:49], v[50:51]
s_nop 0
v_add_f32 v48, v48, v49
s_nop 1
v_add_f32_dpp v48, v48, v48 row_ror:8 row_mask:0xf bank_mask:0xf
s_nop 1
v_add_f32_dpp v48, v48, v48 row_ror:4 row_mask:0xf bank_mask:0xf
s_nop 1
v_add_f32_dpp v48, v48, v48 row_ror:2 row_mask:0xf bank_mask:0xf
s_add_u32 m0, s65, 0
s_nop 0
buffer_load_dwordx4 v2, s[32:35], s64 offen lds
s_nop 1
v_add_f32_dpp v48, v48, v48 row_ror:1 row_mask:0xf bank_mask:0xf
v_mov_b32 v49, v48
s_nop 1
v_permlane16_swap_b32 v48, v49
v_add_f32 v48, v48, v49
v_mul_f32 v48, 0x3acccccd, v48
v_fma_f32 v48, -v47, v47, v48
v_max_f32 v48, 0, v48
s_add_u32 m0, s65, 1024
s_add_u32 s64, s64, 0x2000
buffer_load_dwordx4 v3, s[32:35], s64 offen lds
v_cvt_pk_bf16_f32 v48, v48, v48
v_lshlrev_b32 v48, 16, v48
v_add_f32 v48, 0x3727c5ac, v48
v_cvt_pk_bf16_f32 v48, v48, v48
v_lshlrev_b32 v48, 16, v48
v_sqrt_f32 v48, v48
s_nop 0
v_cvt_pk_bf16_f32 v48, v48, v48
v_lshlrev_b32 v48, 16, v48
v_rcp_f32 v48, v48
s_waitcnt vmcnt(10)
s_barrier
ds_read_b64_tr_b16 a[160:161], v7 offset:0
ds_read_b64_tr_b16 a[162:163], v7 offset:512
ds_read_b64_tr_b16 a[164:165], v7 offset:16896
ds_read_b64_tr_b16 a[166:167], v7 offset:17408
ds_read_b64_tr_b16 a[168:169], v7 offset:32
ds_read_b64_tr_b16 a[170:171], v7 offset:544
ds_read_b64_tr_b16 a[172:173], v7 offset:16928
ds_read_b64_tr_b16 a[174:175], v7 offset:17440
ds_read_b128 a[64:67], v5 offset:0
ds_read_b128 a[68:71], v6 offset:0
ds_read_b128 a[72:75], v5 offset:2048
ds_read_b128 a[76:79], v6 offset:2048
ds_read_b128 a[80:83], v5 offset:4096
ds_read_b128 a[84:87], v6 offset:4096
ds_read_b128 a[88:91], v5 offset:6144
ds_read_b128 a[92:95], v6 offset:6144
ds_read_b128 a[96:99], v5 offset:8192
ds_read_b128 a[100:103], v6 offset:8192
ds_read_b128 a[104:107], v5 offset:10240
ds_read_b128 a[108:111], v6 offset:10240
ds_read_b128 a[112:115], v5 offset:12288
ds_read_b128 a[116:119], v6 offset:12288
ds_read_b128 a[120:123], v5 offset:14336
ds_read_b128 a[124:127], v6 offset:14336
s_add_u32 m0, s65, 2048
s_add_u32 s64, s64, 0x2000
buffer_load_dwordx4 v2, s[32:35], s64 offen lds
v_mul_f32 v48, 0x3e0293ee, v48
v_cvt_pk_bf16_f32 v16, v26, v27
v_cvt_pk_bf16_f32 v17, v28, v29
v_cvt_pk_bf16_f32 v18, v30, v31
v_cvt_pk_bf16_f32 v19, v32, v33
v_cvt_pk_bf16_f32 v20, v34, v35
v_cvt_pk_bf16_f32 v21, v36, v37
v_cvt_pk_bf16_f32 v22, v38, v39
v_cvt_pk_bf16_f32 v23, v40, v41
v_cvt_pk_bf16_f32 v24, v42, v43
v_cvt_pk_bf16_f32 v25, v44, v45
v_lshlrev_b32 v26, 16, v16
v_and_b32 v27, 0xffff0000, v16
v_lshlrev_b32 v28, 16, v17
s_add_u32 m0, s65, 3072
s_add_u32 s64, s64, 0x2000
buffer_load_dwordx4 v3, s[32:35], s64 offen lds
v_and_b32 v29, 0xffff0000, v17
v_lshlrev_b32 v30, 16, v18
v_and_b32 v31, 0xffff0000, v18
v_lshlrev_b32 v32, 16, v19
v_and_b32 v33, 0xffff0000, v19
v_lshlrev_b32 v34, 16, v20
v_and_b32 v35, 0xffff0000, v20
v_lshlrev_b32 v36, 16, v21
v_and_b32 v37, 0xffff0000, v21
v_lshlrev_b32 v38, 16, v22
v_and_b32 v39, 0xffff0000, v22
v_lshlrev_b32 v40, 16, v23
v_and_b32 v41, 0xffff0000, v23
v_lshlrev_b32 v42, 16, v24
s_add_u32 m0, s65, 4096
s_add_u32 s64, s64, 0x2000
buffer_load_dwordx4 v2, s[32:35], s64 offen lds
v_and_b32 v43, 0xffff0000, v24
v_lshlrev_b32 v44, 16, v25
v_and_b32 v45, 0xffff0000, v25
v_pk_mul_f32 v[26:27], v[26:27], v[48:49] op_sel_hi:[1,0]
v_pk_mul_f32 v[28:29], v[28:29], v[48:49] op_sel_hi:[1,0]
v_pk_mul_f32 v[30:31], v[30:31], v[48:49] op_sel_hi:[1,0]
v_pk_mul_f32 v[32:33], v[32:33], v[48:49] op_sel_hi:[1,0]
v_pk_mul_f32 v[34:35], v[34:35], v[48:49] op_sel_hi:[1,0]
v_pk_mul_f32 v[36:37], v[36:37], v[48:49] op_sel_hi:[1,0]
v_pk_mul_f32 v[38:39], v[38:39], v[48:49] op_sel_hi:[1,0]
v_pk_mul_f32 v[40:41], v[40:41], v[48:49] op_sel_hi:[1,0]
v_pk_mul_f32 v[42:43], v[42:43], v[48:49] op_sel_hi:[1,0]
v_pk_mul_f32 v[44:45], v[44:45], v[48:49] op_sel_hi:[1,0]
v_cvt_pk_bf16_f32 v16, v26, v27
s_add_u32 m0, s65, 5120
s_add_u32 s64, s64, 0x2000
buffer_load_dwordx4 v3, s[32:35], s64 offen lds
v_cvt_pk_bf16_f32 v17, v28, v29
ds_write_b64 v8, v[16:17] offset:0
v_cvt_pk_bf16_f32 v18, v30, v31
v_cvt_pk_bf16_f32 v19, v32, v33
ds_write_b64 v8, v[18:19] offset:2048
v_cvt_pk_bf16_f32 v20, v34, v35
v_cvt_pk_bf16_f32 v21, v36, v37
ds_write_b64 v8, v[20:21] offset:4096
v_cvt_pk_bf16_f32 v22, v38, v39
v_cvt_pk_bf16_f32 v23, v40, v41
ds_write_b64 v8, v[22:23] offset:6144
v_cvt_pk_bf16_f32 v24, v42, v43
v_cvt_pk_bf16_f32 v25, v44, v45
ds_write_b64 v8, v[24:25] offset:8192
s_waitcnt lgkmcnt(0)
s_barrier
v_mfma_f32_16x16x32_bf16 v[16:19], a[160:163], a[64:67], 0
s_cmp_lt_u32 s30, 3
s_cselect_b32 s96, s18, s20
s_cselect_b32 s97, s19, s21
v_mfma_f32_16x16x32_bf16 v[16:19], a[164:167], a[68:71], v[16:19]
s_add_u32 m0, s65, 6144
s_add_u32 s64, s64, 0x2000
v_mfma_f32_16x16x32_bf16 a[240:243], a[172:175], a[68:71], 0
buffer_load_dwordx4 v2, s[32:35], s64 offen lds
v_mfma_f32_16x16x32_bf16 a[240:243], a[168:171], a[64:67], a[240:243]
ds_read_b128 a[128:131], v10
ds_read_b128 a[132:135], v10 offset:4096
s_and_b32 s52, s31, 7
s_mul_i32 s52, s52, 3
s_sub_u32 s53, s3, s52
v_mfma_f32_16x16x32_bf16 a[244:247], a[168:171], a[72:75], 0
ds_read_b128 a[136:139], v11
s_and_b32 s53, s53, 7
s_add_u32 s52, s52, s53
s_lshr_b32 s52, s52, 3
v_mfma_f32_16x16x32_bf16 a[244:247], a[172:175], a[76:79], a[244:247]
s_add_u32 s52, s52, 24
s_cmp_lt_u32 s53, 3
s_cselect_b32 s52, s52, 27
v_mfma_f32_16x16x32_bf16 v[44:47], a[164:167], a[76:79], 0
s_add_u32 m0, s65, 7168
s_add_u32 s64, s64, 0x2000
v_mfma_f32_16x16x32_bf16 v[44:47], a[160:163], a[72:75], v[44:47]
buffer_load_dwordx4 v3, s[32:35], s64 offen lds
v_mfma_f32_16x16x32_bf16 v[72:75], a[160:163], a[80:83], 0
s_cmp_lt_u32 s31, 24
s_cselect_b32 s62, s31, s52
v_mfma_f32_16x16x32_bf16 v[72:75], a[164:167], a[84:87], v[72:75]
s_waitcnt lgkmcnt(0)
v_mfma_f32_16x16x32_bf16 a[248:251], a[172:175], a[84:87], 0
s_cmp_lt_u32 s62, 27
s_cselect_b32 s54, 0x21c000, 0
s_lshl_b32 s53, s62, 7
v_mfma_f32_16x16x32_bf16 a[248:251], a[168:171], a[80:83], a[248:251]
ds_read_b64_tr_b16 a[176:177], v7 offset:256
ds_read_b64_tr_b16 a[178:179], v7 offset:768
s_lshl_b32 s52, s31, 1
s_add_u32 s52, s52, s30
s_lshl_b32 s52, s52, 7
v_mfma_f32_16x16x32_bf16 a[252:255], a[168:171], a[88:91], 0
s_sub_u32 s64, s64, 57216
s_xor_b32 s65, s65, 0x8000
s_add_u32 m0, s67, 8448
s_add_u32 s90, s66, 0x0
v_mfma_f32_16x16x32_bf16 a[252:255], a[172:175], a[92:95], a[252:255]
buffer_load_dwordx4 v4, s[92:95], s90 offen lds
v_mfma_f32_16x16x32_bf16 v[100:103], a[164:167], a[92:95], 0
s_cmp_lt_u32 s30, 2
s_cselect_b32 s96, s8, s96
s_cselect_b32 s97, s9, s97
s_cselect_b32 s98, 0x500000, s54
s_mov_b32 s99, 0x20000
s_cselect_b32 s79, s52, s53
s_mov_b32 s80, 8192
s_cselect_b32 s80, s80, 3456
v_mfma_f32_16x16x32_bf16 v[100:103], a[160:163], a[88:91], v[100:103]
ds_read_b64_tr_b16 a[180:181], v7 offset:17152
ds_read_b64_tr_b16 a[182:183], v7 offset:17664
s_mul_i32 s52, s3, 14
s_mul_i32 s52, s52, s80
s_add_u32 s81, s52, s79
v_mfma_f32_16x16x32_bf16 v[128:131], a[160:163], a[96:99], 0
s_mul_i32 s82, s80, 112
s_lshl_b32 s16, s31, 3
s_add_u32 s16, s16, s3
v_mfma_f32_16x16x32_bf16 v[128:131], a[164:167], a[100:103], v[128:131]
s_add_u32 m0, s67, 9504
s_add_u32 s90, s66, 0x10000
v_mfma_f32_16x16x32_bf16 v[132:135], a[172:175], a[100:103], 0
buffer_load_dwordx4 v4, s[92:95], s90 offen lds
v_mfma_f32_16x16x32_bf16 v[132:135], a[168:171], a[96:99], v[132:135]
ds_read_b64_tr_b16 a[184:185], v7 offset:288
ds_read_b64_tr_b16 a[186:187], v7 offset:800
s_lshl_b32 s16, s16, 2
s_lshr_b32 s52, s2, 1
s_mul_i32 s52, s52, 20480
v_mfma_f32_16x16x32_bf16 v[164:167], a[168:171], a[104:107], 0
s_and_b32 s53, s2, 1
s_lshl_b32 s53, s53, 7
s_add_u32 s52, s52, s53
v_mfma_f32_16x16x32_bf16 v[164:167], a[172:175], a[108:111], v[164:167]
Lpad0:
s_cbranch_execz Lpad4
s_add_u32 m0, s67, 10560
s_add_u32 s90, s66, 0x20000
v_mfma_f32_16x16x32_bf16 v[160:163], a[164:167], a[108:111], 0
buffer_load_dwordx4 v4, s[92:95], s90 offen lds
v_mfma_f32_16x16x32_bf16 v[160:163], a[160:163], a[104:107], v[160:163]
ds_read_b64_tr_b16 a[188:189], v7 offset:17184
ds_read_b64_tr_b16 a[190:191], v7 offset:17696
v_mfma_f32_16x16x32_bf16 v[192:195], a[160:163], a[112:115], 0
s_lshl_b32 s53, s30, 11
s_add_u32 s83, s52, s53
s_add_u32 s84, s83, 8192
v_mfma_f32_16x16x32_bf16 v[192:195], a[164:167], a[116:119], v[192:195]
s_add_u32 s85, s83, 16384
s_cmp_lt_u32 s30, 2
s_cselect_b32 s85, s85, 0x280000
s_mov_b32 s40, s28
v_mfma_f32_16x16x32_bf16 v[196:199], a[172:175], a[116:119], 0
s_add_u32 m0, s67, 11616
s_add_u32 s90, s66, 0x30000
v_mfma_f32_16x16x32_bf16 v[196:199], a[168:171], a[112:115], v[196:199]
buffer_load_dwordx4 v4, s[92:95], s90 offen lds
v_mfma_f32_16x16x32_bf16 v[228:231], a[168:171], a[120:123], 0
s_mov_b32 s41, s29
s_mov_b32 s42, 0x280000
s_mov_b32 s43, 0x20000
v_mfma_f32_16x16x32_bf16 v[228:231], a[172:175], a[124:127], v[228:231]
s_sub_u32 s67, s67, s68
s_add_u32 s66, s66, 0x80000
v_mfma_f32_16x16x32_bf16 v[224:227], a[164:167], a[124:127], 0
s_mov_b32 s63, 0
s_cmp_eq_u32 s30, 0
s_cselect_b32 s71, 2, 6
v_mfma_f32_16x16x32_bf16 v[224:227], a[160:163], a[120:123], v[224:227]
s_waitcnt vmcnt(16) lgkmcnt(0)
s_barrier
v_mfma_f32_16x16x32_bf16 v[232:235], a[176:179], a[120:123], 0
s_add_u32 m0, s67, 0
s_add_u32 s90, s66, 0x0
v_mfma_f32_16x16x32_bf16 v[232:235], a[180:183], a[124:127], v[232:235]
buffer_load_dwordx4 v4, s[36:39], s90 offen lds
v_mfma_f32_16x16x32_bf16 v[236:239], a[188:191], a[124:127], 0
ds_read_b64_tr_b16 a[160:161], v7 offset:8448
ds_read_b64_tr_b16 a[162:163], v7 offset:8960
v_mfma_f32_16x16x32_bf16 v[236:239], a[184:187], a[120:123], v[236:239]
s_and_b32 s6, s2, 3
s_and_b32 s52, s2, 4
s_lshl_b32 s52, s52, 1
v_mfma_f32_16x16x32_bf16 v[204:207], a[184:187], a[112:115], 0
s_add_u32 s7, s52, s3
s_bfe_u32 s8, s2, 0x20003
s_lshr_b32 s52, s30, 1
v_mfma_f32_16x16x32_bf16 v[204:207], a[188:191], a[116:119], v[204:207]
s_lshl_b32 s53, s7, 1
s_add_u32 s53, s53, s52
s_lshl_b32 s53, s53, 2
v_mfma_f32_16x16x32_bf16 v[200:203], a[180:183], a[116:119], 0
s_add_u32 s53, s53, s6
s_mul_i32 s53, s53, 20480
s_mul_i32 s54, s8, 320
v_mfma_f32_16x16x32_bf16 v[200:203], a[176:179], a[112:115], v[200:203]
s_add_u32 s13, s53, s54
s_mov_b32 s58, 0x21c000
s_mov_b32 s59, 0x20000
v_mfma_f32_16x16x32_bf16 v[168:171], a[176:179], a[104:107], 0
ds_read_b64_tr_b16 a[164:165], v7 offset:25344
ds_read_b64_tr_b16 a[166:167], v7 offset:25856
v_mfma_f32_16x16x32_bf16 v[168:171], a[180:183], a[108:111], v[168:171]
s_add_u32 m0, s67, 1056
s_add_u32 s90, s66, 0x10000
v_mfma_f32_16x16x32_bf16 v[172:175], a[188:191], a[108:111], 0
buffer_load_dwordx4 v4, s[36:39], s90 offen lds
v_mfma_f32_16x16x32_bf16 v[172:175], a[184:187], a[104:107], v[172:175]
s_add_u32 s86, s17, s30
s_cmp_lt_u32 s86, 216
s_cselect_b32 s52, 0, 216
s_cselect_b32 s88, 0, 0x240000
s_cselect_b64 s[56:57], s[22:23], s[14:15]
s_cselect_b32 s58, s58, 0x500000
v_mfma_f32_16x16x32_bf16 v[140:143], a[184:187], a[96:99], 0
s_add_u32 s88, s88, 0x4c00000
s_sub_u32 s52, s86, s52
s_mul_i32 s87, s52, 10240
v_mfma_f32_16x16x32_bf16 v[140:143], a[188:191], a[100:103], v[140:143]
s_lshr_b32 s53, s52, 2
s_mul_i32 s53, s53, 40960
s_add_u32 s88, s88, s53
v_mfma_f32_16x16x32_bf16 v[136:139], a[180:183], a[100:103], 0
ds_read_b64_tr_b16 a[168:169], v7 offset:8480
ds_read_b64_tr_b16 a[170:171], v7 offset:8992
v_mfma_f32_16x16x32_bf16 v[136:139], a[176:179], a[96:99], v[136:139]
s_and_b32 s53, s52, 1
s_lshl_b32 s53, s53, 9
s_add_u32 s88, s88, s53
v_mfma_f32_16x16x32_bf16 v[104:107], a[176:179], a[88:91], 0
s_and_b32 s53, s52, 2
s_lshl_b32 s53, s53, 7
s_add_u32 s88, s88, s53
v_mfma_f32_16x16x32_bf16 v[104:107], a[180:183], a[92:95], v[104:107]
s_add_u32 m0, s67, 2112
s_add_u32 s90, s66, 0x20000
v_mfma_f32_16x16x32_bf16 v[108:111], a[188:191], a[92:95], 0
buffer_load_dwordx4 v4, s[36:39], s90 offen lds
v_mfma_f32_16x16x32_bf16 v[108:111], a[184:187], a[88:91], v[108:111]
s_mul_i32 s53, s30, 1056
s_xor_b32 s52, s6, 0
s_lshl_b32 s52, s52, 10
v_mfma_f32_16x16x32_bf16 v[80:83], a[184:187], a[80:83], 0
ds_read_b64_tr_b16 a[172:173], v7 offset:25376
ds_read_b64_tr_b16 a[174:175], v7 offset:25888
v_mfma_f32_16x16x32_bf16 v[80:83], a[188:191], a[84:87], v[80:83]
s_add_u32 s52, s52, 20608
s_sub_u32 s18, s52, s53
s_xor_b32 s52, s6, 1
v_mfma_f32_16x16x32_bf16 v[76:79], a[180:183], a[84:87], 0
s_lshl_b32 s52, s52, 10
s_add_u32 s52, s52, 19584
s_sub_u32 s19, s52, s53
v_mfma_f32_16x16x32_bf16 v[76:79], a[176:179], a[80:83], v[76:79]
s_xor_b32 s52, s6, 2
s_lshl_b32 s52, s52, 10
s_add_u32 s52, s52, 18560
v_mfma_f32_16x16x32_bf16 v[48:51], a[176:179], a[72:75], 0
s_sub_u32 s20, s52, s53
s_xor_b32 s52, s6, 3
s_lshl_b32 s52, s52, 10
v_mfma_f32_16x16x32_bf16 v[48:51], a[180:183], a[76:79], v[48:51]
v_xor_b32 v5, 0x8000, v5
v_xor_b32 v6, 0x8000, v6
v_mfma_f32_16x16x32_bf16 v[52:55], a[188:191], a[76:79], 0
s_add_u32 m0, s67, 3168
s_add_u32 s90, s66, 0x30000
v_mfma_f32_16x16x32_bf16 v[52:55], a[184:187], a[72:75], v[52:55]
buffer_load_dwordx4 v4, s[36:39], s90 offen lds
v_mfma_f32_16x16x32_bf16 v[24:27], a[184:187], a[64:67], 0
s_add_u32 s52, s52, 17536
s_sub_u32 s21, s52, s53
s_sub_u32 s52, 15, s7
v_mfma_f32_16x16x32_bf16 v[24:27], a[188:191], a[68:71], v[24:27]
s_min_u32 s52, s52, s7
s_lshl_b32 s52, s52, 2
s_add_u32 s52, s52, s6
v_mfma_f32_16x16x32_bf16 v[20:23], a[180:183], a[68:71], 0
buffer_store_dwordx4 a[128:131], v9, s[40:43], s83 offen sc1
v_mfma_f32_16x16x32_bf16 v[20:23], a[176:179], a[64:67], v[20:23]
s_waitcnt lgkmcnt(0)
v_mfma_f32_16x16x32_bf16 v[28:31], a[64:67], a[160:163], 0
s_add_u32 m0, s65, 0
v_mfma_f32_16x16x32_bf16 v[28:31], a[68:71], a[164:167], v[28:31]
buffer_load_dwordx4 v2, s[32:35], s64 offen lds
v_mfma_f32_16x16x32_bf16 v[32:35], a[68:71], a[172:175], 0
ds_read_b64_tr_b16 a[176:177], v7 offset:8704
ds_read_b64_tr_b16 a[178:179], v7 offset:9216
v_mfma_f32_16x16x32_bf16 v[32:35], a[64:67], a[168:171], v[32:35]
v_cmp_gt_u32 vcc, 14, v0
v_mul_u32_u24 v14, s80, v0
v_mfma_f32_16x16x32_bf16 v[60:63], a[72:75], a[168:171], 0
v_mov_b32 v10, 0x7fffffff
v_cndmask_b32 v14, v10, v14, vcc
v_mfma_f32_16x16x32_bf16 v[60:63], a[76:79], a[172:175], v[60:63]
v_lshrrev_b32 v10, 5, v0
v_bfe_u32 v11, v0, 2, 2
v_mfma_f32_16x16x32_bf16 v[56:59], a[76:79], a[164:167], 0
buffer_store_dwordx4 a[132:135], v9, s[40:43], s84 offen sc1
v_mfma_f32_16x16x32_bf16 v[56:59], a[72:75], a[160:163], v[56:59]
v_lshl_add_u32 v10, v10, 2, v11
v_mul_u32_u24 v8, s80, v10
v_mfma_f32_16x16x32_bf16 v[84:87], a[80:83], a[160:163], 0
ds_read_b64_tr_b16 a[180:181], v7 offset:25600
ds_read_b64_tr_b16 a[182:183], v7 offset:26112
v_mfma_f32_16x16x32_bf16 v[84:87], a[84:87], a[164:167], v[84:87]
s_add_u32 m0, s65, 1024
s_add_u32 s64, s64, 0x2000
v_mfma_f32_16x16x32_bf16 v[88:91], a[84:87], a[172:175], 0
buffer_load_dwordx4 v3, s[32:35], s64 offen lds
v_mfma_f32_16x16x32_bf16 v[88:91], a[80:83], a[168:171], v[88:91]
v_bfe_u32 v10, v0, 4, 1
v_lshl_add_u32 v8, v10, 6, v8
v_mfma_f32_16x16x32_bf16 v[116:119], a[88:91], a[168:171], 0
v_and_b32 v10, 3, v0
v_lshl_add_u32 v8, v10, 4, v8
v_mfma_f32_16x16x32_bf16 v[116:119], a[92:95], a[172:175], v[116:119]
buffer_store_dwordx4 a[136:139], v9, s[40:43], s85 offen sc1
v_mfma_f32_16x16x32_bf16 v[112:115], a[92:95], a[164:167], 0
ds_read_b64_tr_b16 a[184:185], v7 offset:8736
ds_read_b64_tr_b16 a[186:187], v7 offset:9248
v_mfma_f32_16x16x32_bf16 v[112:115], a[88:91], a[160:163], v[112:115]
v_bfe_u32 v10, v0, 4, 1
v_mul_u32_u24 v10, 4864, v10
v_mfma_f32_16x16x32_bf16 v[144:147], a[96:99], a[160:163], 0
v_lshrrev_b32 v11, 5, v0
v_lshl_add_u32 v10, v11, 9, v10
v_mfma_f32_16x16x32_bf16 v[144:147], a[100:103], a[164:167], v[144:147]
s_add_u32 m0, s65, 2048
s_add_u32 s64, s64, 0x2000
v_mfma_f32_16x16x32_bf16 v[148:151], a[100:103], a[172:175], 0
buffer_load_dwordx4 v2, s[32:35], s64 offen lds
v_mfma_f32_16x16x32_bf16 v[148:151], a[96:99], a[168:171], v[148:151]
v_add_u32 v10, v10, v1
v_accvgpr_write_b32 a200, v10
v_mfma_f32_16x16x32_bf16 v[180:183], a[104:107], a[168:171], 0
ds_read_b64_tr_b16 a[188:189], v7 offset:25632
ds_read_b64_tr_b16 a[190:191], v7 offset:26144
v_mfma_f32_16x16x32_bf16 v[180:183], a[108:111], a[172:175], v[180:183]
v_bfe_u32 v10, v0, 2, 3
v_mul_u32_u24 v13, 1280, v10
v_mfma_f32_16x16x32_bf16 v[176:179], a[108:111], a[164:167], 0
v_lshl_add_u32 v13, v11, 6, v13
v_and_b32 v10, 3, v0
v_mfma_f32_16x16x32_bf16 v[176:179], a[104:107], a[160:163], v[176:179]
v_lshl_add_u32 v13, v10, 4, v13
v_and_b32 v10, 1, v0
v_mfma_f32_16x16x32_bf16 v[208:211], a[112:115], a[160:163], 0
v_mul_u32_u24 v10, 15, v10
v_xor_b32 v10, s3, v10
v_mfma_f32_16x16x32_bf16 v[208:211], a[116:119], a[164:167], v[208:211]
v_add_u32 v7, s68, v7
v_mfma_f32_16x16x32_bf16 v[212:215], a[116:119], a[172:175], 0
s_add_u32 m0, s65, 3072
s_add_u32 s64, s64, 0x2000
v_mfma_f32_16x16x32_bf16 v[212:215], a[112:115], a[168:171], v[212:215]
buffer_load_dwordx4 v3, s[32:35], s64 offen lds
v_mfma_f32_16x16x32_bf16 v[244:247], a[120:123], a[168:171], 0
v_and_b32 v11, 30, v0
v_lshlrev_b32 v11, 1, v11
v_mfma_f32_16x16x32_bf16 v[244:247], a[124:127], a[172:175], v[244:247]
v_lshl_add_u32 v9, v10, 6, v11
v_add_u32 v9, 4096, v9
v_mfma_f32_16x16x32_bf16 v[240:243], a[124:127], a[164:167], 0
buffer_load_dword v12, off, s[44:47], 0 sc1
v_mfma_f32_16x16x32_bf16 v[240:243], a[120:123], a[160:163], v[240:243]
s_waitcnt vmcnt(16) lgkmcnt(0)
s_barrier
v_mfma_f32_16x16x32_bf16 v[36:39], a[64:67], a[176:179], 0
s_add_u32 m0, s65, 4096
s_add_u32 s64, s64, 0x2000
v_mfma_f32_16x16x32_bf16 v[36:39], a[68:71], a[180:183], v[36:39]
ds_read_b64_tr_b16 a[160:161], v7 offset:0
ds_read_b64_tr_b16 a[162:163], v7 offset:512
v_mfma_f32_16x16x32_bf16 v[40:43], a[68:71], a[188:191], 0
buffer_load_dwordx4 v2, s[32:35], s64 offen lds
v_mfma_f32_16x16x32_bf16 v[40:43], a[64:67], a[184:187], v[40:43]
ds_read_b128 a[64:67], v5 offset:0
ds_read_b128 a[68:71], v6 offset:0
v_mfma_f32_16x16x32_bf16 v[68:71], a[72:75], a[184:187], 0
s_add_u32 s52, s52, 8
s_lshl_b32 s12, s52, 10
s_lshl_b32 s52, s3, 3
v_mfma_f32_16x16x32_bf16 v[68:71], a[76:79], a[188:191], v[68:71]
ds_read_b64_tr_b16 a[164:165], v7 offset:16896
ds_read_b64_tr_b16 a[166:167], v7 offset:17408
v_mfma_f32_16x16x32_bf16 v[64:67], a[76:79], a[180:183], 0
s_add_u32 s53, s52, s30
s_mul_i32 s72, s53, 20480
s_add_u32 s73, s72, 81920
v_mfma_f32_16x16x32_bf16 v[64:67], a[72:75], a[176:179], v[64:67]
ds_read_b128 a[72:75], v5 offset:2048
ds_read_b128 a[76:79], v6 offset:2048
v_mfma_f32_16x16x32_bf16 v[92:95], a[80:83], a[176:179], 0
s_add_u32 m0, s65, 5120
s_add_u32 s64, s64, 0x2000
v_mfma_f32_16x16x32_bf16 v[92:95], a[84:87], a[180:183], v[92:95]
ds_read_b64_tr_b16 a[168:169], v7 offset:32
ds_read_b64_tr_b16 a[170:171], v7 offset:544
v_mfma_f32_16x16x32_bf16 v[96:99], a[84:87], a[188:191], 0
buffer_load_dwordx4 v3, s[32:35], s64 offen lds
v_mfma_f32_16x16x32_bf16 v[96:99], a[80:83], a[184:187], v[96:99]
ds_read_b128 a[80:83], v5 offset:4096
ds_read_b128 a[84:87], v6 offset:4096
v_mfma_f32_16x16x32_bf16 v[124:127], a[88:91], a[184:187], 0
v_accvgpr_read_b32 v10, a226
v_accvgpr_read_b32 v11, a227
v_mfma_f32_16x16x32_bf16 v[124:127], a[92:95], a[188:191], v[124:127]
ds_read_b64_tr_b16 a[172:173], v7 offset:16928
ds_read_b64_tr_b16 a[174:175], v7 offset:17440
v_mfma_f32_16x16x32_bf16 v[120:123], a[92:95], a[180:183], 0
s_sub_u32 s53, s30, s52
s_add_u32 s53, s53, 120
s_mul_i32 s74, s53, 20480
v_mfma_f32_16x16x32_bf16 v[120:123], a[88:91], a[176:179], v[120:123]
ds_read_b128 a[88:91], v5 offset:6144
ds_read_b128 a[92:95], v6 offset:6144
v_mfma_f32_16x16x32_bf16 v[152:155], a[96:99], a[176:179], 0
s_add_u32 s75, s74, 81920
s_lshr_b32 s52, s30, 1
s_lshl_b32 s53, s3, 1
v_mfma_f32_16x16x32_bf16 v[152:155], a[100:103], a[180:183], v[152:155]
s_add_u32 m0, s65, 6144
s_add_u32 s64, s64, 0x2000
v_mfma_f32_16x16x32_bf16 v[156:159], a[100:103], a[188:191], 0
buffer_load_dwordx4 v2, s[32:35], s64 offen lds
v_mfma_f32_16x16x32_bf16 v[156:159], a[96:99], a[184:187], v[156:159]
ds_read_b128 a[96:99], v5 offset:8192
ds_read_b128 a[100:103], v6 offset:8192
v_mfma_f32_16x16x32_bf16 v[188:191], a[104:107], a[184:187], 0
s_add_u32 s52, s52, s53
s_lshl_b32 s52, s52, 16
s_and_b32 s53, s30, 1
v_mfma_f32_16x16x32_bf16 v[188:191], a[108:111], a[188:191], v[188:191]
s_lshl_b32 s53, s53, 11
s_lshl_b32 s54, s31, 20
s_add_u32 s52, s52, s54
v_mfma_f32_16x16x32_bf16 v[184:187], a[108:111], a[180:183], 0
s_add_u32 s63, s63, 1
v_mfma_f32_16x16x32_bf16 v[184:187], a[104:107], a[176:179], v[184:187]
ds_read_b128 a[104:107], v5 offset:10240
ds_read_b128 a[108:111], v6 offset:10240
v_mfma_f32_16x16x32_bf16 v[216:219], a[112:115], a[176:179], 0
s_add_u32 s54, s17, s30
s_mul_i32 s54, s54, 12288
s_add_u32 s9, s54, 0x3800000
v_mfma_f32_16x16x32_bf16 v[216:219], a[116:119], a[180:183], v[216:219]
s_add_u32 m0, s65, 7168
s_add_u32 s64, s64, 0x2000
v_mfma_f32_16x16x32_bf16 v[220:223], a[116:119], a[188:191], 0
buffer_load_dwordx4 v3, s[32:35], s64 offen lds
v_mfma_f32_16x16x32_bf16 v[220:223], a[112:115], a[184:187], v[220:223]
ds_read_b128 a[112:115], v5 offset:12288
ds_read_b128 a[116:119], v6 offset:12288
v_mfma_f32_16x16x32_bf16 v[252:255], a[120:123], a[184:187], 0
s_sub_u32 s64, s64, 57216
s_xor_b32 s65, s65, 0x8000
s_sub_u32 s68, 0, s68
v_mfma_f32_16x16x32_bf16 v[252:255], a[124:127], a[188:191], v[252:255]
s_add_u32 s76, s52, s53
s_add_u32 s77, s76, s53
s_add_u32 s77, s77, 16384
v_mfma_f32_16x16x32_bf16 v[248:251], a[124:127], a[180:183], 0
s_and_b32 s52, s3, 1
s_lshl_b32 s52, s52, 16
s_sub_u32 s0, 0x18000, s52
v_mfma_f32_16x16x32_bf16 v[248:251], a[120:123], a[176:179], v[248:251]
ds_read_b128 a[120:123], v5 offset:14336
ds_read_b128 a[124:127], v6 offset:14336
s_waitcnt lgkmcnt(6)
s_branch Lp1
.p2align 6
Lp1evt:
s_cmp_eq_u32 s63, 2
s_cbranch_scc1 Lp1e2
buffer_load_dword v12, v9, s[48:51], 0 offen sc1
buffer_load_dwordx4 a[232:235], v13, s[56:59], s87 offen offset:256
buffer_load_dwordx4 a[236:239], v13, s[56:59], s87 offen offset:896
global_load_dword a228, v[10:11], off
s_branch Lp1ret
Lp1e2:
s_mov_b32 s71, 6
v_cmp_gt_u32 vcc, 1, v12
s_mov_b32 s55, 0x200000
s_nop 0
s_cbranch_vccnz Lcl_ld
Lcl_ok:
s_add_u32 s52, s17, 4096
v_mov_b32 v12, 1
s_mov_b64 exec, 1
buffer_store_dword v12, off, s[48:51], s52 sc1
s_mov_b64 exec, -1
s_branch Lp1ret
.p2align 6
Lp1:
v_mfma_f32_16x16x32_bf16 v[16:19], a[160:163], a[64:67], v[16:19]
v_mfma_f32_16x16x32_bf16 v[16:19], a[164:167], a[68:71], v[16:19]
v_mfma_f32_16x16x32_bf16 a[240:243], a[172:175], a[68:71], a[240:243]
buffer_load_dword a224, v14, s[96:99], s81 offen
v_mfma_f32_16x16x32_bf16 a[240:243], a[168:171], a[64:67], a[240:243]
v_mfma_f32_16x16x32_bf16 a[244:247], a[168:171], a[72:75], a[244:247]
s_add_u32 s81, s81, s82
v_mfma_f32_16x16x32_bf16 a[244:247], a[172:175], a[76:79], a[244:247]
v_mfma_f32_16x16x32_bf16 v[44:47], a[164:167], a[76:79], v[44:47]
s_add_u32 m0, s67, 8448
s_add_u32 s90, s66, 0x0
v_mfma_f32_16x16x32_bf16 v[44:47], a[160:163], a[72:75], v[44:47]
buffer_load_dwordx4 v4, s[92:95], s90 offen lds
v_mfma_f32_16x16x32_bf16 v[72:75], a[160:163], a[80:83], v[72:75]
v_mfma_f32_16x16x32_bf16 v[72:75], a[164:167], a[84:87], v[72:75]
s_waitcnt lgkmcnt(0)
v_mfma_f32_16x16x32_bf16 a[248:251], a[172:175], a[84:87], a[248:251]
v_mfma_f32_16x16x32_bf16 a[248:251], a[168:171], a[80:83], a[248:251]
ds_read_b64_tr_b16 a[176:177], v7 offset:256
ds_read_b64_tr_b16 a[178:179], v7 offset:768
v_mfma_f32_16x16x32_bf16 a[252:255], a[168:171], a[88:91], a[252:255]
v_mfma_f32_16x16x32_bf16 a[252:255], a[172:175], a[92:95], a[252:255]
s_add_u32 m0, s67, 9504
s_add_u32 s90, s66, 0x10000
v_mfma_f32_16x16x32_bf16 v[100:103], a[164:167], a[92:95], v[100:103]
buffer_load_dwordx4 v4, s[92:95], s90 offen lds
v_mfma_f32_16x16x32_bf16 v[100:103], a[160:163], a[88:91], v[100:103]
ds_read_b64_tr_b16 a[180:181], v7 offset:17152
ds_read_b64_tr_b16 a[182:183], v7 offset:17664
v_mfma_f32_16x16x32_bf16 v[128:131], a[160:163], a[96:99], v[128:131]
v_mfma_f32_16x16x32_bf16 v[128:131], a[164:167], a[100:103], v[128:131]
v_mfma_f32_16x16x32_bf16 v[132:135], a[172:175], a[100:103], v[132:135]
v_mfma_f32_16x16x32_bf16 v[132:135], a[168:171], a[96:99], v[132:135]
ds_read_b64_tr_b16 a[184:185], v7 offset:288
ds_read_b64_tr_b16 a[186:187], v7 offset:800
v_mfma_f32_16x16x32_bf16 v[164:167], a[168:171], a[104:107], v[164:167]
s_add_u32 m0, s67, 10560
s_add_u32 s90, s66, 0x20000
v_mfma_f32_16x16x32_bf16 v[164:167], a[172:175], a[108:111], v[164:167]
buffer_load_dwordx4 v4, s[92:95], s90 offen lds
v_mfma_f32_16x16x32_bf16 v[160:163], a[164:167], a[108:111], v[160:163]
v_mfma_f32_16x16x32_bf16 v[160:163], a[160:163], a[104:107], v[160:163]
ds_read_b64_tr_b16 a[188:189], v7 offset:17184
ds_read_b64_tr_b16 a[190:191], v7 offset:17696
v_mfma_f32_16x16x32_bf16 v[192:195], a[160:163], a[112:115], v[192:195]
v_mfma_f32_16x16x32_bf16 v[192:195], a[164:167], a[116:119], v[192:195]
v_mfma_f32_16x16x32_bf16 v[196:199], a[172:175], a[116:119], v[196:199]
s_add_u32 m0, s67, 11616
s_add_u32 s90, s66, 0x30000
v_mfma_f32_16x16x32_bf16 v[196:199], a[168:171], a[112:115], v[196:199]
buffer_load_dwordx4 v4, s[92:95], s90 offen lds
v_mfma_f32_16x16x32_bf16 v[228:231], a[168:171], a[120:123], v[228:231]
v_mfma_f32_16x16x32_bf16 v[228:231], a[172:175], a[124:127], v[228:231]
s_sub_u32 s67, s67, s68
s_add_u32 s66, s66, 0x80000
v_mfma_f32_16x16x32_bf16 v[224:227], a[164:167], a[124:127], v[224:227]
v_mfma_f32_16x16x32_bf16 v[224:227], a[160:163], a[120:123], v[224:227]
s_waitcnt vmcnt(17) lgkmcnt(0)
s_barrier
v_mfma_f32_16x16x32_bf16 v[232:235], a[176:179], a[120:123], v[232:235]
s_add_u32 m0, s67, 0
s_add_u32 s90, s66, 0x0
v_mfma_f32_16x16x32_bf16 v[232:235], a[180:183], a[124:127], v[232:235]
buffer_load_dwordx4 v4, s[36:39], s90 offen lds
v_mfma_f32_16x16x32_bf16 v[236:239], a[188:191], a[124:127], v[236:239]
ds_read_b64_tr_b16 a[160:161], v7 offset:8448
ds_read_b64_tr_b16 a[162:163], v7 offset:8960
v_mfma_f32_16x16x32_bf16 v[236:239], a[184:187], a[120:123], v[236:239]
v_mfma_f32_16x16x32_bf16 v[204:207], a[184:187], a[112:115], v[204:207]
s_cmp_lt_u32 s63, 6
s_cselect_b32 s34, 0x200000, 0
v_mfma_f32_16x16x32_bf16 v[204:207], a[188:191], a[116:119], v[204:207]
v_mfma_f32_16x16x32_bf16 v[200:203], a[180:183], a[116:119], v[200:203]
v_mfma_f32_16x16x32_bf16 v[200:203], a[176:179], a[112:115], v[200:203]
v_mfma_f32_16x16x32_bf16 v[168:171], a[176:179], a[104:107], v[168:171]
ds_read_b64_tr_b16 a[164:165], v7 offset:25344
ds_read_b64_tr_b16 a[166:167], v7 offset:25856
v_mfma_f32_16x16x32_bf16 v[168:171], a[180:183], a[108:111], v[168:171]
s_add_u32 m0, s67, 1056
s_add_u32 s90, s66, 0x10000
v_mfma_f32_16x16x32_bf16 v[172:175], a[188:191], a[108:111], v[172:175]
buffer_load_dwordx4 v4, s[36:39], s90 offen lds
v_mfma_f32_16x16x32_bf16 v[172:175], a[184:187], a[104:107], v[172:175]
v_mfma_f32_16x16x32_bf16 v[140:143], a[184:187], a[96:99], v[140:143]
v_mfma_f32_16x16x32_bf16 v[140:143], a[188:191], a[100:103], v[140:143]
v_mfma_f32_16x16x32_bf16 v[136:139], a[180:183], a[100:103], v[136:139]
ds_read_b64_tr_b16 a[168:169], v7 offset:8480
ds_read_b64_tr_b16 a[170:171], v7 offset:8992
v_mfma_f32_16x16x32_bf16 v[136:139], a[176:179], a[96:99], v[136:139]
v_mfma_f32_16x16x32_bf16 v[104:107], a[176:179], a[88:91], v[104:107]
v_mfma_f32_16x16x32_bf16 v[104:107], a[180:183], a[92:95], v[104:107]
s_add_u32 m0, s67, 2112
s_add_u32 s90, s66, 0x20000
v_mfma_f32_16x16x32_bf16 v[108:111], a[188:191], a[92:95], v[108:111]
buffer_load_dwordx4 v4, s[36:39], s90 offen lds
v_mfma_f32_16x16x32_bf16 v[108:111], a[184:187], a[88:91], v[108:111]
v_mfma_f32_16x16x32_bf16 v[80:83], a[184:187], a[80:83], v[80:83]
ds_read_b64_tr_b16 a[172:173], v7 offset:25376
ds_read_b64_tr_b16 a[174:175], v7 offset:25888
v_mfma_f32_16x16x32_bf16 v[80:83], a[188:191], a[84:87], v[80:83]
v_mfma_f32_16x16x32_bf16 v[76:79], a[180:183], a[84:87], v[76:79]
v_mfma_f32_16x16x32_bf16 v[76:79], a[176:179], a[80:83], v[76:79]
v_mfma_f32_16x16x32_bf16 v[48:51], a[176:179], a[72:75], v[48:51]
v_mfma_f32_16x16x32_bf16 v[48:51], a[180:183], a[76:79], v[48:51]
v_xor_b32 v5, 0x8000, v5
v_xor_b32 v6, 0x8000, v6
v_mfma_f32_16x16x32_bf16 v[52:55], a[188:191], a[76:79], v[52:55]
s_add_u32 m0, s67, 3168
s_add_u32 s90, s66, 0x30000
v_mfma_f32_16x16x32_bf16 v[52:55], a[184:187], a[72:75], v[52:55]
buffer_load_dwordx4 v4, s[36:39], s90 offen lds
v_mfma_f32_16x16x32_bf16 v[24:27], a[184:187], a[64:67], v[24:27]
v_mfma_f32_16x16x32_bf16 v[24:27], a[188:191], a[68:71], v[24:27]
v_mfma_f32_16x16x32_bf16 v[20:23], a[180:183], a[68:71], v[20:23]
v_mfma_f32_16x16x32_bf16 v[20:23], a[176:179], a[64:67], v[20:23]
s_waitcnt lgkmcnt(0)
v_mfma_f32_16x16x32_bf16 v[28:31], a[64:67], a[160:163], v[28:31]
s_add_u32 m0, s65, 0
v_mfma_f32_16x16x32_bf16 v[28:31], a[68:71], a[164:167], v[28:31]
buffer_load_dwordx4 v2, s[32:35], s64 offen lds
v_mfma_f32_16x16x32_bf16 v[32:35], a[68:71], a[172:175], v[32:35]
ds_read_b64_tr_b16 a[176:177], v7 offset:8704
ds_read_b64_tr_b16 a[178:179], v7 offset:9216
v_mfma_f32_16x16x32_bf16 v[32:35], a[64:67], a[168:171], v[32:35]
v_mfma_f32_16x16x32_bf16 v[60:63], a[72:75], a[168:171], v[60:63]
v_mfma_f32_16x16x32_bf16 v[60:63], a[76:79], a[172:175], v[60:63]
v_mfma_f32_16x16x32_bf16 v[56:59], a[76:79], a[164:167], v[56:59]
v_mfma_f32_16x16x32_bf16 v[56:59], a[72:75], a[160:163], v[56:59]
v_mfma_f32_16x16x32_bf16 v[84:87], a[80:83], a[160:163], v[84:87]
ds_read_b64_tr_b16 a[180:181], v7 offset:25600
ds_read_b64_tr_b16 a[182:183], v7 offset:26112
v_mfma_f32_16x16x32_bf16 v[84:87], a[84:87], a[164:167], v[84:87]
s_add_u32 m0, s65, 1024
s_add_u32 s64, s64, 0x2000
v_mfma_f32_16x16x32_bf16 v[88:91], a[84:87], a[172:175], v[88:91]
buffer_load_dwordx4 v3, s[32:35], s64 offen lds
v_mfma_f32_16x16x32_bf16 v[88:91], a[80:83], a[168:171], v[88:91]
v_mfma_f32_16x16x32_bf16 v[116:119], a[88:91], a[168:171], v[116:119]
v_mfma_f32_16x16x32_bf16 v[116:119], a[92:95], a[172:175], v[116:119]
v_mfma_f32_16x16x32_bf16 v[112:115], a[92:95], a[164:167], v[112:115]
ds_read_b64_tr_b16 a[184:185], v7 offset:8736
ds_read_b64_tr_b16 a[186:187], v7 offset:9248
v_mfma_f32_16x16x32_bf16 v[112:115], a[88:91], a[160:163], v[112:115]
v_mfma_f32_16x16x32_bf16 v[144:147], a[96:99], a[160:163], v[144:147]
v_mfma_f32_16x16x32_bf16 v[144:147], a[100:103], a[164:167], v[144:147]
s_add_u32 m0, s65, 2048
s_add_u32 s64, s64, 0x2000
v_mfma_f32_16x16x32_bf16 v[148:151], a[100:103], a[172:175], v[148:151]
buffer_load_dwordx4 v2, s[32:35], s64 offen lds
v_mfma_f32_16x16x32_bf16 v[148:151], a[96:99], a[168:171], v[148:151]
v_mfma_f32_16x16x32_bf16 v[180:183], a[104:107], a[168:171], v[180:183]
ds_read_b64_tr_b16 a[188:189], v7 offset:25632
ds_read_b64_tr_b16 a[190:191], v7 offset:26144
v_mfma_f32_16x16x32_bf16 v[180:183], a[108:111], a[172:175], v[180:183]
v_mfma_f32_16x16x32_bf16 v[176:179], a[108:111], a[164:167], v[176:179]
v_mfma_f32_16x16x32_bf16 v[176:179], a[104:107], a[160:163], v[176:179]
v_mfma_f32_16x16x32_bf16 v[208:211], a[112:115], a[160:163], v[208:211]
v_mfma_f32_16x16x32_bf16 v[208:211], a[116:119], a[164:167], v[208:211]
v_add_u32 v7, s68, v7
v_mfma_f32_16x16x32_bf16 v[212:215], a[116:119], a[172:175], v[212:215]
s_add_u32 m0, s65, 3072
s_add_u32 s64, s64, 0x2000
v_mfma_f32_16x16x32_bf16 v[212:215], a[112:115], a[168:171], v[212:215]
buffer_load_dwordx4 v3, s[32:35], s64 offen lds
v_mfma_f32_16x16x32_bf16 v[244:247], a[120:123], a[168:171], v[244:247]
v_mfma_f32_16x16x32_bf16 v[244:247], a[124:127], a[172:175], v[244:247]
v_mfma_f32_16x16x32_bf16 v[240:243], a[124:127], a[164:167], v[240:243]
v_mfma_f32_16x16x32_bf16 v[240:243], a[120:123], a[160:163], v[240:243]
s_waitcnt vmcnt(13) lgkmcnt(0)
s_barrier
v_mfma_f32_16x16x32_bf16 v[36:39], a[64:67], a[176:179], v[36:39]
s_add_u32 m0, s65, 4096
s_add_u32 s64, s64, 0x2000
v_mfma_f32_16x16x32_bf16 v[36:39], a[68:71], a[180:183], v[36:39]
ds_read_b64_tr_b16 a[160:161], v7 offset:0
ds_read_b64_tr_b16 a[162:163], v7 offset:512
v_mfma_f32_16x16x32_bf16 v[40:43], a[68:71], a[188:191], v[40:43]
buffer_load_dwordx4 v2, s[32:35], s64 offen lds
v_mfma_f32_16x16x32_bf16 v[40:43], a[64:67], a[184:187], v[40:43]
ds_read_b128 a[64:67], v5 offset:0
ds_read_b128 a[68:71], v6 offset:0
v_mfma_f32_16x16x32_bf16 v[68:71], a[72:75], a[184:187], v[68:71]
v_mfma_f32_16x16x32_bf16 v[68:71], a[76:79], a[188:191], v[68:71]
ds_read_b64_tr_b16 a[164:165], v7 offset:16896
ds_read_b64_tr_b16 a[166:167], v7 offset:17408
v_mfma_f32_16x16x32_bf16 v[64:67], a[76:79], a[180:183], v[64:67]
v_mfma_f32_16x16x32_bf16 v[64:67], a[72:75], a[176:179], v[64:67]
ds_read_b128 a[72:75], v5 offset:2048
ds_read_b128 a[76:79], v6 offset:2048
v_mfma_f32_16x16x32_bf16 v[92:95], a[80:83], a[176:179], v[92:95]
s_add_u32 m0, s65, 5120
s_add_u32 s64, s64, 0x2000
v_mfma_f32_16x16x32_bf16 v[92:95], a[84:87], a[180:183], v[92:95]
ds_read_b64_tr_b16 a[168:169], v7 offset:32
ds_read_b64_tr_b16 a[170:171], v7 offset:544
v_mfma_f32_16x16x32_bf16 v[96:99], a[84:87], a[188:191], v[96:99]
buffer_load_dwordx4 v3, s[32:35], s64 offen lds
v_mfma_f32_16x16x32_bf16 v[96:99], a[80:83], a[184:187], v[96:99]
ds_read_b128 a[80:83], v5 offset:4096
ds_read_b128 a[84:87], v6 offset:4096
v_mfma_f32_16x16x32_bf16 v[124:127], a[88:91], a[184:187], v[124:127]
v_mfma_f32_16x16x32_bf16 v[124:127], a[92:95], a[188:191], v[124:127]
ds_read_b64_tr_b16 a[172:173], v7 offset:16928
ds_read_b64_tr_b16 a[174:175], v7 offset:17440
v_mfma_f32_16x16x32_bf16 v[120:123], a[92:95], a[180:183], v[120:123]
v_mfma_f32_16x16x32_bf16 v[120:123], a[88:91], a[176:179], v[120:123]
ds_read_b128 a[88:91], v5 offset:6144
ds_read_b128 a[92:95], v6 offset:6144
v_mfma_f32_16x16x32_bf16 v[152:155], a[96:99], a[176:179], v[152:155]
v_mfma_f32_16x16x32_bf16 v[152:155], a[100:103], a[180:183], v[152:155]
s_add_u32 m0, s65, 6144
s_add_u32 s64, s64, 0x2000
v_mfma_f32_16x16x32_bf16 v[156:159], a[100:103], a[188:191], v[156:159]
buffer_load_dwordx4 v2, s[32:35], s64 offen lds
v_mfma_f32_16x16x32_bf16 v[156:159], a[96:99], a[184:187], v[156:159]
ds_read_b128 a[96:99], v5 offset:8192
ds_read_b128 a[100:103], v6 offset:8192
v_mfma_f32_16x16x32_bf16 v[188:191], a[104:107], a[184:187], v[188:191]
v_mfma_f32_16x16x32_bf16 v[188:191], a[108:111], a[188:191], v[188:191]
v_mfma_f32_16x16x32_bf16 v[184:187], a[108:111], a[180:183], v[184:187]
s_add_u32 s63, s63, 1
v_mfma_f32_16x16x32_bf16 v[184:187], a[104:107], a[176:179], v[184:187]
ds_read_b128 a[104:107], v5 offset:10240
ds_read_b128 a[108:111], v6 offset:10240
v_mfma_f32_16x16x32_bf16 v[216:219], a[112:115], a[176:179], v[216:219]
v_mfma_f32_16x16x32_bf16 v[216:219], a[116:119], a[180:183], v[216:219]
s_add_u32 m0, s65, 7168
s_add_u32 s64, s64, 0x2000
v_mfma_f32_16x16x32_bf16 v[220:223], a[116:119], a[188:191], v[220:223]
buffer_load_dwordx4 v3, s[32:35], s64 offen lds
v_mfma_f32_16x16x32_bf16 v[220:223], a[112:115], a[184:187], v[220:223]
ds_read_b128 a[112:115], v5 offset:12288
ds_read_b128 a[116:119], v6 offset:12288
v_mfma_f32_16x16x32_bf16 v[252:255], a[120:123], a[184:187], v[252:255]
s_sub_u32 s64, s64, 57216
s_xor_b32 s65, s65, 0x8000
s_sub_u32 s68, 0, s68
v_mfma_f32_16x16x32_bf16 v[252:255], a[124:127], a[188:191], v[252:255]
s_cmp_eq_u32 s63, s71
s_cbranch_scc1 Lp1evt
Lp1ret:
v_mfma_f32_16x16x32_bf16 v[248:251], a[124:127], a[180:183], v[248:251]
s_cmp_lt_u32 s63, 7
v_mfma_f32_16x16x32_bf16 v[248:251], a[120:123], a[176:179], v[248:251]
ds_read_b128 a[120:123], v5 offset:14336
ds_read_b128 a[124:127], v6 offset:14336
s_waitcnt lgkmcnt(6)
s_cbranch_scc1 Lp1
v_mov_b32 v4, v8
s_mul_i32 s67, s30, 4224
s_lshl_b32 s70, s80, 3
s_sub_u32 s79, s79, s70
v_mfma_f32_16x16x32_bf16 v[16:19], a[160:163], a[64:67], v[16:19]
s_waitcnt vmcnt(8)
s_barrier
v_mfma_f32_16x16x32_bf16 v[16:19], a[164:167], a[68:71], v[16:19]
s_add_u32 m0, s67, 67584
s_add_u32 s79, s79, s70
v_mfma_f32_16x16x32_bf16 a[240:243], a[172:175], a[68:71], a[240:243]
s_add_u32 s44, s28, 0x400000
s_addc_u32 s45, s29, 0
s_mov_b32 s46, 0x5340000
v_mfma_f32_16x16x32_bf16 a[240:243], a[168:171], a[64:67], a[240:243]
buffer_load_dwordx4 v4, s[96:99], s79 offen lds
v_mfma_f32_16x16x32_bf16 a[244:247], a[168:171], a[72:75], a[244:247]
s_add_u32 m0, s67, 68640
s_add_u32 s79, s79, s70
v_mfma_f32_16x16x32_bf16 a[244:247], a[172:175], a[76:79], a[244:247]
s_mov_b32 s47, 0x20000
s_and_b32 s53, s30, 1
s_mul_i32 s54, s53, 4224
v_mfma_f32_16x16x32_bf16 v[44:47], a[164:167], a[76:79], v[44:47]
buffer_load_dwordx4 v4, s[96:99], s79 offen lds
v_mfma_f32_16x16x32_bf16 v[44:47], a[160:163], a[72:75], v[44:47]
v_mfma_f32_16x16x32_bf16 v[72:75], a[160:163], a[80:83], v[72:75]
s_add_u32 s54, s54, 33792
v_mfma_f32_16x16x32_bf16 v[72:75], a[164:167], a[84:87], v[72:75]
s_waitcnt lgkmcnt(0)
s_add_u32 m0, s67, 69696
s_add_u32 s79, s79, s70
v_mfma_f32_16x16x32_bf16 a[248:251], a[172:175], a[84:87], a[248:251]
v_and_b32 v5, 7, v0
v_lshl_add_u32 v5, s31, 3, v5
v_lshlrev_b32 v5, 2, v5
v_accvgpr_read_b32 v13, a200
v_mfma_f32_16x16x32_bf16 a[248:251], a[168:171], a[80:83], a[248:251]
ds_read_b64_tr_b16 a[176:177], v7 offset:256
ds_read_b64_tr_b16 a[178:179], v7 offset:768
v_mfma_f32_16x16x32_bf16 a[252:255], a[168:171], a[88:91], a[252:255]
buffer_load_dwordx4 v4, s[96:99], s79 offen lds
v_mfma_f32_16x16x32_bf16 a[252:255], a[172:175], a[92:95], a[252:255]
s_add_u32 m0, s67, 70752
s_add_u32 s79, s79, s70
v_mfma_f32_16x16x32_bf16 v[100:103], a[164:167], a[92:95], v[100:103]
buffer_load_dwordx4 v4, s[96:99], s79 offen lds
v_mfma_f32_16x16x32_bf16 v[100:103], a[160:163], a[88:91], v[100:103]
ds_read_b64_tr_b16 a[180:181], v7 offset:17152
ds_read_b64_tr_b16 a[182:183], v7 offset:17664
v_mfma_f32_16x16x32_bf16 v[128:131], a[160:163], a[96:99], v[128:131]
s_add_u32 m0, s67, 84480
s_add_u32 s79, s79, s70
v_mfma_f32_16x16x32_bf16 v[128:131], a[164:167], a[100:103], v[128:131]
buffer_load_dwordx4 v4, s[96:99], s79 offen lds
v_mfma_f32_16x16x32_bf16 v[132:135], a[172:175], a[100:103], v[132:135]
s_add_u32 m0, s67, 85536
v_accvgpr_read_b32 v8, a240
v_accvgpr_read_b32 v9, a241
v_mfma_f32_16x16x32_bf16 v[132:135], a[168:171], a[96:99], v[132:135]
ds_read_b64_tr_b16 a[184:185], v7 offset:288
ds_read_b64_tr_b16 a[186:187], v7 offset:800
v_mfma_f32_16x16x32_bf16 v[164:167], a[168:171], a[104:107], v[164:167]
s_add_u32 s79, s79, s70
v_accvgpr_read_b32 v10, a242
v_accvgpr_read_b32 v11, a243
v_mfma_f32_16x16x32_bf16 v[164:167], a[172:175], a[108:111], v[164:167]
buffer_load_dwordx4 v4, s[96:99], s79 offen lds
v_mfma_f32_16x16x32_bf16 v[160:163], a[164:167], a[108:111], v[160:163]
s_add_u32 m0, s67, 86592
v_cvt_pk_bf16_f32 v16, v16, v17
v_cvt_pk_bf16_f32 v17, v18, v19
v_mfma_f32_16x16x32_bf16 v[160:163], a[160:163], a[104:107], v[160:163]
ds_read_b64_tr_b16 a[188:189], v7 offset:17184
ds_read_b64_tr_b16 a[190:191], v7 offset:17696
v_mfma_f32_16x16x32_bf16 v[192:195], a[160:163], a[112:115], v[192:195]
s_add_u32 s79, s79, s70
v_cvt_pk_bf16_f32 v18, v8, v9
v_cvt_pk_bf16_f32 v19, v10, v11
v_mfma_f32_16x16x32_bf16 v[192:195], a[164:167], a[116:119], v[192:195]
buffer_load_dwordx4 v4, s[96:99], s79 offen lds
v_mfma_f32_16x16x32_bf16 v[196:199], a[172:175], a[116:119], v[196:199]
v_accvgpr_read_b32 v8, a244
v_accvgpr_read_b32 v9, a245
v_mfma_f32_16x16x32_bf16 v[196:199], a[168:171], a[112:115], v[196:199]
s_add_u32 m0, s67, 87648
v_accvgpr_read_b32 v10, a246
v_accvgpr_read_b32 v11, a247
v_mfma_f32_16x16x32_bf16 v[228:231], a[168:171], a[120:123], v[228:231]
s_add_u32 s79, s79, s70
v_cvt_pk_bf16_f32 v44, v44, v45
v_cvt_pk_bf16_f32 v45, v46, v47
v_mfma_f32_16x16x32_bf16 v[228:231], a[172:175], a[124:127], v[228:231]
buffer_load_dwordx4 v4, s[96:99], s79 offen lds
v_mfma_f32_16x16x32_bf16 v[224:227], a[164:167], a[124:127], v[224:227]
v_cmp_gt_u32 vcc, 1, v12
s_mov_b32 s55, 0x200000
s_nop 0
s_cbranch_vccnz Lh1_ld
Lh1_ok:
v_mfma_f32_16x16x32_bf16 v[224:227], a[160:163], a[120:123], v[224:227]
s_waitcnt lgkmcnt(0)
v_cvt_pk_bf16_f32 v46, v8, v9
v_cvt_pk_bf16_f32 v47, v10, v11
v_mfma_f32_16x16x32_bf16 v[232:235], a[176:179], a[120:123], v[232:235]
v_accvgpr_read_b32 v8, a248
v_accvgpr_read_b32 v9, a249
v_mfma_f32_16x16x32_bf16 v[232:235], a[180:183], a[124:127], v[232:235]
v_add_u32 v3, 0, v1
v_mfma_f32_16x16x32_bf16 v[236:239], a[188:191], a[124:127], v[236:239]
ds_read_b64_tr_b16 a[160:161], v7 offset:8448
ds_read_b64_tr_b16 a[162:163], v7 offset:8960
v_mfma_f32_16x16x32_bf16 v[236:239], a[184:187], a[120:123], v[236:239]
buffer_load_dwordx4 a[128:131], v3, s[40:43], s72 offen offset:0 sc1
v_mfma_f32_16x16x32_bf16 v[204:207], a[184:187], a[112:115], v[204:207]
v_accvgpr_read_b32 v10, a250
v_accvgpr_read_b32 v11, a251
v_mfma_f32_16x16x32_bf16 v[204:207], a[188:191], a[116:119], v[204:207]
v_cvt_pk_bf16_f32 v72, v72, v73
v_cvt_pk_bf16_f32 v73, v74, v75
v_mfma_f32_16x16x32_bf16 v[200:203], a[180:183], a[116:119], v[200:203]
buffer_load_dwordx4 a[144:147], v3, s[40:43], s72 offen offset:1024 sc1
v_mfma_f32_16x16x32_bf16 v[200:203], a[176:179], a[112:115], v[200:203]
v_cvt_pk_bf16_f32 v74, v8, v9
v_cvt_pk_bf16_f32 v75, v10, v11
v_mfma_f32_16x16x32_bf16 v[168:171], a[176:179], a[104:107], v[168:171]
ds_read_b64_tr_b16 a[164:165], v7 offset:25344
ds_read_b64_tr_b16 a[166:167], v7 offset:25856
v_mfma_f32_16x16x32_bf16 v[168:171], a[180:183], a[108:111], v[168:171]
v_accvgpr_read_b32 v8, a252
v_accvgpr_read_b32 v9, a253
v_mfma_f32_16x16x32_bf16 v[172:175], a[188:191], a[108:111], v[172:175]
buffer_load_dwordx4 a[132:135], v3, s[40:43], s73 offen offset:0 sc1
v_mfma_f32_16x16x32_bf16 v[172:175], a[184:187], a[104:107], v[172:175]
v_accvgpr_read_b32 v10, a254
v_accvgpr_read_b32 v11, a255
v_mfma_f32_16x16x32_bf16 v[140:143], a[184:187], a[96:99], v[140:143]
v_cvt_pk_bf16_f32 v100, v100, v101
v_cvt_pk_bf16_f32 v101, v102, v103
v_mfma_f32_16x16x32_bf16 v[140:143], a[188:191], a[100:103], v[140:143]
v_cvt_pk_bf16_f32 v102, v8, v9
v_cvt_pk_bf16_f32 v103, v10, v11
v_mfma_f32_16x16x32_bf16 v[136:139], a[180:183], a[100:103], v[136:139]
ds_read_b64_tr_b16 a[168:169], v7 offset:8480
ds_read_b64_tr_b16 a[170:171], v7 offset:8992
v_mfma_f32_16x16x32_bf16 v[136:139], a[176:179], a[96:99], v[136:139]
buffer_load_dwordx4 a[148:151], v3, s[40:43], s73 offen offset:1024 sc1
v_mfma_f32_16x16x32_bf16 v[104:107], a[176:179], a[88:91], v[104:107]
v_cvt_pk_bf16_f32 v128, v128, v129
v_cvt_pk_bf16_f32 v129, v130, v131
v_mfma_f32_16x16x32_bf16 v[104:107], a[180:183], a[92:95], v[104:107]
v_cvt_pk_bf16_f32 v130, v132, v133
v_cvt_pk_bf16_f32 v131, v134, v135
v_mfma_f32_16x16x32_bf16 v[108:111], a[188:191], a[92:95], v[108:111]
buffer_load_dwordx4 a[136:139], v3, s[40:43], s74 offen offset:0 sc1
v_mfma_f32_16x16x32_bf16 v[108:111], a[184:187], a[88:91], v[108:111]
v_accvgpr_write_b32 a0, v128
v_accvgpr_write_b32 a1, v129
v_mfma_f32_16x16x32_bf16 v[80:83], a[184:187], a[80:83], v[80:83]
ds_read_b64_tr_b16 a[172:173], v7 offset:25376
ds_read_b64_tr_b16 a[174:175], v7 offset:25888
v_mfma_f32_16x16x32_bf16 v[80:83], a[188:191], a[84:87], v[80:83]
v_accvgpr_write_b32 a2, v130
v_accvgpr_write_b32 a3, v131
v_mfma_f32_16x16x32_bf16 v[76:79], a[180:183], a[84:87], v[76:79]
buffer_load_dwordx4 a[152:155], v3, s[40:43], s74 offen offset:1024 sc1
v_mfma_f32_16x16x32_bf16 v[76:79], a[176:179], a[80:83], v[76:79]
v_cvt_pk_bf16_f32 v160, v160, v161
v_cvt_pk_bf16_f32 v161, v162, v163
v_mfma_f32_16x16x32_bf16 v[48:51], a[176:179], a[72:75], v[48:51]
v_cvt_pk_bf16_f32 v162, v164, v165
v_cvt_pk_bf16_f32 v163, v166, v167
v_mfma_f32_16x16x32_bf16 v[48:51], a[180:183], a[76:79], v[48:51]
v_accvgpr_write_b32 a4, v160
v_accvgpr_write_b32 a5, v161
v_mfma_f32_16x16x32_bf16 v[52:55], a[188:191], a[76:79], v[52:55]
buffer_load_dwordx4 a[140:143], v3, s[40:43], s75 offen offset:0 sc1
v_mfma_f32_16x16x32_bf16 v[52:55], a[184:187], a[72:75], v[52:55]
v_accvgpr_write_b32 a6, v162
v_accvgpr_write_b32 a7, v163
v_mfma_f32_16x16x32_bf16 v[24:27], a[184:187], a[64:67], v[24:27]
v_cvt_pk_bf16_f32 v192, v192, v193
v_cvt_pk_bf16_f32 v193, v194, v195
v_mfma_f32_16x16x32_bf16 v[24:27], a[188:191], a[68:71], v[24:27]
v_cvt_pk_bf16_f32 v194, v196, v197
v_cvt_pk_bf16_f32 v195, v198, v199
v_mfma_f32_16x16x32_bf16 v[20:23], a[180:183], a[68:71], v[20:23]
buffer_load_dwordx4 a[156:159], v3, s[40:43], s75 offen offset:1024 sc1
v_mfma_f32_16x16x32_bf16 v[20:23], a[176:179], a[64:67], v[20:23]
s_waitcnt lgkmcnt(0)
v_accvgpr_write_b32 a8, v192
v_accvgpr_write_b32 a9, v193
v_mfma_f32_16x16x32_bf16 v[28:31], a[64:67], a[160:163], v[28:31]
v_accvgpr_write_b32 a10, v194
v_accvgpr_write_b32 a11, v195
v_mfma_f32_16x16x32_bf16 v[28:31], a[68:71], a[164:167], v[28:31]
s_add_u32 s10, s76, 0
v_cvt_pk_bf16_f32 v224, v224, v225
v_cvt_pk_bf16_f32 v225, v226, v227
v_mfma_f32_16x16x32_bf16 v[32:35], a[68:71], a[172:175], v[32:35]
ds_read_b64_tr_b16 a[176:177], v7 offset:8704
ds_read_b64_tr_b16 a[178:179], v7 offset:9216
v_mfma_f32_16x16x32_bf16 v[32:35], a[64:67], a[168:171], v[32:35]
buffer_store_dwordx4 v[16:19], v1, s[44:47], s10 offen sc1
v_mfma_f32_16x16x32_bf16 v[60:63], a[72:75], a[168:171], v[60:63]
v_cvt_pk_bf16_f32 v226, v228, v229
v_cvt_pk_bf16_f32 v227, v230, v231
v_mfma_f32_16x16x32_bf16 v[60:63], a[76:79], a[172:175], v[60:63]
v_accvgpr_write_b32 a12, v224
v_accvgpr_write_b32 a13, v225
v_mfma_f32_16x16x32_bf16 v[56:59], a[76:79], a[164:167], v[56:59]
v_accvgpr_write_b32 a14, v226
v_accvgpr_write_b32 a15, v227
v_mfma_f32_16x16x32_bf16 v[56:59], a[72:75], a[160:163], v[56:59]
v_cvt_pk_bf16_f32 v232, v232, v233
v_cvt_pk_bf16_f32 v233, v234, v235
v_mfma_f32_16x16x32_bf16 v[84:87], a[80:83], a[160:163], v[84:87]
ds_read_b64_tr_b16 a[180:181], v7 offset:25600
ds_read_b64_tr_b16 a[182:183], v7 offset:26112
v_mfma_f32_16x16x32_bf16 v[84:87], a[84:87], a[164:167], v[84:87]
v_cvt_pk_bf16_f32 v234, v236, v237
v_cvt_pk_bf16_f32 v235, v238, v239
v_mfma_f32_16x16x32_bf16 v[88:91], a[84:87], a[172:175], v[88:91]
s_add_u32 s10, s76, 4096
v_accvgpr_write_b32 a16, v232
v_accvgpr_write_b32 a17, v233
v_mfma_f32_16x16x32_bf16 v[88:91], a[80:83], a[168:171], v[88:91]
buffer_store_dwordx4 v[44:47], v1, s[44:47], s10 offen sc1
v_mfma_f32_16x16x32_bf16 v[116:119], a[88:91], a[168:171], v[116:119]
v_accvgpr_write_b32 a18, v234
v_accvgpr_write_b32 a19, v235
v_mfma_f32_16x16x32_bf16 v[116:119], a[92:95], a[172:175], v[116:119]
v_cvt_pk_bf16_f32 v200, v200, v201
v_cvt_pk_bf16_f32 v201, v202, v203
v_mfma_f32_16x16x32_bf16 v[112:115], a[92:95], a[164:167], v[112:115]
ds_read_b64_tr_b16 a[184:185], v7 offset:8736
ds_read_b64_tr_b16 a[186:187], v7 offset:9248
v_mfma_f32_16x16x32_bf16 v[112:115], a[88:91], a[160:163], v[112:115]
v_cvt_pk_bf16_f32 v202, v204, v205
v_cvt_pk_bf16_f32 v203, v206, v207
v_mfma_f32_16x16x32_bf16 v[144:147], a[96:99], a[160:163], v[144:147]
v_accvgpr_write_b32 a20, v200
v_accvgpr_write_b32 a21, v201
v_mfma_f32_16x16x32_bf16 v[144:147], a[100:103], a[164:167], v[144:147]
v_accvgpr_write_b32 a22, v202
v_accvgpr_write_b32 a23, v203
v_mfma_f32_16x16x32_bf16 v[148:151], a[100:103], a[172:175], v[148:151]
s_add_u32 s10, s76, 8192
v_cvt_pk_bf16_f32 v168, v168, v169
v_cvt_pk_bf16_f32 v169, v170, v171
v_mfma_f32_16x16x32_bf16 v[148:151], a[96:99], a[168:171], v[148:151]
buffer_store_dwordx4 v[72:75], v1, s[44:47], s10 offen sc1
v_mfma_f32_16x16x32_bf16 v[180:183], a[104:107], a[168:171], v[180:183]
ds_read_b64_tr_b16 a[188:189], v7 offset:25632
ds_read_b64_tr_b16 a[190:191], v7 offset:26144
v_mfma_f32_16x16x32_bf16 v[180:183], a[108:111], a[172:175], v[180:183]
v_cvt_pk_bf16_f32 v170, v172, v173
v_cvt_pk_bf16_f32 v171, v174, v175
v_mfma_f32_16x16x32_bf16 v[176:179], a[108:111], a[164:167], v[176:179]
v_accvgpr_write_b32 a24, v168
v_accvgpr_write_b32 a25, v169
v_mfma_f32_16x16x32_bf16 v[176:179], a[104:107], a[160:163], v[176:179]
v_accvgpr_write_b32 a26, v170
v_accvgpr_write_b32 a27, v171
v_mfma_f32_16x16x32_bf16 v[208:211], a[112:115], a[160:163], v[208:211]
v_cvt_pk_bf16_f32 v136, v136, v137
v_cvt_pk_bf16_f32 v137, v138, v139
v_mfma_f32_16x16x32_bf16 v[208:211], a[116:119], a[164:167], v[208:211]
v_subrev_u32 v7, s54, v7
v_subrev_u32 v6, 67584, v7
v_mfma_f32_16x16x32_bf16 v[212:215], a[116:119], a[172:175], v[212:215]
v_cvt_pk_bf16_f32 v138, v140, v141
v_cvt_pk_bf16_f32 v139, v142, v143
v_mfma_f32_16x16x32_bf16 v[212:215], a[112:115], a[168:171], v[212:215]
s_add_u32 s10, s76, 12288
v_accvgpr_write_b32 a28, v136
v_accvgpr_write_b32 a29, v137
v_mfma_f32_16x16x32_bf16 v[244:247], a[120:123], a[168:171], v[244:247]
buffer_store_dwordx4 v[100:103], v1, s[44:47], s10 offen sc1
v_mfma_f32_16x16x32_bf16 v[244:247], a[124:127], a[172:175], v[244:247]
v_accvgpr_write_b32 a30, v138
v_accvgpr_write_b32 a31, v139
v_mfma_f32_16x16x32_bf16 v[240:243], a[124:127], a[164:167], v[240:243]
v_cvt_pk_bf16_f32 v104, v104, v105
v_cvt_pk_bf16_f32 v105, v106, v107
v_mfma_f32_16x16x32_bf16 v[240:243], a[120:123], a[160:163], v[240:243]
s_waitcnt vmcnt(12) lgkmcnt(0)
s_barrier
v_mfma_f32_16x16x32_bf16 v[36:39], a[64:67], a[176:179], v[36:39]
s_add_u32 m0, s67, 101376
s_add_u32 s79, s79, s70
v_mfma_f32_16x16x32_bf16 v[36:39], a[68:71], a[180:183], v[36:39]
buffer_load_dwordx4 v4, s[96:99], s79 offen lds
v_mfma_f32_16x16x32_bf16 v[40:43], a[68:71], a[188:191], v[40:43]
ds_read_b64_tr_b16 a[192:193], v7 offset:0
ds_read_b64_tr_b16 a[194:195], v7 offset:512
v_mfma_f32_16x16x32_bf16 v[40:43], a[64:67], a[184:187], v[40:43]
ds_read_b64_tr_b16 a[196:197], v7 offset:16896
ds_read_b64_tr_b16 a[198:199], v7 offset:17408
v_mfma_f32_16x16x32_bf16 v[68:71], a[72:75], a[184:187], v[68:71]
s_add_u32 m0, s67, 102432
v_mfma_f32_16x16x32_bf16 v[68:71], a[76:79], a[188:191], v[68:71]
s_add_u32 s79, s79, s70
v_mfma_f32_16x16x32_bf16 v[64:67], a[76:79], a[180:183], v[64:67]
ds_read_b64_tr_b16 a[200:201], v7 offset:32
ds_read_b64_tr_b16 a[202:203], v7 offset:544
v_mfma_f32_16x16x32_bf16 v[64:67], a[72:75], a[176:179], v[64:67]
ds_read_b64_tr_b16 a[204:205], v7 offset:16928
ds_read_b64_tr_b16 a[206:207], v7 offset:17440
v_mfma_f32_16x16x32_bf16 v[92:95], a[80:83], a[176:179], v[92:95]
buffer_load_dwordx4 v4, s[96:99], s79 offen lds
v_mfma_f32_16x16x32_bf16 v[92:95], a[84:87], a[180:183], v[92:95]
s_add_u32 m0, s67, 103488
v_mfma_f32_16x16x32_bf16 v[96:99], a[84:87], a[188:191], v[96:99]
ds_read_b64_tr_b16 a[208:209], v7 offset:256
ds_read_b64_tr_b16 a[210:211], v7 offset:768
v_mfma_f32_16x16x32_bf16 v[96:99], a[80:83], a[184:187], v[96:99]
s_add_u32 s79, s79, s70
v_cvt_pk_bf16_f32 v106, v108, v109
v_cvt_pk_bf16_f32 v107, v110, v111
v_mfma_f32_16x16x32_bf16 v[124:127], a[88:91], a[184:187], v[124:127]
buffer_load_dwordx4 v4, s[96:99], s79 offen lds
v_mfma_f32_16x16x32_bf16 v[124:127], a[92:95], a[188:191], v[124:127]
v_accvgpr_write_b32 a32, v104
v_accvgpr_write_b32 a33, v105
v_mfma_f32_16x16x32_bf16 v[120:123], a[92:95], a[180:183], v[120:123]
ds_read_b64_tr_b16 a[212:213], v7 offset:17152
ds_read_b64_tr_b16 a[214:215], v7 offset:17664
v_mfma_f32_16x16x32_bf16 v[120:123], a[88:91], a[176:179], v[120:123]
s_add_u32 m0, s67, 104544
v_accvgpr_write_b32 a34, v106
v_accvgpr_write_b32 a35, v107
v_mfma_f32_16x16x32_bf16 v[152:155], a[96:99], a[176:179], v[152:155]
s_add_u32 s79, s79, s70
v_cvt_pk_bf16_f32 v76, v76, v77
v_cvt_pk_bf16_f32 v77, v78, v79
v_mfma_f32_16x16x32_bf16 v[152:155], a[100:103], a[180:183], v[152:155]
buffer_load_dwordx4 v4, s[96:99], s79 offen lds
v_mfma_f32_16x16x32_bf16 v[156:159], a[100:103], a[188:191], v[156:159]
v_cvt_pk_bf16_f32 v78, v80, v81
v_cvt_pk_bf16_f32 v79, v82, v83
v_mfma_f32_16x16x32_bf16 v[156:159], a[96:99], a[184:187], v[156:159]
v_accvgpr_write_b32 a36, v76
v_accvgpr_write_b32 a37, v77
v_mfma_f32_16x16x32_bf16 v[188:191], a[104:107], a[184:187], v[188:191]
v_accvgpr_write_b32 a38, v78
v_accvgpr_write_b32 a39, v79
v_mfma_f32_16x16x32_bf16 v[188:191], a[108:111], a[188:191], v[188:191]
s_add_u32 m0, s67, 118272
v_cvt_pk_bf16_f32 v48, v48, v49
v_cvt_pk_bf16_f32 v49, v50, v51
v_mfma_f32_16x16x32_bf16 v[184:187], a[108:111], a[180:183], v[184:187]
s_add_u32 s79, s79, s70
v_cvt_pk_bf16_f32 v50, v52, v53
v_cvt_pk_bf16_f32 v51, v54, v55
v_mfma_f32_16x16x32_bf16 v[184:187], a[104:107], a[176:179], v[184:187]
buffer_load_dwordx4 v4, s[96:99], s79 offen lds
v_mfma_f32_16x16x32_bf16 v[216:219], a[112:115], a[176:179], v[216:219]
v_accvgpr_write_b32 a40, v48
v_accvgpr_write_b32 a41, v49
v_mfma_f32_16x16x32_bf16 v[216:219], a[116:119], a[180:183], v[216:219]
v_accvgpr_write_b32 a42, v50
v_accvgpr_write_b32 a43, v51
v_mfma_f32_16x16x32_bf16 v[220:223], a[116:119], a[188:191], v[220:223]
v_cvt_pk_bf16_f32 v20, v20, v21
v_cvt_pk_bf16_f32 v21, v22, v23
v_mfma_f32_16x16x32_bf16 v[220:223], a[112:115], a[184:187], v[220:223]
s_add_u32 m0, s67, 119328
v_cvt_pk_bf16_f32 v22, v24, v25
v_cvt_pk_bf16_f32 v23, v26, v27
v_mfma_f32_16x16x32_bf16 v[252:255], a[120:123], a[184:187], v[252:255]
s_add_u32 s79, s79, s70
v_accvgpr_write_b32 a44, v20
v_accvgpr_write_b32 a45, v21
v_mfma_f32_16x16x32_bf16 v[252:255], a[124:127], a[188:191], v[252:255]
buffer_load_dwordx4 v4, s[96:99], s79 offen lds
v_mfma_f32_16x16x32_bf16 v[248:251], a[124:127], a[180:183], v[248:251]
v_accvgpr_write_b32 a46, v22
v_accvgpr_write_b32 a47, v23
v_mfma_f32_16x16x32_bf16 v[248:251], a[120:123], a[176:179], v[248:251]
s_waitcnt vmcnt(10) lgkmcnt(8)
v_cvt_pk_bf16_f32 v32, v32, v33
v_cvt_pk_bf16_f32 v33, v34, v35
v_mfma_f32_16x16x32_bf16 a[240:243], a[192:195], a[128:131], 0
v_add_u32 v3, 2048, v1
v_mfma_f32_16x16x32_bf16 a[240:243], a[196:199], a[144:147], a[240:243]
ds_read_b64_tr_b16 a[216:217], v7 offset:288
ds_read_b64_tr_b16 a[218:219], v7 offset:800
v_mfma_f32_16x16x32_bf16 a[244:247], a[196:199], a[148:151], 0
buffer_load_dwordx4 a[160:163], v3, s[40:43], s72 offen offset:0 sc1
v_mfma_f32_16x16x32_bf16 a[244:247], a[192:195], a[132:135], a[244:247]
v_cvt_pk_bf16_f32 v34, v60, v61
v_cvt_pk_bf16_f32 v35, v62, v63
v_mfma_f32_16x16x32_bf16 a[248:251], a[192:195], a[136:139], 0
v_accvgpr_write_b32 a48, v32
v_accvgpr_write_b32 a49, v33
v_mfma_f32_16x16x32_bf16 a[248:251], a[196:199], a[152:155], a[248:251]
ds_read_b64_tr_b16 a[220:221], v7 offset:17184
ds_read_b64_tr_b16 a[222:223], v7 offset:17696
v_mfma_f32_16x16x32_bf16 a[252:255], a[196:199], a[156:159], 0
buffer_load_dwordx4 a[176:179], v3, s[40:43], s72 offen offset:1024 sc1
v_mfma_f32_16x16x32_bf16 a[252:255], a[192:195], a[140:143], a[252:255]
s_waitcnt lgkmcnt(8)
v_accvgpr_write_b32 a50, v34
v_accvgpr_write_b32 a51, v35
v_mfma_f32_16x16x32_bf16 v[132:135], a[200:203], a[140:143], 0
v_cvt_pk_bf16_f32 v28, v28, v29
v_cvt_pk_bf16_f32 v29, v30, v31
v_mfma_f32_16x16x32_bf16 v[132:135], a[204:207], a[156:159], v[132:135]
ds_read_b64_tr_b16 a[192:193], v7 offset:4224
ds_read_b64_tr_b16 a[194:195], v7 offset:4736
v_mfma_f32_16x16x32_bf16 v[128:131], a[204:207], a[152:155], 0
buffer_load_dwordx4 a[164:167], v3, s[40:43], s73 offen offset:0 sc1
v_mfma_f32_16x16x32_bf16 v[128:131], a[200:203], a[136:139], v[128:131]
v_cvt_pk_bf16_f32 v30, v56, v57
v_cvt_pk_bf16_f32 v31, v58, v59
v_mfma_f32_16x16x32_bf16 v[164:167], a[200:203], a[132:135], 0
v_accvgpr_write_b32 a52, v28
v_accvgpr_write_b32 a53, v29
v_mfma_f32_16x16x32_bf16 v[164:167], a[204:207], a[148:151], v[164:167]
ds_read_b64_tr_b16 a[196:197], v7 offset:21120
ds_read_b64_tr_b16 a[198:199], v7 offset:21632
v_mfma_f32_16x16x32_bf16 v[160:163], a[204:207], a[144:147], 0
buffer_load_dwordx4 a[180:183], v3, s[40:43], s73 offen offset:1024 sc1
v_mfma_f32_16x16x32_bf16 v[160:163], a[200:203], a[128:131], v[160:163]
s_waitcnt lgkmcnt(8)
v_accvgpr_write_b32 a54, v30
v_accvgpr_write_b32 a55, v31
v_mfma_f32_16x16x32_bf16 v[196:199], a[208:211], a[128:131], 0
v_cvt_pk_bf16_f32 v88, v88, v89
v_cvt_pk_bf16_f32 v89, v90, v91
v_mfma_f32_16x16x32_bf16 v[196:199], a[212:215], a[144:147], v[196:199]
ds_read_b64_tr_b16 a[200:201], v7 offset:4256
ds_read_b64_tr_b16 a[202:203], v7 offset:4768
v_mfma_f32_16x16x32_bf16 v[192:195], a[212:215], a[148:151], 0
buffer_load_dwordx4 a[168:171], v3, s[40:43], s74 offen offset:0 sc1
v_mfma_f32_16x16x32_bf16 v[192:195], a[208:211], a[132:135], v[192:195]
v_cvt_pk_bf16_f32 v90, v116, v117
v_cvt_pk_bf16_f32 v91, v118, v119
v_mfma_f32_16x16x32_bf16 v[16:19], a[208:211], a[136:139], 0
v_accvgpr_write_b32 a56, v88
v_accvgpr_write_b32 a57, v89
v_mfma_f32_16x16x32_bf16 v[16:19], a[212:215], a[152:155], v[16:19]
ds_read_b64_tr_b16 a[204:205], v7 offset:21152
ds_read_b64_tr_b16 a[206:207], v7 offset:21664
v_mfma_f32_16x16x32_bf16 v[228:231], a[212:215], a[156:159], 0
buffer_load_dwordx4 a[184:187], v3, s[40:43], s74 offen offset:1024 sc1
v_mfma_f32_16x16x32_bf16 v[228:231], a[208:211], a[140:143], v[228:231]
s_waitcnt lgkmcnt(8)
v_accvgpr_write_b32 a58, v90
v_accvgpr_write_b32 a59, v91
v_mfma_f32_16x16x32_bf16 v[224:227], a[216:219], a[140:143], 0
v_cvt_pk_bf16_f32 v84, v84, v85
v_cvt_pk_bf16_f32 v85, v86, v87
v_mfma_f32_16x16x32_bf16 v[224:227], a[220:223], a[156:159], v[224:227]
ds_read_b64_tr_b16 a[208:209], v7 offset:4480
ds_read_b64_tr_b16 a[210:211], v7 offset:4992
v_mfma_f32_16x16x32_bf16 v[236:239], a[220:223], a[152:155], 0
buffer_load_dwordx4 a[172:175], v3, s[40:43], s75 offen offset:0 sc1
v_mfma_f32_16x16x32_bf16 v[236:239], a[216:219], a[136:139], v[236:239]
v_cvt_pk_bf16_f32 v86, v112, v113
v_cvt_pk_bf16_f32 v87, v114, v115
v_mfma_f32_16x16x32_bf16 v[44:47], a[216:219], a[132:135], 0
v_accvgpr_write_b32 a60, v84
v_accvgpr_write_b32 a61, v85
v_mfma_f32_16x16x32_bf16 v[44:47], a[220:223], a[148:151], v[44:47]
ds_read_b64_tr_b16 a[212:213], v7 offset:21376
ds_read_b64_tr_b16 a[214:215], v7 offset:21888
v_mfma_f32_16x16x32_bf16 v[232:235], a[220:223], a[144:147], 0
buffer_load_dwordx4 a[188:191], v3, s[40:43], s75 offen offset:1024 sc1
v_mfma_f32_16x16x32_bf16 v[232:235], a[216:219], a[128:131], v[232:235]
s_waitcnt lgkmcnt(8)
v_accvgpr_write_b32 a62, v86
v_accvgpr_write_b32 a63, v87
v_mfma_f32_16x16x32_bf16 v[204:207], a[192:195], a[128:131], 0
v_cvt_pk_bf16_f32 v148, v148, v149
v_cvt_pk_bf16_f32 v149, v150, v151
v_mfma_f32_16x16x32_bf16 v[204:207], a[196:199], a[144:147], v[204:207]
ds_read_b64_tr_b16 a[216:217], v7 offset:4512
ds_read_b64_tr_b16 a[218:219], v7 offset:5024
v_mfma_f32_16x16x32_bf16 v[200:203], a[196:199], a[148:151], 0
s_add_u32 m0, s67, 120384
s_add_u32 s79, s79, s70
v_mfma_f32_16x16x32_bf16 v[200:203], a[192:195], a[132:135], v[200:203]
buffer_load_dwordx4 v4, s[96:99], s79 offen lds
v_mfma_f32_16x16x32_bf16 v[72:75], a[192:195], a[136:139], 0
v_cvt_pk_bf16_f32 v150, v180, v181
v_cvt_pk_bf16_f32 v151, v182, v183
v_mfma_f32_16x16x32_bf16 v[72:75], a[196:199], a[152:155], v[72:75]
ds_read_b64_tr_b16 a[220:221], v7 offset:21408
ds_read_b64_tr_b16 a[222:223], v7 offset:21920
v_mfma_f32_16x16x32_bf16 v[172:175], a[196:199], a[156:159], 0
s_add_u32 m0, s67, 121440
v_cvt_pk_bf16_f32 v144, v144, v145
v_cvt_pk_bf16_f32 v145, v146, v147
v_mfma_f32_16x16x32_bf16 v[172:175], a[192:195], a[140:143], v[172:175]
s_waitcnt lgkmcnt(8)
Lpad1:
s_cbranch_execz Lpad5
v_cvt_pk_bf16_f32 v146, v176, v177
v_cvt_pk_bf16_f32 v147, v178, v179
v_mfma_f32_16x16x32_bf16 v[168:171], a[200:203], a[140:143], 0
s_add_u32 s79, s79, s70
v_cvt_pk_bf16_f32 v212, v212, v213
v_cvt_pk_bf16_f32 v213, v214, v215
v_mfma_f32_16x16x32_bf16 v[168:171], a[204:207], a[156:159], v[168:171]
ds_read_b64_tr_b16 a[192:193], v7 offset:8448
ds_read_b64_tr_b16 a[194:195], v7 offset:8960
v_mfma_f32_16x16x32_bf16 v[140:143], a[204:207], a[152:155], 0
buffer_load_dwordx4 v4, s[96:99], s79 offen lds
v_mfma_f32_16x16x32_bf16 v[140:143], a[200:203], a[136:139], v[140:143]
v_cvt_pk_bf16_f32 v214, v244, v245
v_cvt_pk_bf16_f32 v215, v246, v247
v_mfma_f32_16x16x32_bf16 v[100:103], a[200:203], a[132:135], 0
v_cvt_pk_bf16_f32 v208, v208, v209
v_cvt_pk_bf16_f32 v209, v210, v211
v_mfma_f32_16x16x32_bf16 v[100:103], a[204:207], a[148:151], v[100:103]
ds_read_b64_tr_b16 a[196:197], v7 offset:25344
ds_read_b64_tr_b16 a[198:199], v7 offset:25856
v_mfma_f32_16x16x32_bf16 v[136:139], a[204:207], a[144:147], 0
s_add_u32 s10, s77, 33792
v_cvt_pk_bf16_f32 v210, v240, v241
v_cvt_pk_bf16_f32 v211, v242, v243
v_mfma_f32_16x16x32_bf16 v[136:139], a[200:203], a[128:131], v[136:139]
s_waitcnt lgkmcnt(8)
v_cvt_pk_bf16_f32 v40, v40, v41
v_cvt_pk_bf16_f32 v41, v42, v43
v_mfma_f32_16x16x32_bf16 v[108:111], a[208:211], a[128:131], 0
buffer_store_dwordx4 v[148:151], v1, s[44:47], s10 offen sc1
v_mfma_f32_16x16x32_bf16 v[108:111], a[212:215], a[144:147], v[108:111]
ds_read_b64_tr_b16 a[200:201], v7 offset:8480
ds_read_b64_tr_b16 a[202:203], v7 offset:8992
v_mfma_f32_16x16x32_bf16 v[104:107], a[212:215], a[148:151], 0
v_cvt_pk_bf16_f32 v42, v68, v69
v_cvt_pk_bf16_f32 v43, v70, v71
v_mfma_f32_16x16x32_bf16 v[104:107], a[208:211], a[132:135], v[104:107]
v_cvt_pk_bf16_f32 v36, v36, v37
v_cvt_pk_bf16_f32 v37, v38, v39
v_mfma_f32_16x16x32_bf16 v[80:83], a[208:211], a[136:139], 0
s_add_u32 m0, s67, 0
v_cvt_pk_bf16_f32 v38, v64, v65
v_cvt_pk_bf16_f32 v39, v66, v67
v_mfma_f32_16x16x32_bf16 v[80:83], a[212:215], a[152:155], v[80:83]
ds_read_b64_tr_b16 a[204:205], v7 offset:25376
ds_read_b64_tr_b16 a[206:207], v7 offset:25888
v_mfma_f32_16x16x32_bf16 v[76:79], a[212:215], a[156:159], 0
s_add_u32 s79, s79, s70
v_cvt_pk_bf16_f32 v96, v96, v97
v_cvt_pk_bf16_f32 v97, v98, v99
v_mfma_f32_16x16x32_bf16 v[76:79], a[208:211], a[140:143], v[76:79]
s_waitcnt lgkmcnt(8)
v_cvt_pk_bf16_f32 v98, v124, v125
v_cvt_pk_bf16_f32 v99, v126, v127
v_mfma_f32_16x16x32_bf16 v[52:55], a[216:219], a[140:143], 0
buffer_load_dwordx4 v4, s[96:99], s79 offen lds
v_mfma_f32_16x16x32_bf16 v[52:55], a[220:223], a[156:159], v[52:55]
ds_read_b64_tr_b16 a[208:209], v7 offset:8704
ds_read_b64_tr_b16 a[210:211], v7 offset:9216
v_mfma_f32_16x16x32_bf16 v[48:51], a[220:223], a[152:155], 0
v_cvt_pk_bf16_f32 v92, v92, v93
v_cvt_pk_bf16_f32 v93, v94, v95
v_mfma_f32_16x16x32_bf16 v[48:51], a[216:219], a[136:139], v[48:51]
s_add_u32 m0, s67, 1056
v_cvt_pk_bf16_f32 v94, v120, v121
v_cvt_pk_bf16_f32 v95, v122, v123
v_mfma_f32_16x16x32_bf16 v[24:27], a[216:219], a[132:135], 0
s_add_u32 s79, s79, s70
v_cvt_pk_bf16_f32 v156, v156, v157
v_cvt_pk_bf16_f32 v157, v158, v159
v_mfma_f32_16x16x32_bf16 v[24:27], a[220:223], a[148:151], v[24:27]
ds_read_b64_tr_b16 a[212:213], v7 offset:25600
ds_read_b64_tr_b16 a[214:215], v7 offset:26112
v_mfma_f32_16x16x32_bf16 v[20:23], a[220:223], a[144:147], 0
buffer_load_dwordx4 v4, s[96:99], s79 offen lds
v_mfma_f32_16x16x32_bf16 v[20:23], a[216:219], a[128:131], v[20:23]
s_waitcnt lgkmcnt(8)
v_cvt_pk_bf16_f32 v158, v188, v189
v_cvt_pk_bf16_f32 v159, v190, v191
v_mfma_f32_16x16x32_bf16 v[60:63], a[192:195], a[128:131], 0
v_cvt_pk_bf16_f32 v152, v152, v153
v_cvt_pk_bf16_f32 v153, v154, v155
v_mfma_f32_16x16x32_bf16 v[60:63], a[196:199], a[144:147], v[60:63]
ds_read_b64_tr_b16 a[216:217], v7 offset:8736
ds_read_b64_tr_b16 a[218:219], v7 offset:9248
v_mfma_f32_16x16x32_bf16 v[32:35], a[196:199], a[148:151], 0
v_cvt_pk_bf16_f32 v154, v184, v185
v_cvt_pk_bf16_f32 v155, v186, v187
v_mfma_f32_16x16x32_bf16 v[32:35], a[192:195], a[132:135], v[32:35]
s_add_u32 s10, s77, 32768
v_cvt_pk_bf16_f32 v220, v220, v221
v_cvt_pk_bf16_f32 v221, v222, v223
v_mfma_f32_16x16x32_bf16 v[56:59], a[192:195], a[136:139], 0
buffer_store_dwordx4 v[144:147], v1, s[44:47], s10 offen sc1
v_mfma_f32_16x16x32_bf16 v[56:59], a[196:199], a[152:155], v[56:59]
ds_read_b64_tr_b16 a[220:221], v7 offset:25632
ds_read_b64_tr_b16 a[222:223], v7 offset:26144
v_mfma_f32_16x16x32_bf16 v[28:31], a[196:199], a[156:159], 0
v_cvt_pk_bf16_f32 v222, v252, v253
v_cvt_pk_bf16_f32 v223, v254, v255
v_mfma_f32_16x16x32_bf16 v[28:31], a[192:195], a[140:143], v[28:31]
s_waitcnt lgkmcnt(8)
v_cvt_pk_bf16_f32 v216, v216, v217
v_cvt_pk_bf16_f32 v217, v218, v219
v_mfma_f32_16x16x32_bf16 v[116:119], a[200:203], a[140:143], 0
s_add_u32 m0, s67, 2112
v_cvt_pk_bf16_f32 v218, v248, v249
v_cvt_pk_bf16_f32 v219, v250, v251
v_mfma_f32_16x16x32_bf16 v[116:119], a[204:207], a[156:159], v[116:119]
ds_read_b64_tr_b16 a[192:193], v7 offset:12672
ds_read_b64_tr_b16 a[194:195], v7 offset:13184
v_mfma_f32_16x16x32_bf16 v[88:91], a[204:207], a[152:155], 0
s_add_u32 s79, s79, s70
v_accvgpr_write_b32 a64, v40
v_accvgpr_write_b32 a65, v41
v_mfma_f32_16x16x32_bf16 v[88:91], a[200:203], a[136:139], v[88:91]
buffer_load_dwordx4 v4, s[96:99], s79 offen lds
v_mfma_f32_16x16x32_bf16 v[112:115], a[200:203], a[132:135], 0
v_accvgpr_write_b32 a66, v42
v_accvgpr_write_b32 a67, v43
v_mfma_f32_16x16x32_bf16 v[112:115], a[204:207], a[148:151], v[112:115]
ds_read_b64_tr_b16 a[196:197], v7 offset:29568
ds_read_b64_tr_b16 a[198:199], v7 offset:30080
v_mfma_f32_16x16x32_bf16 v[84:87], a[204:207], a[144:147], 0
s_add_u32 m0, s67, 3168
v_accvgpr_write_b32 a68, v36
v_accvgpr_write_b32 a69, v37
v_mfma_f32_16x16x32_bf16 v[84:87], a[200:203], a[128:131], v[84:87]
s_waitcnt lgkmcnt(8)
v_accvgpr_write_b32 a70, v38
v_accvgpr_write_b32 a71, v39
v_mfma_f32_16x16x32_bf16 v[180:183], a[208:211], a[128:131], 0
s_add_u32 s79, s79, s70
v_accvgpr_write_b32 a72, v96
v_accvgpr_write_b32 a73, v97
v_mfma_f32_16x16x32_bf16 v[180:183], a[212:215], a[144:147], v[180:183]
ds_read_b64_tr_b16 a[200:201], v7 offset:12704
ds_read_b64_tr_b16 a[202:203], v7 offset:13216
v_mfma_f32_16x16x32_bf16 v[176:179], a[212:215], a[148:151], 0
buffer_load_dwordx4 v4, s[96:99], s79 offen lds
v_mfma_f32_16x16x32_bf16 v[176:179], a[208:211], a[132:135], v[176:179]
v_accvgpr_write_b32 a74, v98
v_accvgpr_write_b32 a75, v99
v_mfma_f32_16x16x32_bf16 v[244:247], a[208:211], a[136:139], 0
v_accvgpr_write_b32 a76, v92
v_accvgpr_write_b32 a77, v93
v_mfma_f32_16x16x32_bf16 v[244:247], a[212:215], a[152:155], v[244:247]
ds_read_b64_tr_b16 a[204:205], v7 offset:29600
ds_read_b64_tr_b16 a[206:207], v7 offset:30112
v_mfma_f32_16x16x32_bf16 v[240:243], a[212:215], a[156:159], 0
s_add_u32 s10, s77, 41984
v_accvgpr_write_b32 a78, v94
v_accvgpr_write_b32 a79, v95
v_mfma_f32_16x16x32_bf16 v[240:243], a[208:211], a[140:143], v[240:243]
s_waitcnt lgkmcnt(8)
v_accvgpr_write_b32 a80, v156
v_accvgpr_write_b32 a81, v157
v_mfma_f32_16x16x32_bf16 v[148:151], a[216:219], a[140:143], 0
buffer_store_dwordx4 v[212:215], v1, s[44:47], s10 offen sc1
v_mfma_f32_16x16x32_bf16 v[148:151], a[220:223], a[156:159], v[148:151]
ds_read_b64_tr_b16 a[208:209], v7 offset:12928
ds_read_b64_tr_b16 a[210:211], v7 offset:13440
v_mfma_f32_16x16x32_bf16 v[68:71], a[220:223], a[152:155], 0
v_accvgpr_write_b32 a82, v158
v_accvgpr_write_b32 a83, v159
v_mfma_f32_16x16x32_bf16 v[68:71], a[216:219], a[136:139], v[68:71]
v_accvgpr_write_b32 a84, v152
v_accvgpr_write_b32 a85, v153
v_mfma_f32_16x16x32_bf16 v[64:67], a[216:219], a[132:135], 0
s_add_u32 m0, s67, 16896
v_accvgpr_write_b32 a86, v154
v_accvgpr_write_b32 a87, v155
v_mfma_f32_16x16x32_bf16 v[64:67], a[220:223], a[148:151], v[64:67]
ds_read_b64_tr_b16 a[212:213], v7 offset:29824
ds_read_b64_tr_b16 a[214:215], v7 offset:30336
v_mfma_f32_16x16x32_bf16 v[124:127], a[220:223], a[144:147], 0
s_add_u32 s79, s79, s70
v_accvgpr_write_b32 a88, v220
v_accvgpr_write_b32 a89, v221
v_mfma_f32_16x16x32_bf16 v[124:127], a[216:219], a[128:131], v[124:127]
s_waitcnt lgkmcnt(8)
v_accvgpr_write_b32 a90, v222
v_accvgpr_write_b32 a91, v223
v_mfma_f32_16x16x32_bf16 v[120:123], a[192:195], a[128:131], 0
buffer_load_dwordx4 v4, s[96:99], s79 offen lds
v_mfma_f32_16x16x32_bf16 v[120:123], a[196:199], a[144:147], v[120:123]
ds_read_b64_tr_b16 a[216:217], v7 offset:12960
ds_read_b64_tr_b16 a[218:219], v7 offset:13472
v_mfma_f32_16x16x32_bf16 v[188:191], a[196:199], a[148:151], 0
v_accvgpr_write_b32 a92, v216
v_accvgpr_write_b32 a93, v217
v_mfma_f32_16x16x32_bf16 v[188:191], a[192:195], a[132:135], v[188:191]
s_add_u32 m0, s67, 17952
v_accvgpr_write_b32 a94, v218
v_accvgpr_write_b32 a95, v219
v_mfma_f32_16x16x32_bf16 v[184:187], a[192:195], a[136:139], 0
s_add_u32 s79, s79, s70
v_mfma_f32_16x16x32_bf16 v[184:187], a[196:199], a[152:155], v[184:187]
ds_read_b64_tr_b16 a[220:221], v7 offset:29856
ds_read_b64_tr_b16 a[222:223], v7 offset:30368
v_mfma_f32_16x16x32_bf16 v[144:147], a[196:199], a[156:159], 0
buffer_load_dwordx4 v4, s[96:99], s79 offen lds
v_mfma_f32_16x16x32_bf16 v[144:147], a[192:195], a[140:143], v[144:147]
s_waitcnt lgkmcnt(8)
v_mfma_f32_16x16x32_bf16 v[252:255], a[200:203], a[140:143], 0
s_waitcnt vmcnt(9)
s_barrier
v_mfma_f32_16x16x32_bf16 v[252:255], a[204:207], a[156:159], v[252:255]
ds_read_b64_tr_b16 a[192:193], v7 offset:33792
ds_read_b64_tr_b16 a[194:195], v7 offset:34304
v_mfma_f32_16x16x32_bf16 v[248:251], a[204:207], a[152:155], 0
v_mfma_f32_16x16x32_bf16 v[248:251], a[200:203], a[136:139], v[248:251]
s_add_u32 s10, s77, 40960
v_mfma_f32_16x16x32_bf16 v[40:43], a[200:203], a[132:135], 0
buffer_store_dwordx4 v[208:211], v1, s[44:47], s10 offen sc1
v_mfma_f32_16x16x32_bf16 v[40:43], a[204:207], a[148:151], v[40:43]
ds_read_b64_tr_b16 a[196:197], v7 offset:50688
ds_read_b64_tr_b16 a[198:199], v7 offset:51200
v_mfma_f32_16x16x32_bf16 v[36:39], a[204:207], a[144:147], 0
v_mfma_f32_16x16x32_bf16 v[36:39], a[200:203], a[128:131], v[36:39]
s_waitcnt lgkmcnt(8)
v_mfma_f32_16x16x32_bf16 v[96:99], a[208:211], a[128:131], 0
s_add_u32 m0, s67, 19008
v_mfma_f32_16x16x32_bf16 v[96:99], a[212:215], a[144:147], v[96:99]
ds_read_b64_tr_b16 a[200:201], v7 offset:33824
ds_read_b64_tr_b16 a[202:203], v7 offset:34336
v_mfma_f32_16x16x32_bf16 v[92:95], a[212:215], a[148:151], 0
s_add_u32 s79, s79, s70
v_mfma_f32_16x16x32_bf16 v[92:95], a[208:211], a[132:135], v[92:95]
buffer_load_dwordx4 v4, s[96:99], s79 offen lds
v_mfma_f32_16x16x32_bf16 v[212:215], a[208:211], a[136:139], 0
v_mfma_f32_16x16x32_bf16 v[212:215], a[212:215], a[152:155], v[212:215]
ds_read_b64_tr_b16 a[204:205], v7 offset:50720
ds_read_b64_tr_b16 a[206:207], v7 offset:51232
v_mfma_f32_16x16x32_bf16 v[156:159], a[212:215], a[156:159], 0
s_add_u32 m0, s67, 20064
v_mfma_f32_16x16x32_bf16 v[156:159], a[208:211], a[140:143], v[156:159]
s_waitcnt lgkmcnt(8)
v_mfma_f32_16x16x32_bf16 v[152:155], a[216:219], a[140:143], 0
s_add_u32 s79, s79, s70
v_mfma_f32_16x16x32_bf16 v[152:155], a[220:223], a[156:159], v[152:155]
ds_read_b64_tr_b16 a[208:209], v7 offset:34048
ds_read_b64_tr_b16 a[210:211], v7 offset:34560
v_mfma_f32_16x16x32_bf16 v[220:223], a[220:223], a[152:155], 0
buffer_load_dwordx4 v4, s[96:99], s79 offen lds
v_mfma_f32_16x16x32_bf16 v[220:223], a[216:219], a[136:139], v[220:223]
v_mfma_f32_16x16x32_bf16 v[216:219], a[216:219], a[132:135], 0
v_mfma_f32_16x16x32_bf16 v[216:219], a[220:223], a[148:151], v[216:219]
ds_read_b64_tr_b16 a[212:213], v7 offset:50944
ds_read_b64_tr_b16 a[214:215], v7 offset:51456
v_mfma_f32_16x16x32_bf16 v[208:211], a[220:223], a[144:147], 0
v_mfma_f32_16x16x32_bf16 v[208:211], a[216:219], a[128:131], v[208:211]
s_waitcnt vmcnt(14) lgkmcnt(8)
v_mfma_f32_16x16x32_bf16 a[240:243], a[192:195], a[160:163], a[240:243]
v_add_u32 v3, 4096, v1
v_mfma_f32_16x16x32_bf16 a[240:243], a[196:199], a[176:179], a[240:243]
ds_read_b64_tr_b16 a[216:217], v7 offset:34080
ds_read_b64_tr_b16 a[218:219], v7 offset:34592
v_mfma_f32_16x16x32_bf16 a[244:247], a[196:199], a[180:183], a[244:247]
buffer_load_dwordx4 a[128:131], v3, s[40:43], s72 offen offset:0 sc1
v_mfma_f32_16x16x32_bf16 a[244:247], a[192:195], a[164:167], a[244:247]
v_mfma_f32_16x16x32_bf16 a[248:251], a[192:195], a[168:171], a[248:251]
v_mfma_f32_16x16x32_bf16 a[248:251], a[196:199], a[184:187], a[248:251]
ds_read_b64_tr_b16 a[220:221], v7 offset:50976
ds_read_b64_tr_b16 a[222:223], v7 offset:51488
v_mfma_f32_16x16x32_bf16 a[252:255], a[196:199], a[188:191], a[252:255]
buffer_load_dwordx4 a[144:147], v3, s[40:43], s72 offen offset:1024 sc1
v_mfma_f32_16x16x32_bf16 a[252:255], a[192:195], a[172:175], a[252:255]
s_waitcnt lgkmcnt(8)
v_mfma_f32_16x16x32_bf16 v[132:135], a[200:203], a[172:175], v[132:135]
v_mfma_f32_16x16x32_bf16 v[132:135], a[204:207], a[188:191], v[132:135]
ds_read_b64_tr_b16 a[192:193], v7 offset:38016
ds_read_b64_tr_b16 a[194:195], v7 offset:38528
v_mfma_f32_16x16x32_bf16 v[128:131], a[204:207], a[184:187], v[128:131]
buffer_load_dwordx4 a[132:135], v3, s[40:43], s73 offen offset:0 sc1
v_mfma_f32_16x16x32_bf16 v[128:131], a[200:203], a[168:171], v[128:131]
v_mfma_f32_16x16x32_bf16 v[164:167], a[200:203], a[164:167], v[164:167]
v_mfma_f32_16x16x32_bf16 v[164:167], a[204:207], a[180:183], v[164:167]
ds_read_b64_tr_b16 a[196:197], v7 offset:54912
ds_read_b64_tr_b16 a[198:199], v7 offset:55424
v_mfma_f32_16x16x32_bf16 v[160:163], a[204:207], a[176:179], v[160:163]
buffer_load_dwordx4 a[148:151], v3, s[40:43], s73 offen offset:1024 sc1
v_mfma_f32_16x16x32_bf16 v[160:163], a[200:203], a[160:163], v[160:163]
s_waitcnt lgkmcnt(8)
v_mfma_f32_16x16x32_bf16 v[196:199], a[208:211], a[160:163], v[196:199]
v_mfma_f32_16x16x32_bf16 v[196:199], a[212:215], a[176:179], v[196:199]
ds_read_b64_tr_b16 a[200:201], v7 offset:38048
ds_read_b64_tr_b16 a[202:203], v7 offset:38560
v_mfma_f32_16x16x32_bf16 v[192:195], a[212:215], a[180:183], v[192:195]
buffer_load_dwordx4 a[136:139], v3, s[40:43], s74 offen offset:0 sc1
v_mfma_f32_16x16x32_bf16 v[192:195], a[208:211], a[164:167], v[192:195]
v_mfma_f32_16x16x32_bf16 v[16:19], a[208:211], a[168:171], v[16:19]
v_mfma_f32_16x16x32_bf16 v[16:19], a[212:215], a[184:187], v[16:19]
ds_read_b64_tr_b16 a[204:205], v7 offset:54944
ds_read_b64_tr_b16 a[206:207], v7 offset:55456
v_mfma_f32_16x16x32_bf16 v[228:231], a[212:215], a[188:191], v[228:231]
buffer_load_dwordx4 a[152:155], v3, s[40:43], s74 offen offset:1024 sc1
v_mfma_f32_16x16x32_bf16 v[228:231], a[208:211], a[172:175], v[228:231]
s_waitcnt lgkmcnt(8)
v_mfma_f32_16x16x32_bf16 v[224:227], a[216:219], a[172:175], v[224:227]
v_mfma_f32_16x16x32_bf16 v[224:227], a[220:223], a[188:191], v[224:227]
ds_read_b64_tr_b16 a[208:209], v7 offset:38272
ds_read_b64_tr_b16 a[210:211], v7 offset:38784
v_mfma_f32_16x16x32_bf16 v[236:239], a[220:223], a[184:187], v[236:239]
buffer_load_dwordx4 a[140:143], v3, s[40:43], s75 offen offset:0 sc1
v_mfma_f32_16x16x32_bf16 v[236:239], a[216:219], a[168:171], v[236:239]
v_mfma_f32_16x16x32_bf16 v[44:47], a[216:219], a[164:167], v[44:47]
v_mfma_f32_16x16x32_bf16 v[44:47], a[220:223], a[180:183], v[44:47]
ds_read_b64_tr_b16 a[212:213], v7 offset:55168
ds_read_b64_tr_b16 a[214:215], v7 offset:55680
v_mfma_f32_16x16x32_bf16 v[232:235], a[220:223], a[176:179], v[232:235]
buffer_load_dwordx4 a[156:159], v3, s[40:43], s75 offen offset:1024 sc1
v_mfma_f32_16x16x32_bf16 v[232:235], a[216:219], a[160:163], v[232:235]
s_waitcnt lgkmcnt(8)
v_mfma_f32_16x16x32_bf16 v[204:207], a[192:195], a[160:163], v[204:207]
v_mfma_f32_16x16x32_bf16 v[204:207], a[196:199], a[176:179], v[204:207]
ds_read_b64_tr_b16 a[216:217], v7 offset:38304
ds_read_b64_tr_b16 a[218:219], v7 offset:38816
v_mfma_f32_16x16x32_bf16 v[200:203], a[196:199], a[180:183], v[200:203]
s_add_u32 s10, s77, 3072
v_mfma_f32_16x16x32_bf16 v[200:203], a[192:195], a[164:167], v[200:203]
buffer_store_dwordx4 a[64:67], v1, s[44:47], s10 offen sc1
v_mfma_f32_16x16x32_bf16 v[72:75], a[192:195], a[168:171], v[72:75]
s_add_u32 m0, s67, 33792
v_mfma_f32_16x16x32_bf16 v[72:75], a[196:199], a[184:187], v[72:75]
ds_read_b64_tr_b16 a[220:221], v7 offset:55200
ds_read_b64_tr_b16 a[222:223], v7 offset:55712
v_mfma_f32_16x16x32_bf16 v[172:175], a[196:199], a[188:191], v[172:175]
s_add_u32 s79, s79, s70
v_mfma_f32_16x16x32_bf16 v[172:175], a[192:195], a[172:175], v[172:175]
s_waitcnt lgkmcnt(8)
v_mfma_f32_16x16x32_bf16 v[168:171], a[200:203], a[172:175], v[168:171]
buffer_load_dwordx4 v4, s[96:99], s79 offen lds
v_mfma_f32_16x16x32_bf16 v[168:171], a[204:207], a[188:191], v[168:171]
ds_read_b64_tr_b16 a[192:193], v7 offset:42240
ds_read_b64_tr_b16 a[194:195], v7 offset:42752
v_mfma_f32_16x16x32_bf16 v[140:143], a[204:207], a[184:187], v[140:143]
v_mfma_f32_16x16x32_bf16 v[140:143], a[200:203], a[168:171], v[140:143]
s_add_u32 m0, s67, 34848
v_mfma_f32_16x16x32_bf16 v[100:103], a[200:203], a[164:167], v[100:103]
s_add_u32 s79, s79, s70
v_mfma_f32_16x16x32_bf16 v[100:103], a[204:207], a[180:183], v[100:103]
ds_read_b64_tr_b16 a[196:197], v7 offset:59136
ds_read_b64_tr_b16 a[198:199], v7 offset:59648
v_mfma_f32_16x16x32_bf16 v[136:139], a[204:207], a[176:179], v[136:139]
buffer_load_dwordx4 v4, s[96:99], s79 offen lds
v_mfma_f32_16x16x32_bf16 v[136:139], a[200:203], a[160:163], v[136:139]
s_waitcnt lgkmcnt(8)
v_mfma_f32_16x16x32_bf16 v[108:111], a[208:211], a[160:163], v[108:111]
v_mfma_f32_16x16x32_bf16 v[108:111], a[212:215], a[176:179], v[108:111]
ds_read_b64_tr_b16 a[200:201], v7 offset:42272
ds_read_b64_tr_b16 a[202:203], v7 offset:42784
v_mfma_f32_16x16x32_bf16 v[104:107], a[212:215], a[180:183], v[104:107]
v_mfma_f32_16x16x32_bf16 v[104:107], a[208:211], a[164:167], v[104:107]
s_add_u32 s10, s77, 2048
v_mfma_f32_16x16x32_bf16 v[80:83], a[208:211], a[168:171], v[80:83]
buffer_store_dwordx4 a[68:71], v1, s[44:47], s10 offen sc1
v_mfma_f32_16x16x32_bf16 v[80:83], a[212:215], a[184:187], v[80:83]
ds_read_b64_tr_b16 a[204:205], v7 offset:59168
ds_read_b64_tr_b16 a[206:207], v7 offset:59680
v_mfma_f32_16x16x32_bf16 v[76:79], a[212:215], a[188:191], v[76:79]
s_add_u32 m0, s67, 35904
v_mfma_f32_16x16x32_bf16 v[76:79], a[208:211], a[172:175], v[76:79]
s_waitcnt lgkmcnt(8)
v_mfma_f32_16x16x32_bf16 v[52:55], a[216:219], a[172:175], v[52:55]
s_add_u32 s79, s79, s70
v_mfma_f32_16x16x32_bf16 v[52:55], a[220:223], a[188:191], v[52:55]
ds_read_b64_tr_b16 a[208:209], v7 offset:42496
ds_read_b64_tr_b16 a[210:211], v7 offset:43008
v_mfma_f32_16x16x32_bf16 v[48:51], a[220:223], a[184:187], v[48:51]
buffer_load_dwordx4 v4, s[96:99], s79 offen lds
v_mfma_f32_16x16x32_bf16 v[48:51], a[216:219], a[168:171], v[48:51]
v_mfma_f32_16x16x32_bf16 v[24:27], a[216:219], a[164:167], v[24:27]
s_add_u32 m0, s67, 36960
v_mfma_f32_16x16x32_bf16 v[24:27], a[220:223], a[180:183], v[24:27]
ds_read_b64_tr_b16 a[212:213], v7 offset:59392
ds_read_b64_tr_b16 a[214:215], v7 offset:59904
v_mfma_f32_16x16x32_bf16 v[20:23], a[220:223], a[176:179], v[20:23]
s_add_u32 s79, s79, s70
v_mfma_f32_16x16x32_bf16 v[20:23], a[216:219], a[160:163], v[20:23]
s_waitcnt lgkmcnt(8)
v_mfma_f32_16x16x32_bf16 v[60:63], a[192:195], a[160:163], v[60:63]
buffer_load_dwordx4 v4, s[96:99], s79 offen lds
v_mfma_f32_16x16x32_bf16 v[60:63], a[196:199], a[176:179], v[60:63]
ds_read_b64_tr_b16 a[216:217], v7 offset:42528
ds_read_b64_tr_b16 a[218:219], v7 offset:43040
v_mfma_f32_16x16x32_bf16 v[32:35], a[196:199], a[180:183], v[32:35]
v_mfma_f32_16x16x32_bf16 v[32:35], a[192:195], a[164:167], v[32:35]
v_mfma_f32_16x16x32_bf16 v[56:59], a[192:195], a[168:171], v[56:59]
s_add_u32 s10, s77, 11264
v_mfma_f32_16x16x32_bf16 v[56:59], a[196:199], a[184:187], v[56:59]
ds_read_b64_tr_b16 a[220:221], v7 offset:59424
ds_read_b64_tr_b16 a[222:223], v7 offset:59936
v_mfma_f32_16x16x32_bf16 v[28:31], a[196:199], a[188:191], v[28:31]
buffer_store_dwordx4 a[72:75], v1, s[44:47], s10 offen sc1
v_mfma_f32_16x16x32_bf16 v[28:31], a[192:195], a[172:175], v[28:31]
s_waitcnt lgkmcnt(8)
v_mfma_f32_16x16x32_bf16 v[116:119], a[200:203], a[172:175], v[116:119]
v_mfma_f32_16x16x32_bf16 v[116:119], a[204:207], a[188:191], v[116:119]
ds_read_b64_tr_b16 a[192:193], v7 offset:46464
ds_read_b64_tr_b16 a[194:195], v7 offset:46976
v_mfma_f32_16x16x32_bf16 v[88:91], a[204:207], a[184:187], v[88:91]
s_add_u32 m0, s67, 50688
v_mfma_f32_16x16x32_bf16 v[88:91], a[200:203], a[168:171], v[88:91]
s_add_u32 s79, s79, s70
v_mfma_f32_16x16x32_bf16 v[112:115], a[200:203], a[164:167], v[112:115]
buffer_load_dwordx4 v4, s[96:99], s79 offen lds
v_mfma_f32_16x16x32_bf16 v[112:115], a[204:207], a[180:183], v[112:115]
ds_read_b64_tr_b16 a[196:197], v7 offset:63360
ds_read_b64_tr_b16 a[198:199], v7 offset:63872
v_mfma_f32_16x16x32_bf16 v[84:87], a[204:207], a[176:179], v[84:87]
s_add_u32 m0, s67, 51744
v_mfma_f32_16x16x32_bf16 v[84:87], a[200:203], a[160:163], v[84:87]
s_waitcnt lgkmcnt(8)
v_mfma_f32_16x16x32_bf16 v[180:183], a[208:211], a[160:163], v[180:183]
s_add_u32 s79, s79, s70
v_mfma_f32_16x16x32_bf16 v[180:183], a[212:215], a[176:179], v[180:183]
ds_read_b64_tr_b16 a[200:201], v7 offset:46496
ds_read_b64_tr_b16 a[202:203], v7 offset:47008
v_mfma_f32_16x16x32_bf16 v[176:179], a[212:215], a[180:183], v[176:179]
buffer_load_dwordx4 v4, s[96:99], s79 offen lds
v_mfma_f32_16x16x32_bf16 v[176:179], a[208:211], a[164:167], v[176:179]
v_mfma_f32_16x16x32_bf16 v[244:247], a[208:211], a[168:171], v[244:247]
v_mfma_f32_16x16x32_bf16 v[244:247], a[212:215], a[184:187], v[244:247]
ds_read_b64_tr_b16 a[204:205], v7 offset:63392
ds_read_b64_tr_b16 a[206:207], v7 offset:63904
v_mfma_f32_16x16x32_bf16 v[240:243], a[212:215], a[188:191], v[240:243]
s_add_u32 s10, s77, 10240
v_mfma_f32_16x16x32_bf16 v[240:243], a[208:211], a[172:175], v[240:243]
s_waitcnt lgkmcnt(8)
v_mfma_f32_16x16x32_bf16 v[148:151], a[216:219], a[172:175], v[148:151]
buffer_store_dwordx4 a[76:79], v1, s[44:47], s10 offen sc1
v_mfma_f32_16x16x32_bf16 v[148:151], a[220:223], a[188:191], v[148:151]
ds_read_b64_tr_b16 a[208:209], v7 offset:46720
ds_read_b64_tr_b16 a[210:211], v7 offset:47232
v_mfma_f32_16x16x32_bf16 v[68:71], a[220:223], a[184:187], v[68:71]
v_mfma_f32_16x16x32_bf16 v[68:71], a[216:219], a[168:171], v[68:71]
s_add_u32 m0, s67, 52800
v_mfma_f32_16x16x32_bf16 v[64:67], a[216:219], a[164:167], v[64:67]
s_add_u32 s79, s79, s70
v_mfma_f32_16x16x32_bf16 v[64:67], a[220:223], a[180:183], v[64:67]
ds_read_b64_tr_b16 a[212:213], v7 offset:63616
ds_read_b64_tr_b16 a[214:215], v7 offset:64128
v_mfma_f32_16x16x32_bf16 v[124:127], a[220:223], a[176:179], v[124:127]
buffer_load_dwordx4 v4, s[96:99], s79 offen lds
v_mfma_f32_16x16x32_bf16 v[124:127], a[216:219], a[160:163], v[124:127]
s_waitcnt lgkmcnt(8)
v_mfma_f32_16x16x32_bf16 v[120:123], a[192:195], a[160:163], v[120:123]
v_mfma_f32_16x16x32_bf16 v[120:123], a[196:199], a[176:179], v[120:123]
ds_read_b64_tr_b16 a[216:217], v7 offset:46752
ds_read_b64_tr_b16 a[218:219], v7 offset:47264
v_mfma_f32_16x16x32_bf16 v[188:191], a[196:199], a[180:183], v[188:191]
s_add_u32 m0, s67, 53856
v_mfma_f32_16x16x32_bf16 v[188:191], a[192:195], a[164:167], v[188:191]
s_add_u32 s79, s79, s70
v_mfma_f32_16x16x32_bf16 v[184:187], a[192:195], a[168:171], v[184:187]
buffer_load_dwordx4 v4, s[96:99], s79 offen lds
v_mfma_f32_16x16x32_bf16 v[184:187], a[196:199], a[184:187], v[184:187]
ds_read_b64_tr_b16 a[220:221], v7 offset:63648
ds_read_b64_tr_b16 a[222:223], v7 offset:64160
v_mfma_f32_16x16x32_bf16 v[144:147], a[196:199], a[188:191], v[144:147]
v_mfma_f32_16x16x32_bf16 v[144:147], a[192:195], a[172:175], v[144:147]
s_waitcnt lgkmcnt(8)
v_mfma_f32_16x16x32_bf16 v[252:255], a[200:203], a[172:175], v[252:255]
s_waitcnt vmcnt(20)
s_barrier
v_mfma_f32_16x16x32_bf16 v[252:255], a[204:207], a[188:191], v[252:255]
ds_read_b64_tr_b16 a[192:193], v6 offset:0
ds_read_b64_tr_b16 a[194:195], v6 offset:512
v_mfma_f32_16x16x32_bf16 v[248:251], a[204:207], a[184:187], v[248:251]
v_mfma_f32_16x16x32_bf16 v[248:251], a[200:203], a[168:171], v[248:251]
v_mfma_f32_16x16x32_bf16 v[40:43], a[200:203], a[164:167], v[40:43]
v_mfma_f32_16x16x32_bf16 v[40:43], a[204:207], a[180:183], v[40:43]
ds_read_b64_tr_b16 a[196:197], v6 offset:16896
ds_read_b64_tr_b16 a[198:199], v6 offset:17408
v_mfma_f32_16x16x32_bf16 v[36:39], a[204:207], a[176:179], v[36:39]
v_mfma_f32_16x16x32_bf16 v[36:39], a[200:203], a[160:163], v[36:39]
s_waitcnt lgkmcnt(8)
v_mfma_f32_16x16x32_bf16 v[96:99], a[208:211], a[160:163], v[96:99]
v_mfma_f32_16x16x32_bf16 v[96:99], a[212:215], a[176:179], v[96:99]
ds_read_b64_tr_b16 a[200:201], v6 offset:32
ds_read_b64_tr_b16 a[202:203], v6 offset:544
v_mfma_f32_16x16x32_bf16 v[92:95], a[212:215], a[180:183], v[92:95]
v_mfma_f32_16x16x32_bf16 v[92:95], a[208:211], a[164:167], v[92:95]
v_mfma_f32_16x16x32_bf16 v[212:215], a[208:211], a[168:171], v[212:215]
v_accvgpr_read_b32 v10, a226
v_accvgpr_read_b32 v11, a227
v_mfma_f32_16x16x32_bf16 v[212:215], a[212:215], a[184:187], v[212:215]
ds_read_b64_tr_b16 a[204:205], v6 offset:16928
ds_read_b64_tr_b16 a[206:207], v6 offset:17440
v_mfma_f32_16x16x32_bf16 v[156:159], a[212:215], a[188:191], v[156:159]
v_mfma_f32_16x16x32_bf16 v[156:159], a[208:211], a[172:175], v[156:159]
s_waitcnt lgkmcnt(8)
v_mfma_f32_16x16x32_bf16 v[152:155], a[216:219], a[172:175], v[152:155]
v_mfma_f32_16x16x32_bf16 v[152:155], a[220:223], a[188:191], v[152:155]
ds_read_b64_tr_b16 a[208:209], v6 offset:256
ds_read_b64_tr_b16 a[210:211], v6 offset:768
v_mfma_f32_16x16x32_bf16 v[220:223], a[220:223], a[184:187], v[220:223]
v_mfma_f32_16x16x32_bf16 v[220:223], a[216:219], a[168:171], v[220:223]
v_mfma_f32_16x16x32_bf16 v[216:219], a[216:219], a[164:167], v[216:219]
v_mfma_f32_16x16x32_bf16 v[216:219], a[220:223], a[180:183], v[216:219]
ds_read_b64_tr_b16 a[212:213], v6 offset:17152
ds_read_b64_tr_b16 a[214:215], v6 offset:17664
v_mfma_f32_16x16x32_bf16 v[208:211], a[220:223], a[176:179], v[208:211]
global_load_dword a228, v[10:11], off
v_mfma_f32_16x16x32_bf16 v[208:211], a[216:219], a[160:163], v[208:211]
s_waitcnt vmcnt(13) lgkmcnt(8)
v_mfma_f32_16x16x32_bf16 a[240:243], a[192:195], a[128:131], a[240:243]
v_add_u32 v3, 6144, v1
v_mfma_f32_16x16x32_bf16 a[240:243], a[196:199], a[144:147], a[240:243]
ds_read_b64_tr_b16 a[216:217], v6 offset:288
ds_read_b64_tr_b16 a[218:219], v6 offset:800
v_mfma_f32_16x16x32_bf16 a[244:247], a[196:199], a[148:151], a[244:247]
buffer_load_dwordx4 a[160:163], v3, s[40:43], s72 offen offset:0 sc1
v_mfma_f32_16x16x32_bf16 a[244:247], a[192:195], a[132:135], a[244:247]
v_mfma_f32_16x16x32_bf16 a[248:251], a[192:195], a[136:139], a[248:251]
v_mfma_f32_16x16x32_bf16 a[248:251], a[196:199], a[152:155], a[248:251]
ds_read_b64_tr_b16 a[220:221], v6 offset:17184
ds_read_b64_tr_b16 a[222:223], v6 offset:17696
v_mfma_f32_16x16x32_bf16 a[252:255], a[196:199], a[156:159], a[252:255]
buffer_load_dwordx4 a[176:179], v3, s[40:43], s72 offen offset:1024 sc1
v_mfma_f32_16x16x32_bf16 a[252:255], a[192:195], a[140:143], a[252:255]
s_waitcnt lgkmcnt(8)
v_mfma_f32_16x16x32_bf16 v[132:135], a[200:203], a[140:143], v[132:135]
v_mfma_f32_16x16x32_bf16 v[132:135], a[204:207], a[156:159], v[132:135]
ds_read_b64_tr_b16 a[192:193], v6 offset:4224
ds_read_b64_tr_b16 a[194:195], v6 offset:4736
v_mfma_f32_16x16x32_bf16 v[128:131], a[204:207], a[152:155], v[128:131]
buffer_load_dwordx4 a[164:167], v3, s[40:43], s73 offen offset:0 sc1
v_mfma_f32_16x16x32_bf16 v[128:131], a[200:203], a[136:139], v[128:131]
v_mfma_f32_16x16x32_bf16 v[164:167], a[200:203], a[132:135], v[164:167]
v_mfma_f32_16x16x32_bf16 v[164:167], a[204:207], a[148:151], v[164:167]
ds_read_b64_tr_b16 a[196:197], v6 offset:21120
ds_read_b64_tr_b16 a[198:199], v6 offset:21632
v_mfma_f32_16x16x32_bf16 v[160:163], a[204:207], a[144:147], v[160:163]
buffer_load_dwordx4 a[180:183], v3, s[40:43], s73 offen offset:1024 sc1
v_mfma_f32_16x16x32_bf16 v[160:163], a[200:203], a[128:131], v[160:163]
Lpad2:
s_cbranch_execz Lpad6
s_waitcnt lgkmcnt(8)
v_mfma_f32_16x16x32_bf16 v[196:199], a[208:211], a[128:131], v[196:199]
v_mfma_f32_16x16x32_bf16 v[196:199], a[212:215], a[144:147], v[196:199]
ds_read_b64_tr_b16 a[200:201], v6 offset:4256
ds_read_b64_tr_b16 a[202:203], v6 offset:4768
v_mfma_f32_16x16x32_bf16 v[192:195], a[212:215], a[148:151], v[192:195]
buffer_load_dwordx4 a[168:171], v3, s[40:43], s74 offen offset:0 sc1
v_mfma_f32_16x16x32_bf16 v[192:195], a[208:211], a[132:135], v[192:195]
v_mfma_f32_16x16x32_bf16 v[16:19], a[208:211], a[136:139], v[16:19]
v_mfma_f32_16x16x32_bf16 v[16:19], a[212:215], a[152:155], v[16:19]
ds_read_b64_tr_b16 a[204:205], v6 offset:21152
ds_read_b64_tr_b16 a[206:207], v6 offset:21664
v_mfma_f32_16x16x32_bf16 v[228:231], a[212:215], a[156:159], v[228:231]
buffer_load_dwordx4 a[184:187], v3, s[40:43], s74 offen offset:1024 sc1
v_mfma_f32_16x16x32_bf16 v[228:231], a[208:211], a[140:143], v[228:231]
s_waitcnt lgkmcnt(8)
v_mfma_f32_16x16x32_bf16 v[224:227], a[216:219], a[140:143], v[224:227]
v_mfma_f32_16x16x32_bf16 v[224:227], a[220:223], a[156:159], v[224:227]
ds_read_b64_tr_b16 a[208:209], v6 offset:4480
ds_read_b64_tr_b16 a[210:211], v6 offset:4992
v_mfma_f32_16x16x32_bf16 v[236:239], a[220:223], a[152:155], v[236:239]
buffer_load_dwordx4 a[172:175], v3, s[40:43], s75 offen offset:0 sc1
v_mfma_f32_16x16x32_bf16 v[236:239], a[216:219], a[136:139], v[236:239]
v_mfma_f32_16x16x32_bf16 v[44:47], a[216:219], a[132:135], v[44:47]
v_mfma_f32_16x16x32_bf16 v[44:47], a[220:223], a[148:151], v[44:47]
ds_read_b64_tr_b16 a[212:213], v6 offset:21376
ds_read_b64_tr_b16 a[214:215], v6 offset:21888
v_mfma_f32_16x16x32_bf16 v[232:235], a[220:223], a[144:147], v[232:235]
buffer_load_dwordx4 a[188:191], v3, s[40:43], s75 offen offset:1024 sc1
v_mfma_f32_16x16x32_bf16 v[232:235], a[216:219], a[128:131], v[232:235]
s_waitcnt lgkmcnt(8)
v_mfma_f32_16x16x32_bf16 v[204:207], a[192:195], a[128:131], v[204:207]
v_mfma_f32_16x16x32_bf16 v[204:207], a[196:199], a[144:147], v[204:207]
ds_read_b64_tr_b16 a[216:217], v6 offset:4512
ds_read_b64_tr_b16 a[218:219], v6 offset:5024
v_mfma_f32_16x16x32_bf16 v[200:203], a[196:199], a[148:151], v[200:203]
s_add_u32 s10, s77, 35840
v_mfma_f32_16x16x32_bf16 v[200:203], a[192:195], a[132:135], v[200:203]
buffer_store_dwordx4 a[80:83], v1, s[44:47], s10 offen sc1
v_mfma_f32_16x16x32_bf16 v[72:75], a[192:195], a[136:139], v[72:75]
s_add_u32 m0, s67, 67584
v_mfma_f32_16x16x32_bf16 v[72:75], a[196:199], a[152:155], v[72:75]
ds_read_b64_tr_b16 a[220:221], v6 offset:21408
ds_read_b64_tr_b16 a[222:223], v6 offset:21920
v_mfma_f32_16x16x32_bf16 v[172:175], a[196:199], a[156:159], v[172:175]
s_add_u32 s79, s79, s70
v_mfma_f32_16x16x32_bf16 v[172:175], a[192:195], a[140:143], v[172:175]
s_waitcnt lgkmcnt(8)
v_mfma_f32_16x16x32_bf16 v[168:171], a[200:203], a[140:143], v[168:171]
buffer_load_dwordx4 v4, s[96:99], s79 offen lds
v_mfma_f32_16x16x32_bf16 v[168:171], a[204:207], a[156:159], v[168:171]
ds_read_b64_tr_b16 a[192:193], v6 offset:8448
ds_read_b64_tr_b16 a[194:195], v6 offset:8960
v_mfma_f32_16x16x32_bf16 v[140:143], a[204:207], a[152:155], v[140:143]
v_mfma_f32_16x16x32_bf16 v[140:143], a[200:203], a[136:139], v[140:143]
s_add_u32 m0, s67, 68640
v_mfma_f32_16x16x32_bf16 v[100:103], a[200:203], a[132:135], v[100:103]
s_add_u32 s79, s79, s70
v_mfma_f32_16x16x32_bf16 v[100:103], a[204:207], a[148:151], v[100:103]
ds_read_b64_tr_b16 a[196:197], v6 offset:25344
ds_read_b64_tr_b16 a[198:199], v6 offset:25856
v_mfma_f32_16x16x32_bf16 v[136:139], a[204:207], a[144:147], v[136:139]
buffer_load_dwordx4 v4, s[96:99], s79 offen lds
v_mfma_f32_16x16x32_bf16 v[136:139], a[200:203], a[128:131], v[136:139]
s_waitcnt lgkmcnt(8)
v_mfma_f32_16x16x32_bf16 v[108:111], a[208:211], a[128:131], v[108:111]
v_mfma_f32_16x16x32_bf16 v[108:111], a[212:215], a[144:147], v[108:111]
ds_read_b64_tr_b16 a[200:201], v6 offset:8480
ds_read_b64_tr_b16 a[202:203], v6 offset:8992
v_mfma_f32_16x16x32_bf16 v[104:107], a[212:215], a[148:151], v[104:107]
v_mfma_f32_16x16x32_bf16 v[104:107], a[208:211], a[132:135], v[104:107]
s_add_u32 s10, s77, 34816
v_mfma_f32_16x16x32_bf16 v[80:83], a[208:211], a[136:139], v[80:83]
buffer_store_dwordx4 a[84:87], v1, s[44:47], s10 offen sc1
v_mfma_f32_16x16x32_bf16 v[80:83], a[212:215], a[152:155], v[80:83]
ds_read_b64_tr_b16 a[204:205], v6 offset:25376
ds_read_b64_tr_b16 a[206:207], v6 offset:25888
v_mfma_f32_16x16x32_bf16 v[76:79], a[212:215], a[156:159], v[76:79]
s_add_u32 m0, s67, 69696
v_mfma_f32_16x16x32_bf16 v[76:79], a[208:211], a[140:143], v[76:79]
s_waitcnt lgkmcnt(8)
v_mfma_f32_16x16x32_bf16 v[52:55], a[216:219], a[140:143], v[52:55]
s_add_u32 s79, s79, s70
v_mfma_f32_16x16x32_bf16 v[52:55], a[220:223], a[156:159], v[52:55]
ds_read_b64_tr_b16 a[208:209], v6 offset:8704
ds_read_b64_tr_b16 a[210:211], v6 offset:9216
v_mfma_f32_16x16x32_bf16 v[48:51], a[220:223], a[152:155], v[48:51]
buffer_load_dwordx4 v4, s[96:99], s79 offen lds
v_mfma_f32_16x16x32_bf16 v[48:51], a[216:219], a[136:139], v[48:51]
v_mfma_f32_16x16x32_bf16 v[24:27], a[216:219], a[132:135], v[24:27]
s_add_u32 m0, s67, 70752
v_mfma_f32_16x16x32_bf16 v[24:27], a[220:223], a[148:151], v[24:27]
ds_read_b64_tr_b16 a[212:213], v6 offset:25600
ds_read_b64_tr_b16 a[214:215], v6 offset:26112
v_mfma_f32_16x16x32_bf16 v[20:23], a[220:223], a[144:147], v[20:23]
s_add_u32 s79, s79, s70
v_mfma_f32_16x16x32_bf16 v[20:23], a[216:219], a[128:131], v[20:23]
s_waitcnt lgkmcnt(8)
v_mfma_f32_16x16x32_bf16 v[60:63], a[192:195], a[128:131], v[60:63]
buffer_load_dwordx4 v4, s[96:99], s79 offen lds
v_mfma_f32_16x16x32_bf16 v[60:63], a[196:199], a[144:147], v[60:63]
ds_read_b64_tr_b16 a[216:217], v6 offset:8736
ds_read_b64_tr_b16 a[218:219], v6 offset:9248
v_mfma_f32_16x16x32_bf16 v[32:35], a[196:199], a[148:151], v[32:35]
v_mfma_f32_16x16x32_bf16 v[32:35], a[192:195], a[132:135], v[32:35]
v_mfma_f32_16x16x32_bf16 v[56:59], a[192:195], a[136:139], v[56:59]
s_add_u32 s10, s77, 44032
v_mfma_f32_16x16x32_bf16 v[56:59], a[196:199], a[152:155], v[56:59]
ds_read_b64_tr_b16 a[220:221], v6 offset:25632
ds_read_b64_tr_b16 a[222:223], v6 offset:26144
v_mfma_f32_16x16x32_bf16 v[28:31], a[196:199], a[156:159], v[28:31]
buffer_store_dwordx4 a[88:91], v1, s[44:47], s10 offen sc1
v_mfma_f32_16x16x32_bf16 v[28:31], a[192:195], a[140:143], v[28:31]
s_waitcnt lgkmcnt(8)
v_mfma_f32_16x16x32_bf16 v[116:119], a[200:203], a[140:143], v[116:119]
v_mfma_f32_16x16x32_bf16 v[116:119], a[204:207], a[156:159], v[116:119]
ds_read_b64_tr_b16 a[192:193], v6 offset:12672
ds_read_b64_tr_b16 a[194:195], v6 offset:13184
v_mfma_f32_16x16x32_bf16 v[88:91], a[204:207], a[152:155], v[88:91]
s_add_u32 m0, s67, 84480
v_mfma_f32_16x16x32_bf16 v[88:91], a[200:203], a[136:139], v[88:91]
s_add_u32 s79, s79, s70
v_mfma_f32_16x16x32_bf16 v[112:115], a[200:203], a[132:135], v[112:115]
buffer_load_dwordx4 v4, s[96:99], s79 offen lds
v_mfma_f32_16x16x32_bf16 v[112:115], a[204:207], a[148:151], v[112:115]
ds_read_b64_tr_b16 a[196:197], v6 offset:29568
ds_read_b64_tr_b16 a[198:199], v6 offset:30080
v_mfma_f32_16x16x32_bf16 v[84:87], a[204:207], a[144:147], v[84:87]
s_add_u32 m0, s67, 85536
v_mfma_f32_16x16x32_bf16 v[84:87], a[200:203], a[128:131], v[84:87]
s_waitcnt lgkmcnt(8)
v_mfma_f32_16x16x32_bf16 v[180:183], a[208:211], a[128:131], v[180:183]
s_add_u32 s79, s79, s70
v_mfma_f32_16x16x32_bf16 v[180:183], a[212:215], a[144:147], v[180:183]
ds_read_b64_tr_b16 a[200:201], v6 offset:12704
ds_read_b64_tr_b16 a[202:203], v6 offset:13216
v_mfma_f32_16x16x32_bf16 v[176:179], a[212:215], a[148:151], v[176:179]
buffer_load_dwordx4 v4, s[96:99], s79 offen lds
v_mfma_f32_16x16x32_bf16 v[176:179], a[208:211], a[132:135], v[176:179]
v_mfma_f32_16x16x32_bf16 v[244:247], a[208:211], a[136:139], v[244:247]
v_mfma_f32_16x16x32_bf16 v[244:247], a[212:215], a[152:155], v[244:247]
ds_read_b64_tr_b16 a[204:205], v6 offset:29600
ds_read_b64_tr_b16 a[206:207], v6 offset:30112
v_mfma_f32_16x16x32_bf16 v[240:243], a[212:215], a[156:159], v[240:243]
s_add_u32 s10, s77, 43008
v_mfma_f32_16x16x32_bf16 v[240:243], a[208:211], a[140:143], v[240:243]
s_waitcnt lgkmcnt(8)
v_mfma_f32_16x16x32_bf16 v[148:151], a[216:219], a[140:143], v[148:151]
buffer_store_dwordx4 a[92:95], v1, s[44:47], s10 offen sc1
v_mfma_f32_16x16x32_bf16 v[148:151], a[220:223], a[156:159], v[148:151]
ds_read_b64_tr_b16 a[208:209], v6 offset:12928
ds_read_b64_tr_b16 a[210:211], v6 offset:13440
v_mfma_f32_16x16x32_bf16 v[68:71], a[220:223], a[152:155], v[68:71]
v_mfma_f32_16x16x32_bf16 v[68:71], a[216:219], a[136:139], v[68:71]
s_add_u32 m0, s67, 86592
v_mfma_f32_16x16x32_bf16 v[64:67], a[216:219], a[132:135], v[64:67]
s_add_u32 s79, s79, s70
v_mfma_f32_16x16x32_bf16 v[64:67], a[220:223], a[148:151], v[64:67]
ds_read_b64_tr_b16 a[212:213], v6 offset:29824
ds_read_b64_tr_b16 a[214:215], v6 offset:30336
v_mfma_f32_16x16x32_bf16 v[124:127], a[220:223], a[144:147], v[124:127]
buffer_load_dwordx4 v4, s[96:99], s79 offen lds
v_mfma_f32_16x16x32_bf16 v[124:127], a[216:219], a[128:131], v[124:127]
s_waitcnt lgkmcnt(8)
v_mfma_f32_16x16x32_bf16 v[120:123], a[192:195], a[128:131], v[120:123]
v_mfma_f32_16x16x32_bf16 v[120:123], a[196:199], a[144:147], v[120:123]
ds_read_b64_tr_b16 a[216:217], v6 offset:12960
ds_read_b64_tr_b16 a[218:219], v6 offset:13472
v_mfma_f32_16x16x32_bf16 v[188:191], a[196:199], a[148:151], v[188:191]
s_add_u32 m0, s67, 87648
v_mfma_f32_16x16x32_bf16 v[188:191], a[192:195], a[132:135], v[188:191]
s_add_u32 s79, s79, s70
v_mfma_f32_16x16x32_bf16 v[184:187], a[192:195], a[136:139], v[184:187]
buffer_load_dwordx4 v4, s[96:99], s79 offen lds
v_mfma_f32_16x16x32_bf16 v[184:187], a[196:199], a[152:155], v[184:187]
ds_read_b64_tr_b16 a[220:221], v6 offset:29856
ds_read_b64_tr_b16 a[222:223], v6 offset:30368
v_mfma_f32_16x16x32_bf16 v[144:147], a[196:199], a[156:159], v[144:147]
v_mfma_f32_16x16x32_bf16 v[144:147], a[192:195], a[140:143], v[144:147]
s_waitcnt lgkmcnt(8)
v_mfma_f32_16x16x32_bf16 v[252:255], a[200:203], a[140:143], v[252:255]
s_waitcnt vmcnt(21)
s_barrier
v_mfma_f32_16x16x32_bf16 v[252:255], a[204:207], a[156:159], v[252:255]
ds_read_b64_tr_b16 a[192:193], v6 offset:33792
ds_read_b64_tr_b16 a[194:195], v6 offset:34304
v_mfma_f32_16x16x32_bf16 v[248:251], a[204:207], a[152:155], v[248:251]
v_mfma_f32_16x16x32_bf16 v[248:251], a[200:203], a[136:139], v[248:251]
v_mfma_f32_16x16x32_bf16 v[40:43], a[200:203], a[132:135], v[40:43]
v_mfma_f32_16x16x32_bf16 v[40:43], a[204:207], a[148:151], v[40:43]
ds_read_b64_tr_b16 a[196:197], v6 offset:50688
ds_read_b64_tr_b16 a[198:199], v6 offset:51200
v_mfma_f32_16x16x32_bf16 v[36:39], a[204:207], a[144:147], v[36:39]
buffer_store_dwordx4 a[232:235], v13, s[44:47], s88 offen offset:0 sc1
v_mfma_f32_16x16x32_bf16 v[36:39], a[200:203], a[128:131], v[36:39]
s_waitcnt lgkmcnt(8)
v_mfma_f32_16x16x32_bf16 v[96:99], a[208:211], a[128:131], v[96:99]
v_mfma_f32_16x16x32_bf16 v[96:99], a[212:215], a[144:147], v[96:99]
ds_read_b64_tr_b16 a[200:201], v6 offset:33824
ds_read_b64_tr_b16 a[202:203], v6 offset:34336
v_mfma_f32_16x16x32_bf16 v[92:95], a[212:215], a[148:151], v[92:95]
v_mfma_f32_16x16x32_bf16 v[92:95], a[208:211], a[132:135], v[92:95]
v_mfma_f32_16x16x32_bf16 v[212:215], a[208:211], a[136:139], v[212:215]
v_mfma_f32_16x16x32_bf16 v[212:215], a[212:215], a[152:155], v[212:215]
ds_read_b64_tr_b16 a[204:205], v6 offset:50720
ds_read_b64_tr_b16 a[206:207], v6 offset:51232
v_mfma_f32_16x16x32_bf16 v[156:159], a[212:215], a[156:159], v[156:159]
v_mfma_f32_16x16x32_bf16 v[156:159], a[208:211], a[140:143], v[156:159]
s_waitcnt lgkmcnt(8)
v_mfma_f32_16x16x32_bf16 v[152:155], a[216:219], a[140:143], v[152:155]
buffer_store_dwordx4 a[236:239], v13, s[44:47], s88 offen offset:2048 sc1
v_mfma_f32_16x16x32_bf16 v[152:155], a[220:223], a[156:159], v[152:155]
ds_read_b64_tr_b16 a[208:209], v6 offset:34048
ds_read_b64_tr_b16 a[210:211], v6 offset:34560
v_mfma_f32_16x16x32_bf16 v[220:223], a[220:223], a[152:155], v[220:223]
v_mfma_f32_16x16x32_bf16 v[220:223], a[216:219], a[136:139], v[220:223]
v_mfma_f32_16x16x32_bf16 v[216:219], a[216:219], a[132:135], v[216:219]
v_mfma_f32_16x16x32_bf16 v[216:219], a[220:223], a[148:151], v[216:219]
ds_read_b64_tr_b16 a[212:213], v6 offset:50944
ds_read_b64_tr_b16 a[214:215], v6 offset:51456
v_mfma_f32_16x16x32_bf16 v[208:211], a[220:223], a[144:147], v[208:211]
v_mfma_f32_16x16x32_bf16 v[208:211], a[216:219], a[128:131], v[208:211]
s_waitcnt vmcnt(14) lgkmcnt(8)
v_mfma_f32_16x16x32_bf16 a[240:243], a[192:195], a[160:163], a[240:243]
v_add_u32 v3, 8192, v1
v_mfma_f32_16x16x32_bf16 a[240:243], a[196:199], a[176:179], a[240:243]
ds_read_b64_tr_b16 a[216:217], v6 offset:34080
ds_read_b64_tr_b16 a[218:219], v6 offset:34592
v_mfma_f32_16x16x32_bf16 a[244:247], a[196:199], a[180:183], a[244:247]
buffer_load_dwordx4 a[128:131], v3, s[40:43], s72 offen offset:0 sc1
v_mfma_f32_16x16x32_bf16 a[244:247], a[192:195], a[164:167], a[244:247]
v_mfma_f32_16x16x32_bf16 a[248:251], a[192:195], a[168:171], a[248:251]
v_mfma_f32_16x16x32_bf16 a[248:251], a[196:199], a[184:187], a[248:251]
ds_read_b64_tr_b16 a[220:221], v6 offset:50976
ds_read_b64_tr_b16 a[222:223], v6 offset:51488
v_mfma_f32_16x16x32_bf16 a[252:255], a[196:199], a[188:191], a[252:255]
buffer_load_dwordx4 a[144:147], v3, s[40:43], s72 offen offset:1024 sc1
v_mfma_f32_16x16x32_bf16 a[252:255], a[192:195], a[172:175], a[252:255]
s_waitcnt lgkmcnt(8)
v_mfma_f32_16x16x32_bf16 v[132:135], a[200:203], a[172:175], v[132:135]
v_mfma_f32_16x16x32_bf16 v[132:135], a[204:207], a[188:191], v[132:135]
ds_read_b64_tr_b16 a[192:193], v6 offset:38016
ds_read_b64_tr_b16 a[194:195], v6 offset:38528
v_mfma_f32_16x16x32_bf16 v[128:131], a[204:207], a[184:187], v[128:131]
buffer_load_dwordx4 a[132:135], v3, s[40:43], s73 offen offset:0 sc1
v_mfma_f32_16x16x32_bf16 v[128:131], a[200:203], a[168:171], v[128:131]
v_mfma_f32_16x16x32_bf16 v[164:167], a[200:203], a[164:167], v[164:167]
v_mfma_f32_16x16x32_bf16 v[164:167], a[204:207], a[180:183], v[164:167]
ds_read_b64_tr_b16 a[196:197], v6 offset:54912
ds_read_b64_tr_b16 a[198:199], v6 offset:55424
v_mfma_f32_16x16x32_bf16 v[160:163], a[204:207], a[176:179], v[160:163]
buffer_load_dwordx4 a[148:151], v3, s[40:43], s73 offen offset:1024 sc1
v_mfma_f32_16x16x32_bf16 v[160:163], a[200:203], a[160:163], v[160:163]
s_waitcnt lgkmcnt(8)
v_mfma_f32_16x16x32_bf16 v[196:199], a[208:211], a[160:163], v[196:199]
v_mfma_f32_16x16x32_bf16 v[196:199], a[212:215], a[176:179], v[196:199]
ds_read_b64_tr_b16 a[200:201], v6 offset:38048
ds_read_b64_tr_b16 a[202:203], v6 offset:38560
v_mfma_f32_16x16x32_bf16 v[192:195], a[212:215], a[180:183], v[192:195]
buffer_load_dwordx4 a[136:139], v3, s[40:43], s74 offen offset:0 sc1
v_mfma_f32_16x16x32_bf16 v[192:195], a[208:211], a[164:167], v[192:195]
v_mfma_f32_16x16x32_bf16 v[16:19], a[208:211], a[168:171], v[16:19]
v_mfma_f32_16x16x32_bf16 v[16:19], a[212:215], a[184:187], v[16:19]
ds_read_b64_tr_b16 a[204:205], v6 offset:54944
ds_read_b64_tr_b16 a[206:207], v6 offset:55456
v_mfma_f32_16x16x32_bf16 v[228:231], a[212:215], a[188:191], v[228:231]
buffer_load_dwordx4 a[152:155], v3, s[40:43], s74 offen offset:1024 sc1
v_mfma_f32_16x16x32_bf16 v[228:231], a[208:211], a[172:175], v[228:231]
s_waitcnt lgkmcnt(8)
v_mfma_f32_16x16x32_bf16 v[224:227], a[216:219], a[172:175], v[224:227]
v_mfma_f32_16x16x32_bf16 v[224:227], a[220:223], a[188:191], v[224:227]
ds_read_b64_tr_b16 a[208:209], v6 offset:38272
ds_read_b64_tr_b16 a[210:211], v6 offset:38784
v_mfma_f32_16x16x32_bf16 v[236:239], a[220:223], a[184:187], v[236:239]
buffer_load_dwordx4 a[140:143], v3, s[40:43], s75 offen offset:0 sc1
v_mfma_f32_16x16x32_bf16 v[236:239], a[216:219], a[168:171], v[236:239]
v_mfma_f32_16x16x32_bf16 v[44:47], a[216:219], a[164:167], v[44:47]
v_mfma_f32_16x16x32_bf16 v[44:47], a[220:223], a[180:183], v[44:47]
ds_read_b64_tr_b16 a[212:213], v6 offset:55168
ds_read_b64_tr_b16 a[214:215], v6 offset:55680
v_mfma_f32_16x16x32_bf16 v[232:235], a[220:223], a[176:179], v[232:235]
buffer_load_dwordx4 a[156:159], v3, s[40:43], s75 offen offset:1024 sc1
v_mfma_f32_16x16x32_bf16 v[232:235], a[216:219], a[160:163], v[232:235]
s_waitcnt lgkmcnt(8)
v_mfma_f32_16x16x32_bf16 v[204:207], a[192:195], a[160:163], v[204:207]
v_mfma_f32_16x16x32_bf16 v[204:207], a[196:199], a[176:179], v[204:207]
ds_read_b64_tr_b16 a[216:217], v6 offset:38304
ds_read_b64_tr_b16 a[218:219], v6 offset:38816
v_mfma_f32_16x16x32_bf16 v[200:203], a[196:199], a[180:183], v[200:203]
s_add_u32 s10, s76, 32768
v_mfma_f32_16x16x32_bf16 v[200:203], a[192:195], a[164:167], v[200:203]
buffer_store_dwordx4 a[0:3], v1, s[44:47], s10 offen sc1
v_mfma_f32_16x16x32_bf16 v[72:75], a[192:195], a[168:171], v[72:75]
s_add_u32 m0, s67, 101376
v_mfma_f32_16x16x32_bf16 v[72:75], a[196:199], a[184:187], v[72:75]
ds_read_b64_tr_b16 a[220:221], v6 offset:55200
ds_read_b64_tr_b16 a[222:223], v6 offset:55712
v_mfma_f32_16x16x32_bf16 v[172:175], a[196:199], a[188:191], v[172:175]
s_add_u32 s79, s79, s70
v_mfma_f32_16x16x32_bf16 v[172:175], a[192:195], a[172:175], v[172:175]
s_waitcnt lgkmcnt(8)
v_mfma_f32_16x16x32_bf16 v[168:171], a[200:203], a[172:175], v[168:171]
buffer_load_dwordx4 v4, s[96:99], s79 offen lds
v_mfma_f32_16x16x32_bf16 v[168:171], a[204:207], a[188:191], v[168:171]
ds_read_b64_tr_b16 a[192:193], v6 offset:42240
ds_read_b64_tr_b16 a[194:195], v6 offset:42752
v_mfma_f32_16x16x32_bf16 v[140:143], a[204:207], a[184:187], v[140:143]
v_mfma_f32_16x16x32_bf16 v[140:143], a[200:203], a[168:171], v[140:143]
s_add_u32 m0, s67, 102432
v_mfma_f32_16x16x32_bf16 v[100:103], a[200:203], a[164:167], v[100:103]
s_add_u32 s79, s79, s70
v_mfma_f32_16x16x32_bf16 v[100:103], a[204:207], a[180:183], v[100:103]
ds_read_b64_tr_b16 a[196:197], v6 offset:59136
ds_read_b64_tr_b16 a[198:199], v6 offset:59648
v_mfma_f32_16x16x32_bf16 v[136:139], a[204:207], a[176:179], v[136:139]
buffer_load_dwordx4 v4, s[96:99], s79 offen lds
v_mfma_f32_16x16x32_bf16 v[136:139], a[200:203], a[160:163], v[136:139]
s_waitcnt lgkmcnt(8)
v_mfma_f32_16x16x32_bf16 v[108:111], a[208:211], a[160:163], v[108:111]
v_mfma_f32_16x16x32_bf16 v[108:111], a[212:215], a[176:179], v[108:111]
ds_read_b64_tr_b16 a[200:201], v6 offset:42272
ds_read_b64_tr_b16 a[202:203], v6 offset:42784
v_mfma_f32_16x16x32_bf16 v[104:107], a[212:215], a[180:183], v[104:107]
v_mfma_f32_16x16x32_bf16 v[104:107], a[208:211], a[164:167], v[104:107]
s_add_u32 s10, s76, 36864
v_mfma_f32_16x16x32_bf16 v[80:83], a[208:211], a[168:171], v[80:83]
buffer_store_dwordx4 a[4:7], v1, s[44:47], s10 offen sc1
v_mfma_f32_16x16x32_bf16 v[80:83], a[212:215], a[184:187], v[80:83]
ds_read_b64_tr_b16 a[204:205], v6 offset:59168
ds_read_b64_tr_b16 a[206:207], v6 offset:59680
v_mfma_f32_16x16x32_bf16 v[76:79], a[212:215], a[188:191], v[76:79]
s_add_u32 m0, s67, 103488
v_mfma_f32_16x16x32_bf16 v[76:79], a[208:211], a[172:175], v[76:79]
s_waitcnt lgkmcnt(8)
v_mfma_f32_16x16x32_bf16 v[52:55], a[216:219], a[172:175], v[52:55]
s_add_u32 s79, s79, s70
v_mfma_f32_16x16x32_bf16 v[52:55], a[220:223], a[188:191], v[52:55]
ds_read_b64_tr_b16 a[208:209], v6 offset:42496
ds_read_b64_tr_b16 a[210:211], v6 offset:43008
v_mfma_f32_16x16x32_bf16 v[48:51], a[220:223], a[184:187], v[48:51]
buffer_load_dwordx4 v4, s[96:99], s79 offen lds
v_mfma_f32_16x16x32_bf16 v[48:51], a[216:219], a[168:171], v[48:51]
v_mfma_f32_16x16x32_bf16 v[24:27], a[216:219], a[164:167], v[24:27]
s_add_u32 m0, s67, 104544
v_mfma_f32_16x16x32_bf16 v[24:27], a[220:223], a[180:183], v[24:27]
ds_read_b64_tr_b16 a[212:213], v6 offset:59392
ds_read_b64_tr_b16 a[214:215], v6 offset:59904
v_mfma_f32_16x16x32_bf16 v[20:23], a[220:223], a[176:179], v[20:23]
s_add_u32 s79, s79, s70
v_mfma_f32_16x16x32_bf16 v[20:23], a[216:219], a[160:163], v[20:23]
s_waitcnt lgkmcnt(8)
v_mfma_f32_16x16x32_bf16 v[60:63], a[192:195], a[160:163], v[60:63]
buffer_load_dwordx4 v4, s[96:99], s79 offen lds
v_mfma_f32_16x16x32_bf16 v[60:63], a[196:199], a[176:179], v[60:63]
ds_read_b64_tr_b16 a[216:217], v6 offset:42528
ds_read_b64_tr_b16 a[218:219], v6 offset:43040
v_mfma_f32_16x16x32_bf16 v[32:35], a[196:199], a[180:183], v[32:35]
v_mfma_f32_16x16x32_bf16 v[32:35], a[192:195], a[164:167], v[32:35]
v_mfma_f32_16x16x32_bf16 v[56:59], a[192:195], a[168:171], v[56:59]
s_add_u32 s10, s76, 40960
v_mfma_f32_16x16x32_bf16 v[56:59], a[196:199], a[184:187], v[56:59]
ds_read_b64_tr_b16 a[220:221], v6 offset:59424
ds_read_b64_tr_b16 a[222:223], v6 offset:59936
v_mfma_f32_16x16x32_bf16 v[28:31], a[196:199], a[188:191], v[28:31]
buffer_store_dwordx4 a[8:11], v1, s[44:47], s10 offen sc1
v_mfma_f32_16x16x32_bf16 v[28:31], a[192:195], a[172:175], v[28:31]
s_waitcnt lgkmcnt(8)
v_mfma_f32_16x16x32_bf16 v[116:119], a[200:203], a[172:175], v[116:119]
v_mfma_f32_16x16x32_bf16 v[116:119], a[204:207], a[188:191], v[116:119]
ds_read_b64_tr_b16 a[192:193], v6 offset:46464
ds_read_b64_tr_b16 a[194:195], v6 offset:46976
v_mfma_f32_16x16x32_bf16 v[88:91], a[204:207], a[184:187], v[88:91]
s_add_u32 m0, s67, 118272
v_mfma_f32_16x16x32_bf16 v[88:91], a[200:203], a[168:171], v[88:91]
s_add_u32 s79, s79, s70
v_mfma_f32_16x16x32_bf16 v[112:115], a[200:203], a[164:167], v[112:115]
buffer_load_dwordx4 v4, s[96:99], s79 offen lds
v_mfma_f32_16x16x32_bf16 v[112:115], a[204:207], a[180:183], v[112:115]
ds_read_b64_tr_b16 a[196:197], v6 offset:63360
ds_read_b64_tr_b16 a[198:199], v6 offset:63872
v_mfma_f32_16x16x32_bf16 v[84:87], a[204:207], a[176:179], v[84:87]
s_add_u32 m0, s67, 119328
v_mfma_f32_16x16x32_bf16 v[84:87], a[200:203], a[160:163], v[84:87]
s_waitcnt lgkmcnt(8)
v_mfma_f32_16x16x32_bf16 v[180:183], a[208:211], a[160:163], v[180:183]
s_add_u32 s79, s79, s70
v_mfma_f32_16x16x32_bf16 v[180:183], a[212:215], a[176:179], v[180:183]
ds_read_b64_tr_b16 a[200:201], v6 offset:46496
ds_read_b64_tr_b16 a[202:203], v6 offset:47008
v_mfma_f32_16x16x32_bf16 v[176:179], a[212:215], a[180:183], v[176:179]
buffer_load_dwordx4 v4, s[96:99], s79 offen lds
v_mfma_f32_16x16x32_bf16 v[176:179], a[208:211], a[164:167], v[176:179]
v_mfma_f32_16x16x32_bf16 v[244:247], a[208:211], a[168:171], v[244:247]
v_mfma_f32_16x16x32_bf16 v[244:247], a[212:215], a[184:187], v[244:247]
ds_read_b64_tr_b16 a[204:205], v6 offset:63392
ds_read_b64_tr_b16 a[206:207], v6 offset:63904
v_mfma_f32_16x16x32_bf16 v[240:243], a[212:215], a[188:191], v[240:243]
s_add_u32 s10, s76, 45056
v_mfma_f32_16x16x32_bf16 v[240:243], a[208:211], a[172:175], v[240:243]
s_waitcnt lgkmcnt(8)
v_mfma_f32_16x16x32_bf16 v[148:151], a[216:219], a[172:175], v[148:151]
buffer_store_dwordx4 a[12:15], v1, s[44:47], s10 offen sc1
v_mfma_f32_16x16x32_bf16 v[148:151], a[220:223], a[188:191], v[148:151]
ds_read_b64_tr_b16 a[208:209], v6 offset:46720
ds_read_b64_tr_b16 a[210:211], v6 offset:47232
v_mfma_f32_16x16x32_bf16 v[68:71], a[220:223], a[184:187], v[68:71]
v_mfma_f32_16x16x32_bf16 v[68:71], a[216:219], a[168:171], v[68:71]
s_add_u32 m0, s67, 120384
v_mfma_f32_16x16x32_bf16 v[64:67], a[216:219], a[164:167], v[64:67]
s_add_u32 s79, s79, s70
v_mfma_f32_16x16x32_bf16 v[64:67], a[220:223], a[180:183], v[64:67]
ds_read_b64_tr_b16 a[212:213], v6 offset:63616
ds_read_b64_tr_b16 a[214:215], v6 offset:64128
v_mfma_f32_16x16x32_bf16 v[124:127], a[220:223], a[176:179], v[124:127]
buffer_load_dwordx4 v4, s[96:99], s79 offen lds
v_mfma_f32_16x16x32_bf16 v[124:127], a[216:219], a[160:163], v[124:127]
s_waitcnt lgkmcnt(8)
v_mfma_f32_16x16x32_bf16 v[120:123], a[192:195], a[160:163], v[120:123]
v_mfma_f32_16x16x32_bf16 v[120:123], a[196:199], a[176:179], v[120:123]
ds_read_b64_tr_b16 a[216:217], v6 offset:46752
ds_read_b64_tr_b16 a[218:219], v6 offset:47264
v_mfma_f32_16x16x32_bf16 v[188:191], a[196:199], a[180:183], v[188:191]
s_add_u32 m0, s67, 121440
v_mfma_f32_16x16x32_bf16 v[188:191], a[192:195], a[164:167], v[188:191]
s_add_u32 s79, s79, s70
v_mfma_f32_16x16x32_bf16 v[184:187], a[192:195], a[168:171], v[184:187]
buffer_load_dwordx4 v4, s[96:99], s79 offen lds
v_mfma_f32_16x16x32_bf16 v[184:187], a[196:199], a[184:187], v[184:187]
ds_read_b64_tr_b16 a[220:221], v6 offset:63648
ds_read_b64_tr_b16 a[222:223], v6 offset:64160
v_mfma_f32_16x16x32_bf16 v[144:147], a[196:199], a[188:191], v[144:147]
v_mfma_f32_16x16x32_bf16 v[144:147], a[192:195], a[172:175], v[144:147]
s_waitcnt lgkmcnt(8)
v_mfma_f32_16x16x32_bf16 v[252:255], a[200:203], a[172:175], v[252:255]
s_waitcnt vmcnt(22)
s_barrier
v_mfma_f32_16x16x32_bf16 v[252:255], a[204:207], a[188:191], v[252:255]
ds_read_b64_tr_b16 a[192:193], v7 offset:0
ds_read_b64_tr_b16 a[194:195], v7 offset:512
v_mfma_f32_16x16x32_bf16 v[248:251], a[204:207], a[184:187], v[248:251]
v_mfma_f32_16x16x32_bf16 v[248:251], a[200:203], a[168:171], v[248:251]
v_mfma_f32_16x16x32_bf16 v[40:43], a[200:203], a[164:167], v[40:43]
v_add_u32 v3, 18432, v1
v_mfma_f32_16x16x32_bf16 v[40:43], a[204:207], a[180:183], v[40:43]
ds_read_b64_tr_b16 a[196:197], v7 offset:16896
ds_read_b64_tr_b16 a[198:199], v7 offset:17408
v_mfma_f32_16x16x32_bf16 v[36:39], a[204:207], a[176:179], v[36:39]
buffer_load_dwordx4 a[96:99], v3, s[40:43], s72 offen offset:0 sc1
v_mfma_f32_16x16x32_bf16 v[36:39], a[200:203], a[160:163], v[36:39]
s_waitcnt lgkmcnt(8)
v_mfma_f32_16x16x32_bf16 v[96:99], a[208:211], a[160:163], v[96:99]
v_mfma_f32_16x16x32_bf16 v[96:99], a[212:215], a[176:179], v[96:99]
ds_read_b64_tr_b16 a[200:201], v7 offset:32
ds_read_b64_tr_b16 a[202:203], v7 offset:544
v_mfma_f32_16x16x32_bf16 v[92:95], a[212:215], a[180:183], v[92:95]
v_mfma_f32_16x16x32_bf16 v[92:95], a[208:211], a[164:167], v[92:95]
v_mfma_f32_16x16x32_bf16 v[212:215], a[208:211], a[168:171], v[212:215]
v_mfma_f32_16x16x32_bf16 v[212:215], a[212:215], a[184:187], v[212:215]
ds_read_b64_tr_b16 a[204:205], v7 offset:16928
ds_read_b64_tr_b16 a[206:207], v7 offset:17440
v_mfma_f32_16x16x32_bf16 v[156:159], a[212:215], a[188:191], v[156:159]
v_mfma_f32_16x16x32_bf16 v[156:159], a[208:211], a[172:175], v[156:159]
s_waitcnt lgkmcnt(8)
v_mfma_f32_16x16x32_bf16 v[152:155], a[216:219], a[172:175], v[152:155]
buffer_load_dwordx4 a[112:115], v3, s[40:43], s72 offen offset:1024 sc1
v_mfma_f32_16x16x32_bf16 v[152:155], a[220:223], a[188:191], v[152:155]
ds_read_b64_tr_b16 a[208:209], v7 offset:256
ds_read_b64_tr_b16 a[210:211], v7 offset:768
v_mfma_f32_16x16x32_bf16 v[220:223], a[220:223], a[184:187], v[220:223]
v_mfma_f32_16x16x32_bf16 v[220:223], a[216:219], a[168:171], v[220:223]
v_mfma_f32_16x16x32_bf16 v[216:219], a[216:219], a[164:167], v[216:219]
v_mfma_f32_16x16x32_bf16 v[216:219], a[220:223], a[180:183], v[216:219]
ds_read_b64_tr_b16 a[212:213], v7 offset:17152
ds_read_b64_tr_b16 a[214:215], v7 offset:17664
v_mfma_f32_16x16x32_bf16 v[208:211], a[220:223], a[176:179], v[208:211]
v_mfma_f32_16x16x32_bf16 v[208:211], a[216:219], a[160:163], v[208:211]
s_waitcnt vmcnt(14) lgkmcnt(8)
v_mfma_f32_16x16x32_bf16 a[240:243], a[192:195], a[128:131], a[240:243]
v_add_u32 v3, 10240, v1
v_mfma_f32_16x16x32_bf16 a[240:243], a[196:199], a[144:147], a[240:243]
ds_read_b64_tr_b16 a[216:217], v7 offset:288
ds_read_b64_tr_b16 a[218:219], v7 offset:800
v_mfma_f32_16x16x32_bf16 a[244:247], a[196:199], a[148:151], a[244:247]
buffer_load_dwordx4 a[160:163], v3, s[40:43], s72 offen offset:0 sc1
v_mfma_f32_16x16x32_bf16 a[244:247], a[192:195], a[132:135], a[244:247]
v_mfma_f32_16x16x32_bf16 a[248:251], a[192:195], a[136:139], a[248:251]
v_mfma_f32_16x16x32_bf16 a[248:251], a[196:199], a[152:155], a[248:251]
ds_read_b64_tr_b16 a[220:221], v7 offset:17184
ds_read_b64_tr_b16 a[222:223], v7 offset:17696
v_mfma_f32_16x16x32_bf16 a[252:255], a[196:199], a[156:159], a[252:255]
buffer_load_dwordx4 a[176:179], v3, s[40:43], s72 offen offset:1024 sc1
v_mfma_f32_16x16x32_bf16 a[252:255], a[192:195], a[140:143], a[252:255]
s_waitcnt lgkmcnt(8)
v_mfma_f32_16x16x32_bf16 v[132:135], a[200:203], a[140:143], v[132:135]
v_mfma_f32_16x16x32_bf16 v[132:135], a[204:207], a[156:159], v[132:135]
ds_read_b64_tr_b16 a[192:193], v7 offset:4224
ds_read_b64_tr_b16 a[194:195], v7 offset:4736
v_mfma_f32_16x16x32_bf16 v[128:131], a[204:207], a[152:155], v[128:131]
buffer_load_dwordx4 a[164:167], v3, s[40:43], s73 offen offset:0 sc1
v_mfma_f32_16x16x32_bf16 v[128:131], a[200:203], a[136:139], v[128:131]
v_mfma_f32_16x16x32_bf16 v[164:167], a[200:203], a[132:135], v[164:167]
v_mfma_f32_16x16x32_bf16 v[164:167], a[204:207], a[148:151], v[164:167]
ds_read_b64_tr_b16 a[196:197], v7 offset:21120
ds_read_b64_tr_b16 a[198:199], v7 offset:21632
v_mfma_f32_16x16x32_bf16 v[160:163], a[204:207], a[144:147], v[160:163]
buffer_load_dwordx4 a[180:183], v3, s[40:43], s73 offen offset:1024 sc1
v_mfma_f32_16x16x32_bf16 v[160:163], a[200:203], a[128:131], v[160:163]
s_waitcnt lgkmcnt(8)
v_mfma_f32_16x16x32_bf16 v[196:199], a[208:211], a[128:131], v[196:199]
v_mfma_f32_16x16x32_bf16 v[196:199], a[212:215], a[144:147], v[196:199]
ds_read_b64_tr_b16 a[200:201], v7 offset:4256
ds_read_b64_tr_b16 a[202:203], v7 offset:4768
v_mfma_f32_16x16x32_bf16 v[192:195], a[212:215], a[148:151], v[192:195]
buffer_load_dwordx4 a[168:171], v3, s[40:43], s74 offen offset:0 sc1
v_mfma_f32_16x16x32_bf16 v[192:195], a[208:211], a[132:135], v[192:195]
v_mfma_f32_16x16x32_bf16 v[16:19], a[208:211], a[136:139], v[16:19]
v_mfma_f32_16x16x32_bf16 v[16:19], a[212:215], a[152:155], v[16:19]
ds_read_b64_tr_b16 a[204:205], v7 offset:21152
ds_read_b64_tr_b16 a[206:207], v7 offset:21664
v_mfma_f32_16x16x32_bf16 v[228:231], a[212:215], a[156:159], v[228:231]
buffer_load_dwordx4 a[184:187], v3, s[40:43], s74 offen offset:1024 sc1
v_mfma_f32_16x16x32_bf16 v[228:231], a[208:211], a[140:143], v[228:231]
s_waitcnt lgkmcnt(8)
v_mfma_f32_16x16x32_bf16 v[224:227], a[216:219], a[140:143], v[224:227]
v_mfma_f32_16x16x32_bf16 v[224:227], a[220:223], a[156:159], v[224:227]
ds_read_b64_tr_b16 a[208:209], v7 offset:4480
ds_read_b64_tr_b16 a[210:211], v7 offset:4992
v_mfma_f32_16x16x32_bf16 v[236:239], a[220:223], a[152:155], v[236:239]
buffer_load_dwordx4 a[172:175], v3, s[40:43], s75 offen offset:0 sc1
v_mfma_f32_16x16x32_bf16 v[236:239], a[216:219], a[136:139], v[236:239]
v_mfma_f32_16x16x32_bf16 v[44:47], a[216:219], a[132:135], v[44:47]
v_mfma_f32_16x16x32_bf16 v[44:47], a[220:223], a[148:151], v[44:47]
ds_read_b64_tr_b16 a[212:213], v7 offset:21376
ds_read_b64_tr_b16 a[214:215], v7 offset:21888
v_mfma_f32_16x16x32_bf16 v[232:235], a[220:223], a[144:147], v[232:235]
buffer_load_dwordx4 a[188:191], v3, s[40:43], s75 offen offset:1024 sc1
v_mfma_f32_16x16x32_bf16 v[232:235], a[216:219], a[128:131], v[232:235]
s_waitcnt lgkmcnt(8)
v_mfma_f32_16x16x32_bf16 v[204:207], a[192:195], a[128:131], v[204:207]
Lpad3:
s_cbranch_execz Lpad7
v_mfma_f32_16x16x32_bf16 v[204:207], a[196:199], a[144:147], v[204:207]
ds_read_b64_tr_b16 a[216:217], v7 offset:4512
ds_read_b64_tr_b16 a[218:219], v7 offset:5024
v_mfma_f32_16x16x32_bf16 v[200:203], a[196:199], a[148:151], v[200:203]
s_add_u32 s10, s76, 46080
v_mfma_f32_16x16x32_bf16 v[200:203], a[192:195], a[132:135], v[200:203]
buffer_store_dwordx4 a[16:19], v1, s[44:47], s10 offen sc1
v_mfma_f32_16x16x32_bf16 v[72:75], a[192:195], a[136:139], v[72:75]
s_add_u32 m0, s67, 0
v_mfma_f32_16x16x32_bf16 v[72:75], a[196:199], a[152:155], v[72:75]
ds_read_b64_tr_b16 a[220:221], v7 offset:21408
ds_read_b64_tr_b16 a[222:223], v7 offset:21920
v_mfma_f32_16x16x32_bf16 v[172:175], a[196:199], a[156:159], v[172:175]
s_add_u32 s79, s79, s70
v_mfma_f32_16x16x32_bf16 v[172:175], a[192:195], a[140:143], v[172:175]
s_waitcnt lgkmcnt(8)
v_mfma_f32_16x16x32_bf16 v[168:171], a[200:203], a[140:143], v[168:171]
buffer_load_dwordx4 v4, s[96:99], s79 offen lds
v_mfma_f32_16x16x32_bf16 v[168:171], a[204:207], a[156:159], v[168:171]
ds_read_b64_tr_b16 a[192:193], v7 offset:8448
ds_read_b64_tr_b16 a[194:195], v7 offset:8960
v_mfma_f32_16x16x32_bf16 v[140:143], a[204:207], a[152:155], v[140:143]
v_mfma_f32_16x16x32_bf16 v[140:143], a[200:203], a[136:139], v[140:143]
s_add_u32 m0, s67, 1056
v_mfma_f32_16x16x32_bf16 v[100:103], a[200:203], a[132:135], v[100:103]
s_add_u32 s79, s79, s70
v_mfma_f32_16x16x32_bf16 v[100:103], a[204:207], a[148:151], v[100:103]
ds_read_b64_tr_b16 a[196:197], v7 offset:25344
ds_read_b64_tr_b16 a[198:199], v7 offset:25856
v_mfma_f32_16x16x32_bf16 v[136:139], a[204:207], a[144:147], v[136:139]
buffer_load_dwordx4 v4, s[96:99], s79 offen lds
v_mfma_f32_16x16x32_bf16 v[136:139], a[200:203], a[128:131], v[136:139]
s_waitcnt lgkmcnt(8)
v_mfma_f32_16x16x32_bf16 v[108:111], a[208:211], a[128:131], v[108:111]
v_mfma_f32_16x16x32_bf16 v[108:111], a[212:215], a[144:147], v[108:111]
ds_read_b64_tr_b16 a[200:201], v7 offset:8480
ds_read_b64_tr_b16 a[202:203], v7 offset:8992
v_mfma_f32_16x16x32_bf16 v[104:107], a[212:215], a[148:151], v[104:107]
v_mfma_f32_16x16x32_bf16 v[104:107], a[208:211], a[132:135], v[104:107]
s_add_u32 s10, s76, 41984
v_mfma_f32_16x16x32_bf16 v[80:83], a[208:211], a[136:139], v[80:83]
buffer_store_dwordx4 a[20:23], v1, s[44:47], s10 offen sc1
v_mfma_f32_16x16x32_bf16 v[80:83], a[212:215], a[152:155], v[80:83]
ds_read_b64_tr_b16 a[204:205], v7 offset:25376
ds_read_b64_tr_b16 a[206:207], v7 offset:25888
v_mfma_f32_16x16x32_bf16 v[76:79], a[212:215], a[156:159], v[76:79]
s_add_u32 m0, s67, 2112
v_mfma_f32_16x16x32_bf16 v[76:79], a[208:211], a[140:143], v[76:79]
s_waitcnt lgkmcnt(8)
v_mfma_f32_16x16x32_bf16 v[52:55], a[216:219], a[140:143], v[52:55]
s_add_u32 s79, s79, s70
v_mfma_f32_16x16x32_bf16 v[52:55], a[220:223], a[156:159], v[52:55]
ds_read_b64_tr_b16 a[208:209], v7 offset:8704
ds_read_b64_tr_b16 a[210:211], v7 offset:9216
v_mfma_f32_16x16x32_bf16 v[48:51], a[220:223], a[152:155], v[48:51]
buffer_load_dwordx4 v4, s[96:99], s79 offen lds
v_mfma_f32_16x16x32_bf16 v[48:51], a[216:219], a[136:139], v[48:51]
v_mfma_f32_16x16x32_bf16 v[24:27], a[216:219], a[132:135], v[24:27]
s_add_u32 m0, s67, 3168
v_mfma_f32_16x16x32_bf16 v[24:27], a[220:223], a[148:151], v[24:27]
ds_read_b64_tr_b16 a[212:213], v7 offset:25600
ds_read_b64_tr_b16 a[214:215], v7 offset:26112
v_mfma_f32_16x16x32_bf16 v[20:23], a[220:223], a[144:147], v[20:23]
s_add_u32 s79, s79, s70
v_mfma_f32_16x16x32_bf16 v[20:23], a[216:219], a[128:131], v[20:23]
s_waitcnt lgkmcnt(8)
v_mfma_f32_16x16x32_bf16 v[60:63], a[192:195], a[128:131], v[60:63]
buffer_load_dwordx4 v4, s[96:99], s79 offen lds
v_mfma_f32_16x16x32_bf16 v[60:63], a[196:199], a[144:147], v[60:63]
ds_read_b64_tr_b16 a[216:217], v7 offset:8736
ds_read_b64_tr_b16 a[218:219], v7 offset:9248
v_mfma_f32_16x16x32_bf16 v[32:35], a[196:199], a[148:151], v[32:35]
v_mfma_f32_16x16x32_bf16 v[32:35], a[192:195], a[132:135], v[32:35]
v_mfma_f32_16x16x32_bf16 v[56:59], a[192:195], a[136:139], v[56:59]
s_add_u32 s10, s76, 37888
v_mfma_f32_16x16x32_bf16 v[56:59], a[196:199], a[152:155], v[56:59]
ds_read_b64_tr_b16 a[220:221], v7 offset:25632
ds_read_b64_tr_b16 a[222:223], v7 offset:26144
v_mfma_f32_16x16x32_bf16 v[28:31], a[196:199], a[156:159], v[28:31]
buffer_store_dwordx4 a[24:27], v1, s[44:47], s10 offen sc1
v_mfma_f32_16x16x32_bf16 v[28:31], a[192:195], a[140:143], v[28:31]
s_waitcnt lgkmcnt(8)
v_mfma_f32_16x16x32_bf16 v[116:119], a[200:203], a[140:143], v[116:119]
v_mfma_f32_16x16x32_bf16 v[116:119], a[204:207], a[156:159], v[116:119]
ds_read_b64_tr_b16 a[192:193], v7 offset:12672
ds_read_b64_tr_b16 a[194:195], v7 offset:13184
v_mfma_f32_16x16x32_bf16 v[88:91], a[204:207], a[152:155], v[88:91]
s_add_u32 m0, s67, 16896
v_mfma_f32_16x16x32_bf16 v[88:91], a[200:203], a[136:139], v[88:91]
s_add_u32 s79, s79, s70
v_mfma_f32_16x16x32_bf16 v[112:115], a[200:203], a[132:135], v[112:115]
buffer_load_dwordx4 v4, s[96:99], s79 offen lds
v_mfma_f32_16x16x32_bf16 v[112:115], a[204:207], a[148:151], v[112:115]
ds_read_b64_tr_b16 a[196:197], v7 offset:29568
ds_read_b64_tr_b16 a[198:199], v7 offset:30080
v_mfma_f32_16x16x32_bf16 v[84:87], a[204:207], a[144:147], v[84:87]
s_add_u32 m0, s67, 17952
v_mfma_f32_16x16x32_bf16 v[84:87], a[200:203], a[128:131], v[84:87]
s_waitcnt lgkmcnt(8)
v_mfma_f32_16x16x32_bf16 v[180:183], a[208:211], a[128:131], v[180:183]
s_add_u32 s79, s79, s70
v_mfma_f32_16x16x32_bf16 v[180:183], a[212:215], a[144:147], v[180:183]
ds_read_b64_tr_b16 a[200:201], v7 offset:12704
ds_read_b64_tr_b16 a[202:203], v7 offset:13216
v_mfma_f32_16x16x32_bf16 v[176:179], a[212:215], a[148:151], v[176:179]
buffer_load_dwordx4 v4, s[96:99], s79 offen lds
v_mfma_f32_16x16x32_bf16 v[176:179], a[208:211], a[132:135], v[176:179]
v_mfma_f32_16x16x32_bf16 v[244:247], a[208:211], a[136:139], v[244:247]
v_mfma_f32_16x16x32_bf16 v[244:247], a[212:215], a[152:155], v[244:247]
ds_read_b64_tr_b16 a[204:205], v7 offset:29600
ds_read_b64_tr_b16 a[206:207], v7 offset:30112
v_mfma_f32_16x16x32_bf16 v[240:243], a[212:215], a[156:159], v[240:243]
s_add_u32 s10, s76, 33792
v_mfma_f32_16x16x32_bf16 v[240:243], a[208:211], a[140:143], v[240:243]
s_waitcnt lgkmcnt(8)
v_mfma_f32_16x16x32_bf16 v[148:151], a[216:219], a[140:143], v[148:151]
buffer_store_dwordx4 a[28:31], v1, s[44:47], s10 offen sc1
v_mfma_f32_16x16x32_bf16 v[148:151], a[220:223], a[156:159], v[148:151]
ds_read_b64_tr_b16 a[208:209], v7 offset:12928
ds_read_b64_tr_b16 a[210:211], v7 offset:13440
v_mfma_f32_16x16x32_bf16 v[68:71], a[220:223], a[152:155], v[68:71]
v_mfma_f32_16x16x32_bf16 v[68:71], a[216:219], a[136:139], v[68:71]
s_add_u32 m0, s67, 19008
v_mfma_f32_16x16x32_bf16 v[64:67], a[216:219], a[132:135], v[64:67]
s_add_u32 s79, s79, s70
v_mfma_f32_16x16x32_bf16 v[64:67], a[220:223], a[148:151], v[64:67]
ds_read_b64_tr_b16 a[212:213], v7 offset:29824
ds_read_b64_tr_b16 a[214:215], v7 offset:30336
v_mfma_f32_16x16x32_bf16 v[124:127], a[220:223], a[144:147], v[124:127]
buffer_load_dwordx4 v4, s[96:99], s79 offen lds
v_mfma_f32_16x16x32_bf16 v[124:127], a[216:219], a[128:131], v[124:127]
s_waitcnt lgkmcnt(8)
v_mfma_f32_16x16x32_bf16 v[120:123], a[192:195], a[128:131], v[120:123]
v_mfma_f32_16x16x32_bf16 v[120:123], a[196:199], a[144:147], v[120:123]
ds_read_b64_tr_b16 a[216:217], v7 offset:12960
ds_read_b64_tr_b16 a[218:219], v7 offset:13472
v_mfma_f32_16x16x32_bf16 v[188:191], a[196:199], a[148:151], v[188:191]
s_add_u32 m0, s67, 20064
v_mfma_f32_16x16x32_bf16 v[188:191], a[192:195], a[132:135], v[188:191]
s_add_u32 s79, s79, s70
v_mfma_f32_16x16x32_bf16 v[184:187], a[192:195], a[136:139], v[184:187]
buffer_load_dwordx4 v4, s[96:99], s79 offen lds
v_mfma_f32_16x16x32_bf16 v[184:187], a[196:199], a[152:155], v[184:187]
ds_read_b64_tr_b16 a[220:221], v7 offset:29856
ds_read_b64_tr_b16 a[222:223], v7 offset:30368
v_mfma_f32_16x16x32_bf16 v[144:147], a[196:199], a[156:159], v[144:147]
v_mfma_f32_16x16x32_bf16 v[144:147], a[192:195], a[140:143], v[144:147]
s_waitcnt lgkmcnt(8)
v_mfma_f32_16x16x32_bf16 v[252:255], a[200:203], a[140:143], v[252:255]
s_waitcnt vmcnt(22)
s_barrier
v_mfma_f32_16x16x32_bf16 v[252:255], a[204:207], a[156:159], v[252:255]
ds_read_b64_tr_b16 a[192:193], v7 offset:33792
ds_read_b64_tr_b16 a[194:195], v7 offset:34304
v_mfma_f32_16x16x32_bf16 v[248:251], a[204:207], a[152:155], v[248:251]
v_mfma_f32_16x16x32_bf16 v[248:251], a[200:203], a[136:139], v[248:251]
v_mfma_f32_16x16x32_bf16 v[40:43], a[200:203], a[132:135], v[40:43]
v_mfma_f32_16x16x32_bf16 v[40:43], a[204:207], a[148:151], v[40:43]
ds_read_b64_tr_b16 a[196:197], v7 offset:50688
ds_read_b64_tr_b16 a[198:199], v7 offset:51200
v_mfma_f32_16x16x32_bf16 v[36:39], a[204:207], a[144:147], v[36:39]
v_mfma_f32_16x16x32_bf16 v[36:39], a[200:203], a[128:131], v[36:39]
s_waitcnt lgkmcnt(8)
v_mfma_f32_16x16x32_bf16 v[96:99], a[208:211], a[128:131], v[96:99]
v_mfma_f32_16x16x32_bf16 v[96:99], a[212:215], a[144:147], v[96:99]
ds_read_b64_tr_b16 a[200:201], v7 offset:33824
ds_read_b64_tr_b16 a[202:203], v7 offset:34336
v_mfma_f32_16x16x32_bf16 v[92:95], a[212:215], a[148:151], v[92:95]
v_mfma_f32_16x16x32_bf16 v[92:95], a[208:211], a[132:135], v[92:95]
v_accvgpr_write_b32 a239, -1
v_accvgpr_write_b32 a238, -1
v_mfma_f32_16x16x32_bf16 v[212:215], a[208:211], a[136:139], v[212:215]
v_accvgpr_write_b32 a237, -1
v_accvgpr_write_b32 a236, -1
v_mfma_f32_16x16x32_bf16 v[212:215], a[212:215], a[152:155], v[212:215]
ds_read_b64_tr_b16 a[204:205], v7 offset:50720
ds_read_b64_tr_b16 a[206:207], v7 offset:51232
v_mfma_f32_16x16x32_bf16 v[156:159], a[212:215], a[156:159], v[156:159]
v_mfma_f32_16x16x32_bf16 v[156:159], a[208:211], a[140:143], v[156:159]
s_waitcnt lgkmcnt(8)
v_mfma_f32_16x16x32_bf16 v[152:155], a[216:219], a[140:143], v[152:155]
v_mfma_f32_16x16x32_bf16 v[152:155], a[220:223], a[156:159], v[152:155]
ds_read_b64_tr_b16 a[208:209], v7 offset:34048
ds_read_b64_tr_b16 a[210:211], v7 offset:34560
v_mfma_f32_16x16x32_bf16 v[220:223], a[220:223], a[152:155], v[220:223]
v_mfma_f32_16x16x32_bf16 v[220:223], a[216:219], a[136:139], v[220:223]
v_mfma_f32_16x16x32_bf16 v[216:219], a[216:219], a[132:135], v[216:219]
v_mfma_f32_16x16x32_bf16 v[216:219], a[220:223], a[148:151], v[216:219]
ds_read_b64_tr_b16 a[212:213], v7 offset:50944
ds_read_b64_tr_b16 a[214:215], v7 offset:51456
v_mfma_f32_16x16x32_bf16 v[208:211], a[220:223], a[144:147], v[208:211]
v_mfma_f32_16x16x32_bf16 v[208:211], a[216:219], a[128:131], v[208:211]
s_waitcnt vmcnt(12) lgkmcnt(8)
v_mfma_f32_16x16x32_bf16 a[240:243], a[192:195], a[160:163], a[240:243]
v_add_u32 v3, 12288, v1
v_mfma_f32_16x16x32_bf16 a[240:243], a[196:199], a[176:179], a[240:243]
ds_read_b64_tr_b16 a[216:217], v7 offset:34080
ds_read_b64_tr_b16 a[218:219], v7 offset:34592
v_mfma_f32_16x16x32_bf16 a[244:247], a[196:199], a[180:183], a[244:247]
buffer_load_dwordx4 a[128:131], v3, s[40:43], s72 offen offset:0 sc1
v_mfma_f32_16x16x32_bf16 a[244:247], a[192:195], a[164:167], a[244:247]
v_mfma_f32_16x16x32_bf16 a[248:251], a[192:195], a[168:171], a[248:251]
v_mfma_f32_16x16x32_bf16 a[248:251], a[196:199], a[184:187], a[248:251]
ds_read_b64_tr_b16 a[220:221], v7 offset:50976
ds_read_b64_tr_b16 a[222:223], v7 offset:51488
v_mfma_f32_16x16x32_bf16 a[252:255], a[196:199], a[188:191], a[252:255]
buffer_load_dwordx4 a[144:147], v3, s[40:43], s72 offen offset:1024 sc1
v_mfma_f32_16x16x32_bf16 a[252:255], a[192:195], a[172:175], a[252:255]
s_waitcnt lgkmcnt(8)
v_mfma_f32_16x16x32_bf16 v[132:135], a[200:203], a[172:175], v[132:135]
v_mfma_f32_16x16x32_bf16 v[132:135], a[204:207], a[188:191], v[132:135]
ds_read_b64_tr_b16 a[192:193], v7 offset:38016
ds_read_b64_tr_b16 a[194:195], v7 offset:38528
v_mfma_f32_16x16x32_bf16 v[128:131], a[204:207], a[184:187], v[128:131]
buffer_load_dwordx4 a[132:135], v3, s[40:43], s73 offen offset:0 sc1
v_mfma_f32_16x16x32_bf16 v[128:131], a[200:203], a[168:171], v[128:131]
v_mfma_f32_16x16x32_bf16 v[164:167], a[200:203], a[164:167], v[164:167]
v_mfma_f32_16x16x32_bf16 v[164:167], a[204:207], a[180:183], v[164:167]
ds_read_b64_tr_b16 a[196:197], v7 offset:54912
ds_read_b64_tr_b16 a[198:199], v7 offset:55424
v_mfma_f32_16x16x32_bf16 v[160:163], a[204:207], a[176:179], v[160:163]
buffer_load_dwordx4 a[148:151], v3, s[40:43], s73 offen offset:1024 sc1
v_mfma_f32_16x16x32_bf16 v[160:163], a[200:203], a[160:163], v[160:163]
s_waitcnt lgkmcnt(8)
v_mfma_f32_16x16x32_bf16 v[196:199], a[208:211], a[160:163], v[196:199]
v_mfma_f32_16x16x32_bf16 v[196:199], a[212:215], a[176:179], v[196:199]
ds_read_b64_tr_b16 a[200:201], v7 offset:38048
ds_read_b64_tr_b16 a[202:203], v7 offset:38560
v_mfma_f32_16x16x32_bf16 v[192:195], a[212:215], a[180:183], v[192:195]
buffer_load_dwordx4 a[136:139], v3, s[40:43], s74 offen offset:0 sc1
v_mfma_f32_16x16x32_bf16 v[192:195], a[208:211], a[164:167], v[192:195]
v_mfma_f32_16x16x32_bf16 v[16:19], a[208:211], a[168:171], v[16:19]
v_mfma_f32_16x16x32_bf16 v[16:19], a[212:215], a[184:187], v[16:19]
ds_read_b64_tr_b16 a[204:205], v7 offset:54944
ds_read_b64_tr_b16 a[206:207], v7 offset:55456
v_mfma_f32_16x16x32_bf16 v[228:231], a[212:215], a[188:191], v[228:231]
buffer_load_dwordx4 a[152:155], v3, s[40:43], s74 offen offset:1024 sc1
v_mfma_f32_16x16x32_bf16 v[228:231], a[208:211], a[172:175], v[228:231]
s_waitcnt lgkmcnt(8)
v_mfma_f32_16x16x32_bf16 v[224:227], a[216:219], a[172:175], v[224:227]
v_mfma_f32_16x16x32_bf16 v[224:227], a[220:223], a[188:191], v[224:227]
ds_read_b64_tr_b16 a[208:209], v7 offset:38272
ds_read_b64_tr_b16 a[210:211], v7 offset:38784
v_mfma_f32_16x16x32_bf16 v[236:239], a[220:223], a[184:187], v[236:239]
buffer_load_dwordx4 a[140:143], v3, s[40:43], s75 offen offset:0 sc1
v_mfma_f32_16x16x32_bf16 v[236:239], a[216:219], a[168:171], v[236:239]
v_mfma_f32_16x16x32_bf16 v[44:47], a[216:219], a[164:167], v[44:47]
v_mfma_f32_16x16x32_bf16 v[44:47], a[220:223], a[180:183], v[44:47]
ds_read_b64_tr_b16 a[212:213], v7 offset:55168
ds_read_b64_tr_b16 a[214:215], v7 offset:55680
v_mfma_f32_16x16x32_bf16 v[232:235], a[220:223], a[176:179], v[232:235]
buffer_load_dwordx4 a[156:159], v3, s[40:43], s75 offen offset:1024 sc1
v_mfma_f32_16x16x32_bf16 v[232:235], a[216:219], a[160:163], v[232:235]
s_waitcnt lgkmcnt(8)
v_mfma_f32_16x16x32_bf16 v[204:207], a[192:195], a[160:163], v[204:207]
v_mfma_f32_16x16x32_bf16 v[204:207], a[196:199], a[176:179], v[204:207]
ds_read_b64_tr_b16 a[216:217], v7 offset:38304
ds_read_b64_tr_b16 a[218:219], v7 offset:38816
v_mfma_f32_16x16x32_bf16 v[200:203], a[196:199], a[180:183], v[200:203]
s_add_u32 s10, s76, 13312
v_mfma_f32_16x16x32_bf16 v[200:203], a[192:195], a[164:167], v[200:203]
buffer_store_dwordx4 a[32:35], v1, s[44:47], s10 offen sc1
v_mfma_f32_16x16x32_bf16 v[72:75], a[192:195], a[168:171], v[72:75]
s_add_u32 m0, s67, 33792
v_mfma_f32_16x16x32_bf16 v[72:75], a[196:199], a[184:187], v[72:75]
ds_read_b64_tr_b16 a[220:221], v7 offset:55200
ds_read_b64_tr_b16 a[222:223], v7 offset:55712
v_mfma_f32_16x16x32_bf16 v[172:175], a[196:199], a[188:191], v[172:175]
s_add_u32 s79, s79, s70
v_mfma_f32_16x16x32_bf16 v[172:175], a[192:195], a[172:175], v[172:175]
s_waitcnt lgkmcnt(8)
v_mfma_f32_16x16x32_bf16 v[168:171], a[200:203], a[172:175], v[168:171]
buffer_load_dwordx4 v4, s[96:99], s79 offen lds
v_mfma_f32_16x16x32_bf16 v[168:171], a[204:207], a[188:191], v[168:171]
ds_read_b64_tr_b16 a[192:193], v7 offset:42240
ds_read_b64_tr_b16 a[194:195], v7 offset:42752
v_mfma_f32_16x16x32_bf16 v[140:143], a[204:207], a[184:187], v[140:143]
v_mfma_f32_16x16x32_bf16 v[140:143], a[200:203], a[168:171], v[140:143]
s_add_u32 m0, s67, 34848
v_mfma_f32_16x16x32_bf16 v[100:103], a[200:203], a[164:167], v[100:103]
s_add_u32 s79, s79, s70
v_mfma_f32_16x16x32_bf16 v[100:103], a[204:207], a[180:183], v[100:103]
ds_read_b64_tr_b16 a[196:197], v7 offset:59136
ds_read_b64_tr_b16 a[198:199], v7 offset:59648
v_mfma_f32_16x16x32_bf16 v[136:139], a[204:207], a[176:179], v[136:139]
buffer_load_dwordx4 v4, s[96:99], s79 offen lds
v_mfma_f32_16x16x32_bf16 v[136:139], a[200:203], a[160:163], v[136:139]
s_waitcnt lgkmcnt(8)
v_mfma_f32_16x16x32_bf16 v[108:111], a[208:211], a[160:163], v[108:111]
v_mfma_f32_16x16x32_bf16 v[108:111], a[212:215], a[176:179], v[108:111]
ds_read_b64_tr_b16 a[200:201], v7 offset:42272
ds_read_b64_tr_b16 a[202:203], v7 offset:42784
v_mfma_f32_16x16x32_bf16 v[104:107], a[212:215], a[180:183], v[104:107]
v_mfma_f32_16x16x32_bf16 v[104:107], a[208:211], a[164:167], v[104:107]
s_add_u32 s10, s76, 9216
v_mfma_f32_16x16x32_bf16 v[80:83], a[208:211], a[168:171], v[80:83]
buffer_store_dwordx4 a[36:39], v1, s[44:47], s10 offen sc1
v_mfma_f32_16x16x32_bf16 v[80:83], a[212:215], a[184:187], v[80:83]
ds_read_b64_tr_b16 a[204:205], v7 offset:59168
ds_read_b64_tr_b16 a[206:207], v7 offset:59680
v_mfma_f32_16x16x32_bf16 v[76:79], a[212:215], a[188:191], v[76:79]
s_add_u32 m0, s67, 35904
v_mfma_f32_16x16x32_bf16 v[76:79], a[208:211], a[172:175], v[76:79]
s_waitcnt lgkmcnt(8)
v_mfma_f32_16x16x32_bf16 v[52:55], a[216:219], a[172:175], v[52:55]
s_add_u32 s79, s79, s70
v_mfma_f32_16x16x32_bf16 v[52:55], a[220:223], a[188:191], v[52:55]
ds_read_b64_tr_b16 a[208:209], v7 offset:42496
ds_read_b64_tr_b16 a[210:211], v7 offset:43008
v_mfma_f32_16x16x32_bf16 v[48:51], a[220:223], a[184:187], v[48:51]
buffer_load_dwordx4 v4, s[96:99], s79 offen lds
v_mfma_f32_16x16x32_bf16 v[48:51], a[216:219], a[168:171], v[48:51]
v_mfma_f32_16x16x32_bf16 v[24:27], a[216:219], a[164:167], v[24:27]
s_add_u32 m0, s67, 36960
v_mfma_f32_16x16x32_bf16 v[24:27], a[220:223], a[180:183], v[24:27]
ds_read_b64_tr_b16 a[212:213], v7 offset:59392
ds_read_b64_tr_b16 a[214:215], v7 offset:59904
v_mfma_f32_16x16x32_bf16 v[20:23], a[220:223], a[176:179], v[20:23]
s_add_u32 s79, s79, s70
v_mfma_f32_16x16x32_bf16 v[20:23], a[216:219], a[160:163], v[20:23]
s_waitcnt lgkmcnt(8)
v_mfma_f32_16x16x32_bf16 v[60:63], a[192:195], a[160:163], v[60:63]
buffer_load_dwordx4 v4, s[96:99], s79 offen lds
v_mfma_f32_16x16x32_bf16 v[60:63], a[196:199], a[176:179], v[60:63]
ds_read_b64_tr_b16 a[216:217], v7 offset:42528
ds_read_b64_tr_b16 a[218:219], v7 offset:43040
v_mfma_f32_16x16x32_bf16 v[32:35], a[196:199], a[180:183], v[32:35]
v_mfma_f32_16x16x32_bf16 v[32:35], a[192:195], a[164:167], v[32:35]
v_mfma_f32_16x16x32_bf16 v[56:59], a[192:195], a[168:171], v[56:59]
s_add_u32 s10, s76, 5120
v_mfma_f32_16x16x32_bf16 v[56:59], a[196:199], a[184:187], v[56:59]
ds_read_b64_tr_b16 a[220:221], v7 offset:59424
ds_read_b64_tr_b16 a[222:223], v7 offset:59936
v_mfma_f32_16x16x32_bf16 v[28:31], a[196:199], a[188:191], v[28:31]
buffer_store_dwordx4 a[40:43], v1, s[44:47], s10 offen sc1
v_mfma_f32_16x16x32_bf16 v[28:31], a[192:195], a[172:175], v[28:31]
s_waitcnt lgkmcnt(8)
v_mfma_f32_16x16x32_bf16 v[116:119], a[200:203], a[172:175], v[116:119]
v_mfma_f32_16x16x32_bf16 v[116:119], a[204:207], a[188:191], v[116:119]
ds_read_b64_tr_b16 a[192:193], v7 offset:46464
ds_read_b64_tr_b16 a[194:195], v7 offset:46976
v_mfma_f32_16x16x32_bf16 v[88:91], a[204:207], a[184:187], v[88:91]
s_add_u32 m0, s67, 50688
v_mfma_f32_16x16x32_bf16 v[88:91], a[200:203], a[168:171], v[88:91]
s_add_u32 s79, s79, s70
v_mfma_f32_16x16x32_bf16 v[112:115], a[200:203], a[164:167], v[112:115]
buffer_load_dwordx4 v4, s[96:99], s79 offen lds
v_mfma_f32_16x16x32_bf16 v[112:115], a[204:207], a[180:183], v[112:115]
ds_read_b64_tr_b16 a[196:197], v7 offset:63360
ds_read_b64_tr_b16 a[198:199], v7 offset:63872
v_mfma_f32_16x16x32_bf16 v[84:87], a[204:207], a[176:179], v[84:87]
s_add_u32 m0, s67, 51744
v_mfma_f32_16x16x32_bf16 v[84:87], a[200:203], a[160:163], v[84:87]
s_waitcnt lgkmcnt(8)
v_mfma_f32_16x16x32_bf16 v[180:183], a[208:211], a[160:163], v[180:183]
s_add_u32 s79, s79, s70
v_mfma_f32_16x16x32_bf16 v[180:183], a[212:215], a[176:179], v[180:183]
ds_read_b64_tr_b16 a[200:201], v7 offset:46496
ds_read_b64_tr_b16 a[202:203], v7 offset:47008
v_mfma_f32_16x16x32_bf16 v[176:179], a[212:215], a[180:183], v[176:179]
buffer_load_dwordx4 v4, s[96:99], s79 offen lds
v_mfma_f32_16x16x32_bf16 v[176:179], a[208:211], a[164:167], v[176:179]
v_mfma_f32_16x16x32_bf16 v[244:247], a[208:211], a[168:171], v[244:247]
v_mfma_f32_16x16x32_bf16 v[244:247], a[212:215], a[184:187], v[244:247]
ds_read_b64_tr_b16 a[204:205], v7 offset:63392
ds_read_b64_tr_b16 a[206:207], v7 offset:63904
v_mfma_f32_16x16x32_bf16 v[240:243], a[212:215], a[188:191], v[240:243]
s_add_u32 s10, s76, 1024
v_mfma_f32_16x16x32_bf16 v[240:243], a[208:211], a[172:175], v[240:243]
s_waitcnt lgkmcnt(8)
v_mfma_f32_16x16x32_bf16 v[148:151], a[216:219], a[172:175], v[148:151]
buffer_store_dwordx4 a[44:47], v1, s[44:47], s10 offen sc1
v_mfma_f32_16x16x32_bf16 v[148:151], a[220:223], a[188:191], v[148:151]
ds_read_b64_tr_b16 a[208:209], v7 offset:46720
ds_read_b64_tr_b16 a[210:211], v7 offset:47232
v_mfma_f32_16x16x32_bf16 v[68:71], a[220:223], a[184:187], v[68:71]
v_mfma_f32_16x16x32_bf16 v[68:71], a[216:219], a[168:171], v[68:71]
s_add_u32 m0, s67, 52800
v_mfma_f32_16x16x32_bf16 v[64:67], a[216:219], a[164:167], v[64:67]
s_add_u32 s79, s79, s70
v_mfma_f32_16x16x32_bf16 v[64:67], a[220:223], a[180:183], v[64:67]
ds_read_b64_tr_b16 a[212:213], v7 offset:63616
ds_read_b64_tr_b16 a[214:215], v7 offset:64128
v_mfma_f32_16x16x32_bf16 v[124:127], a[220:223], a[176:179], v[124:127]
buffer_load_dwordx4 v4, s[96:99], s79 offen lds
v_mfma_f32_16x16x32_bf16 v[124:127], a[216:219], a[160:163], v[124:127]
s_waitcnt lgkmcnt(8)
v_mfma_f32_16x16x32_bf16 v[120:123], a[192:195], a[160:163], v[120:123]
v_mfma_f32_16x16x32_bf16 v[120:123], a[196:199], a[176:179], v[120:123]
ds_read_b64_tr_b16 a[216:217], v7 offset:46752
ds_read_b64_tr_b16 a[218:219], v7 offset:47264
v_mfma_f32_16x16x32_bf16 v[188:191], a[196:199], a[180:183], v[188:191]
s_add_u32 m0, s67, 53856
v_mfma_f32_16x16x32_bf16 v[188:191], a[192:195], a[164:167], v[188:191]
s_add_u32 s79, s79, s70
v_mfma_f32_16x16x32_bf16 v[184:187], a[192:195], a[168:171], v[184:187]
buffer_load_dwordx4 v4, s[96:99], s79 offen lds
v_mfma_f32_16x16x32_bf16 v[184:187], a[196:199], a[184:187], v[184:187]
ds_read_b64_tr_b16 a[220:221], v7 offset:63648
ds_read_b64_tr_b16 a[222:223], v7 offset:64160
v_mfma_f32_16x16x32_bf16 v[144:147], a[196:199], a[188:191], v[144:147]
v_mfma_f32_16x16x32_bf16 v[144:147], a[192:195], a[172:175], v[144:147]
s_waitcnt lgkmcnt(8)
v_mfma_f32_16x16x32_bf16 v[252:255], a[200:203], a[172:175], v[252:255]
s_waitcnt vmcnt(20)
s_barrier
v_mfma_f32_16x16x32_bf16 v[252:255], a[204:207], a[188:191], v[252:255]
ds_read_b64_tr_b16 a[192:193], v6 offset:0
ds_read_b64_tr_b16 a[194:195], v6 offset:512
v_mfma_f32_16x16x32_bf16 v[248:251], a[204:207], a[184:187], v[248:251]
v_mfma_f32_16x16x32_bf16 v[248:251], a[200:203], a[168:171], v[248:251]
v_mfma_f32_16x16x32_bf16 v[40:43], a[200:203], a[164:167], v[40:43]
v_add_u32 v3, 18432, v1
v_mfma_f32_16x16x32_bf16 v[40:43], a[204:207], a[180:183], v[40:43]
ds_read_b64_tr_b16 a[196:197], v6 offset:16896
ds_read_b64_tr_b16 a[198:199], v6 offset:17408
v_mfma_f32_16x16x32_bf16 v[36:39], a[204:207], a[176:179], v[36:39]
buffer_load_dwordx4 a[100:103], v3, s[40:43], s73 offen offset:0 sc1
v_mfma_f32_16x16x32_bf16 v[36:39], a[200:203], a[160:163], v[36:39]
s_waitcnt lgkmcnt(8)
v_mfma_f32_16x16x32_bf16 v[96:99], a[208:211], a[160:163], v[96:99]
v_mfma_f32_16x16x32_bf16 v[96:99], a[212:215], a[176:179], v[96:99]
ds_read_b64_tr_b16 a[200:201], v6 offset:32
ds_read_b64_tr_b16 a[202:203], v6 offset:544
v_mfma_f32_16x16x32_bf16 v[92:95], a[212:215], a[180:183], v[92:95]
v_mfma_f32_16x16x32_bf16 v[92:95], a[208:211], a[164:167], v[92:95]
v_mfma_f32_16x16x32_bf16 v[212:215], a[208:211], a[168:171], v[212:215]
v_mfma_f32_16x16x32_bf16 v[212:215], a[212:215], a[184:187], v[212:215]
ds_read_b64_tr_b16 a[204:205], v6 offset:16928
ds_read_b64_tr_b16 a[206:207], v6 offset:17440
v_mfma_f32_16x16x32_bf16 v[156:159], a[212:215], a[188:191], v[156:159]
v_mfma_f32_16x16x32_bf16 v[156:159], a[208:211], a[172:175], v[156:159]
s_waitcnt lgkmcnt(8)
v_mfma_f32_16x16x32_bf16 v[152:155], a[216:219], a[172:175], v[152:155]
buffer_load_dwordx4 a[116:119], v3, s[40:43], s73 offen offset:1024 sc1
v_mfma_f32_16x16x32_bf16 v[152:155], a[220:223], a[188:191], v[152:155]
ds_read_b64_tr_b16 a[208:209], v6 offset:256
ds_read_b64_tr_b16 a[210:211], v6 offset:768
v_mfma_f32_16x16x32_bf16 v[220:223], a[220:223], a[184:187], v[220:223]
v_mfma_f32_16x16x32_bf16 v[220:223], a[216:219], a[168:171], v[220:223]
v_mfma_f32_16x16x32_bf16 v[216:219], a[216:219], a[164:167], v[216:219]
v_mfma_f32_16x16x32_bf16 v[216:219], a[220:223], a[180:183], v[216:219]
ds_read_b64_tr_b16 a[212:213], v6 offset:17152
ds_read_b64_tr_b16 a[214:215], v6 offset:17664
v_mfma_f32_16x16x32_bf16 v[208:211], a[220:223], a[176:179], v[208:211]
v_mfma_f32_16x16x32_bf16 v[208:211], a[216:219], a[160:163], v[208:211]
s_waitcnt vmcnt(14) lgkmcnt(8)
v_mfma_f32_16x16x32_bf16 a[240:243], a[192:195], a[128:131], a[240:243]
v_add_u32 v3, 14336, v1
v_mfma_f32_16x16x32_bf16 a[240:243], a[196:199], a[144:147], a[240:243]
ds_read_b64_tr_b16 a[216:217], v6 offset:288
ds_read_b64_tr_b16 a[218:219], v6 offset:800
v_mfma_f32_16x16x32_bf16 a[244:247], a[196:199], a[148:151], a[244:247]
buffer_load_dwordx4 a[160:163], v3, s[40:43], s72 offen offset:0 sc1
v_mfma_f32_16x16x32_bf16 a[244:247], a[192:195], a[132:135], a[244:247]
v_mfma_f32_16x16x32_bf16 a[248:251], a[192:195], a[136:139], a[248:251]
v_mfma_f32_16x16x32_bf16 a[248:251], a[196:199], a[152:155], a[248:251]
ds_read_b64_tr_b16 a[220:221], v6 offset:17184
ds_read_b64_tr_b16 a[222:223], v6 offset:17696
v_mfma_f32_16x16x32_bf16 a[252:255], a[196:199], a[156:159], a[252:255]
buffer_load_dwordx4 a[176:179], v3, s[40:43], s72 offen offset:1024 sc1
v_mfma_f32_16x16x32_bf16 a[252:255], a[192:195], a[140:143], a[252:255]
s_waitcnt lgkmcnt(8)
v_mfma_f32_16x16x32_bf16 v[132:135], a[200:203], a[140:143], v[132:135]
v_mfma_f32_16x16x32_bf16 v[132:135], a[204:207], a[156:159], v[132:135]
ds_read_b64_tr_b16 a[192:193], v6 offset:4224
ds_read_b64_tr_b16 a[194:195], v6 offset:4736
v_mfma_f32_16x16x32_bf16 v[128:131], a[204:207], a[152:155], v[128:131]
buffer_load_dwordx4 a[164:167], v3, s[40:43], s73 offen offset:0 sc1
v_mfma_f32_16x16x32_bf16 v[128:131], a[200:203], a[136:139], v[128:131]
v_mfma_f32_16x16x32_bf16 v[164:167], a[200:203], a[132:135], v[164:167]
v_mfma_f32_16x16x32_bf16 v[164:167], a[204:207], a[148:151], v[164:167]
ds_read_b64_tr_b16 a[196:197], v6 offset:21120
ds_read_b64_tr_b16 a[198:199], v6 offset:21632
v_mfma_f32_16x16x32_bf16 v[160:163], a[204:207], a[144:147], v[160:163]
buffer_load_dwordx4 a[180:183], v3, s[40:43], s73 offen offset:1024 sc1
v_mfma_f32_16x16x32_bf16 v[160:163], a[200:203], a[128:131], v[160:163]
s_waitcnt lgkmcnt(8)
v_mfma_f32_16x16x32_bf16 v[196:199], a[208:211], a[128:131], v[196:199]
v_mfma_f32_16x16x32_bf16 v[196:199], a[212:215], a[144:147], v[196:199]
ds_read_b64_tr_b16 a[200:201], v6 offset:4256
ds_read_b64_tr_b16 a[202:203], v6 offset:4768
v_mfma_f32_16x16x32_bf16 v[192:195], a[212:215], a[148:151], v[192:195]
buffer_load_dwordx4 a[168:171], v3, s[40:43], s74 offen offset:0 sc1
v_mfma_f32_16x16x32_bf16 v[192:195], a[208:211], a[132:135], v[192:195]
v_mfma_f32_16x16x32_bf16 v[16:19], a[208:211], a[136:139], v[16:19]
v_mfma_f32_16x16x32_bf16 v[16:19], a[212:215], a[152:155], v[16:19]
ds_read_b64_tr_b16 a[204:205], v6 offset:21152
ds_read_b64_tr_b16 a[206:207], v6 offset:21664
v_mfma_f32_16x16x32_bf16 v[228:231], a[212:215], a[156:159], v[228:231]
buffer_load_dwordx4 a[184:187], v3, s[40:43], s74 offen offset:1024 sc1
v_mfma_f32_16x16x32_bf16 v[228:231], a[208:211], a[140:143], v[228:231]
s_waitcnt lgkmcnt(8)
v_mfma_f32_16x16x32_bf16 v[224:227], a[216:219], a[140:143], v[224:227]
v_mfma_f32_16x16x32_bf16 v[224:227], a[220:223], a[156:159], v[224:227]
ds_read_b64_tr_b16 a[208:209], v6 offset:4480
ds_read_b64_tr_b16 a[210:211], v6 offset:4992
v_mfma_f32_16x16x32_bf16 v[236:239], a[220:223], a[152:155], v[236:239]
buffer_load_dwordx4 a[172:175], v3, s[40:43], s75 offen offset:0 sc1
v_mfma_f32_16x16x32_bf16 v[236:239], a[216:219], a[136:139], v[236:239]
v_mfma_f32_16x16x32_bf16 v[44:47], a[216:219], a[132:135], v[44:47]
v_mfma_f32_16x16x32_bf16 v[44:47], a[220:223], a[148:151], v[44:47]
ds_read_b64_tr_b16 a[212:213], v6 offset:21376
ds_read_b64_tr_b16 a[214:215], v6 offset:21888
v_mfma_f32_16x16x32_bf16 v[232:235], a[220:223], a[144:147], v[232:235]
buffer_load_dwordx4 a[188:191], v3, s[40:43], s75 offen offset:1024 sc1
v_mfma_f32_16x16x32_bf16 v[232:235], a[216:219], a[128:131], v[232:235]
s_waitcnt lgkmcnt(8)
v_mfma_f32_16x16x32_bf16 v[204:207], a[192:195], a[128:131], v[204:207]
v_mfma_f32_16x16x32_bf16 v[204:207], a[196:199], a[144:147], v[204:207]
ds_read_b64_tr_b16 a[216:217], v6 offset:4512
ds_read_b64_tr_b16 a[218:219], v6 offset:5024
v_mfma_f32_16x16x32_bf16 v[200:203], a[196:199], a[148:151], v[200:203]
s_add_u32 s10, s77, 1024
v_mfma_f32_16x16x32_bf16 v[200:203], a[192:195], a[132:135], v[200:203]
buffer_store_dwordx4 a[48:51], v1, s[44:47], s10 offen sc1
v_mfma_f32_16x16x32_bf16 v[72:75], a[192:195], a[136:139], v[72:75]
s_add_u32 m0, s67, 67584
v_mfma_f32_16x16x32_bf16 v[72:75], a[196:199], a[152:155], v[72:75]
ds_read_b64_tr_b16 a[220:221], v6 offset:21408
ds_read_b64_tr_b16 a[222:223], v6 offset:21920
v_mfma_f32_16x16x32_bf16 v[172:175], a[196:199], a[156:159], v[172:175]
s_add_u32 s79, s79, s70
v_mfma_f32_16x16x32_bf16 v[172:175], a[192:195], a[140:143], v[172:175]
s_waitcnt lgkmcnt(8)
v_mfma_f32_16x16x32_bf16 v[168:171], a[200:203], a[140:143], v[168:171]
buffer_load_dwordx4 v4, s[96:99], s79 offen lds
v_mfma_f32_16x16x32_bf16 v[168:171], a[204:207], a[156:159], v[168:171]
ds_read_b64_tr_b16 a[192:193], v6 offset:8448
ds_read_b64_tr_b16 a[194:195], v6 offset:8960
v_mfma_f32_16x16x32_bf16 v[140:143], a[204:207], a[152:155], v[140:143]
v_mfma_f32_16x16x32_bf16 v[140:143], a[200:203], a[136:139], v[140:143]
s_add_u32 m0, s67, 68640
v_mfma_f32_16x16x32_bf16 v[100:103], a[200:203], a[132:135], v[100:103]
s_add_u32 s79, s79, s70
v_mfma_f32_16x16x32_bf16 v[100:103], a[204:207], a[148:151], v[100:103]
ds_read_b64_tr_b16 a[196:197], v6 offset:25344
ds_read_b64_tr_b16 a[198:199], v6 offset:25856
v_mfma_f32_16x16x32_bf16 v[136:139], a[204:207], a[144:147], v[136:139]
buffer_load_dwordx4 v4, s[96:99], s79 offen lds
v_mfma_f32_16x16x32_bf16 v[136:139], a[200:203], a[128:131], v[136:139]
Lpad4:
s_cbranch_execz Lhopback
s_waitcnt lgkmcnt(8)
v_mfma_f32_16x16x32_bf16 v[108:111], a[208:211], a[128:131], v[108:111]
v_mfma_f32_16x16x32_bf16 v[108:111], a[212:215], a[144:147], v[108:111]
ds_read_b64_tr_b16 a[200:201], v6 offset:8480
ds_read_b64_tr_b16 a[202:203], v6 offset:8992
v_mfma_f32_16x16x32_bf16 v[104:107], a[212:215], a[148:151], v[104:107]
v_mfma_f32_16x16x32_bf16 v[104:107], a[208:211], a[132:135], v[104:107]
s_add_u32 s10, s77, 0
v_mfma_f32_16x16x32_bf16 v[80:83], a[208:211], a[136:139], v[80:83]
buffer_store_dwordx4 a[52:55], v1, s[44:47], s10 offen sc1
v_mfma_f32_16x16x32_bf16 v[80:83], a[212:215], a[152:155], v[80:83]
ds_read_b64_tr_b16 a[204:205], v6 offset:25376
ds_read_b64_tr_b16 a[206:207], v6 offset:25888
v_mfma_f32_16x16x32_bf16 v[76:79], a[212:215], a[156:159], v[76:79]
s_add_u32 m0, s67, 69696
v_mfma_f32_16x16x32_bf16 v[76:79], a[208:211], a[140:143], v[76:79]
s_waitcnt lgkmcnt(8)
v_mfma_f32_16x16x32_bf16 v[52:55], a[216:219], a[140:143], v[52:55]
s_add_u32 s79, s79, s70
v_mfma_f32_16x16x32_bf16 v[52:55], a[220:223], a[156:159], v[52:55]
ds_read_b64_tr_b16 a[208:209], v6 offset:8704
ds_read_b64_tr_b16 a[210:211], v6 offset:9216
v_mfma_f32_16x16x32_bf16 v[48:51], a[220:223], a[152:155], v[48:51]
buffer_load_dwordx4 v4, s[96:99], s79 offen lds
v_mfma_f32_16x16x32_bf16 v[48:51], a[216:219], a[136:139], v[48:51]
v_mfma_f32_16x16x32_bf16 v[24:27], a[216:219], a[132:135], v[24:27]
s_add_u32 m0, s67, 70752
v_mfma_f32_16x16x32_bf16 v[24:27], a[220:223], a[148:151], v[24:27]
ds_read_b64_tr_b16 a[212:213], v6 offset:25600
ds_read_b64_tr_b16 a[214:215], v6 offset:26112
v_mfma_f32_16x16x32_bf16 v[20:23], a[220:223], a[144:147], v[20:23]
s_add_u32 s79, s79, s70
v_mfma_f32_16x16x32_bf16 v[20:23], a[216:219], a[128:131], v[20:23]
s_waitcnt lgkmcnt(8)
v_mfma_f32_16x16x32_bf16 v[60:63], a[192:195], a[128:131], v[60:63]
buffer_load_dwordx4 v4, s[96:99], s79 offen lds
v_mfma_f32_16x16x32_bf16 v[60:63], a[196:199], a[144:147], v[60:63]
ds_read_b64_tr_b16 a[216:217], v6 offset:8736
ds_read_b64_tr_b16 a[218:219], v6 offset:9248
v_mfma_f32_16x16x32_bf16 v[32:35], a[196:199], a[148:151], v[32:35]
v_mfma_f32_16x16x32_bf16 v[32:35], a[192:195], a[132:135], v[32:35]
v_mfma_f32_16x16x32_bf16 v[56:59], a[192:195], a[136:139], v[56:59]
s_add_u32 s10, s77, 9216
v_mfma_f32_16x16x32_bf16 v[56:59], a[196:199], a[152:155], v[56:59]
ds_read_b64_tr_b16 a[220:221], v6 offset:25632
ds_read_b64_tr_b16 a[222:223], v6 offset:26144
v_mfma_f32_16x16x32_bf16 v[28:31], a[196:199], a[156:159], v[28:31]
buffer_store_dwordx4 a[56:59], v1, s[44:47], s10 offen sc1
v_mfma_f32_16x16x32_bf16 v[28:31], a[192:195], a[140:143], v[28:31]
s_waitcnt lgkmcnt(8)
v_mfma_f32_16x16x32_bf16 v[116:119], a[200:203], a[140:143], v[116:119]
v_mfma_f32_16x16x32_bf16 v[116:119], a[204:207], a[156:159], v[116:119]
ds_read_b64_tr_b16 a[192:193], v6 offset:12672
ds_read_b64_tr_b16 a[194:195], v6 offset:13184
v_mfma_f32_16x16x32_bf16 v[88:91], a[204:207], a[152:155], v[88:91]
s_add_u32 m0, s67, 84480
v_mfma_f32_16x16x32_bf16 v[88:91], a[200:203], a[136:139], v[88:91]
s_add_u32 s79, s79, s70
v_mfma_f32_16x16x32_bf16 v[112:115], a[200:203], a[132:135], v[112:115]
buffer_load_dwordx4 v4, s[96:99], s79 offen lds
v_mfma_f32_16x16x32_bf16 v[112:115], a[204:207], a[148:151], v[112:115]
ds_read_b64_tr_b16 a[196:197], v6 offset:29568
ds_read_b64_tr_b16 a[198:199], v6 offset:30080
v_mfma_f32_16x16x32_bf16 v[84:87], a[204:207], a[144:147], v[84:87]
s_add_u32 m0, s67, 85536
v_mfma_f32_16x16x32_bf16 v[84:87], a[200:203], a[128:131], v[84:87]
s_waitcnt lgkmcnt(8)
v_mfma_f32_16x16x32_bf16 v[180:183], a[208:211], a[128:131], v[180:183]
s_add_u32 s79, s79, s70
v_mfma_f32_16x16x32_bf16 v[180:183], a[212:215], a[144:147], v[180:183]
ds_read_b64_tr_b16 a[200:201], v6 offset:12704
ds_read_b64_tr_b16 a[202:203], v6 offset:13216
v_mfma_f32_16x16x32_bf16 v[176:179], a[212:215], a[148:151], v[176:179]
buffer_load_dwordx4 v4, s[96:99], s79 offen lds
v_mfma_f32_16x16x32_bf16 v[176:179], a[208:211], a[132:135], v[176:179]
v_mfma_f32_16x16x32_bf16 v[244:247], a[208:211], a[136:139], v[244:247]
v_mfma_f32_16x16x32_bf16 v[244:247], a[212:215], a[152:155], v[244:247]
ds_read_b64_tr_b16 a[204:205], v6 offset:29600
ds_read_b64_tr_b16 a[206:207], v6 offset:30112
v_mfma_f32_16x16x32_bf16 v[240:243], a[212:215], a[156:159], v[240:243]
s_add_u32 s10, s77, 8192
v_mfma_f32_16x16x32_bf16 v[240:243], a[208:211], a[140:143], v[240:243]
s_waitcnt lgkmcnt(8)
v_mfma_f32_16x16x32_bf16 v[148:151], a[216:219], a[140:143], v[148:151]
buffer_store_dwordx4 a[60:63], v1, s[44:47], s10 offen sc1
v_mfma_f32_16x16x32_bf16 v[148:151], a[220:223], a[156:159], v[148:151]
ds_read_b64_tr_b16 a[208:209], v6 offset:12928
ds_read_b64_tr_b16 a[210:211], v6 offset:13440
v_mfma_f32_16x16x32_bf16 v[68:71], a[220:223], a[152:155], v[68:71]
v_mfma_f32_16x16x32_bf16 v[68:71], a[216:219], a[136:139], v[68:71]
s_add_u32 m0, s67, 86592
v_mfma_f32_16x16x32_bf16 v[64:67], a[216:219], a[132:135], v[64:67]
s_add_u32 s79, s79, s70
v_mfma_f32_16x16x32_bf16 v[64:67], a[220:223], a[148:151], v[64:67]
ds_read_b64_tr_b16 a[212:213], v6 offset:29824
ds_read_b64_tr_b16 a[214:215], v6 offset:30336
v_mfma_f32_16x16x32_bf16 v[124:127], a[220:223], a[144:147], v[124:127]
buffer_load_dwordx4 v4, s[96:99], s79 offen lds
v_mfma_f32_16x16x32_bf16 v[124:127], a[216:219], a[128:131], v[124:127]
s_waitcnt lgkmcnt(8)
v_mfma_f32_16x16x32_bf16 v[120:123], a[192:195], a[128:131], v[120:123]
v_mfma_f32_16x16x32_bf16 v[120:123], a[196:199], a[144:147], v[120:123]
ds_read_b64_tr_b16 a[216:217], v6 offset:12960
ds_read_b64_tr_b16 a[218:219], v6 offset:13472
v_mfma_f32_16x16x32_bf16 v[188:191], a[196:199], a[148:151], v[188:191]
s_add_u32 m0, s67, 87648
v_mfma_f32_16x16x32_bf16 v[188:191], a[192:195], a[132:135], v[188:191]
s_add_u32 s79, s79, s70
v_mfma_f32_16x16x32_bf16 v[184:187], a[192:195], a[136:139], v[184:187]
buffer_load_dwordx4 v4, s[96:99], s79 offen lds
v_mfma_f32_16x16x32_bf16 v[184:187], a[196:199], a[152:155], v[184:187]
ds_read_b64_tr_b16 a[220:221], v6 offset:29856
ds_read_b64_tr_b16 a[222:223], v6 offset:30368
v_mfma_f32_16x16x32_bf16 v[144:147], a[196:199], a[156:159], v[144:147]
v_mfma_f32_16x16x32_bf16 v[144:147], a[192:195], a[140:143], v[144:147]
s_waitcnt lgkmcnt(8)
v_mfma_f32_16x16x32_bf16 v[252:255], a[200:203], a[140:143], v[252:255]
s_waitcnt vmcnt(22)
s_barrier
v_mfma_f32_16x16x32_bf16 v[252:255], a[204:207], a[156:159], v[252:255]
ds_read_b64_tr_b16 a[192:193], v6 offset:33792
ds_read_b64_tr_b16 a[194:195], v6 offset:34304
v_mfma_f32_16x16x32_bf16 v[248:251], a[204:207], a[152:155], v[248:251]
v_mfma_f32_16x16x32_bf16 v[248:251], a[200:203], a[136:139], v[248:251]
v_mfma_f32_16x16x32_bf16 v[40:43], a[200:203], a[132:135], v[40:43]
v_mfma_f32_16x16x32_bf16 v[40:43], a[204:207], a[148:151], v[40:43]
ds_read_b64_tr_b16 a[196:197], v6 offset:50688
ds_read_b64_tr_b16 a[198:199], v6 offset:51200
v_mfma_f32_16x16x32_bf16 v[36:39], a[204:207], a[144:147], v[36:39]
v_mfma_f32_16x16x32_bf16 v[36:39], a[200:203], a[128:131], v[36:39]
s_waitcnt lgkmcnt(8)
v_mfma_f32_16x16x32_bf16 v[96:99], a[208:211], a[128:131], v[96:99]
v_mfma_f32_16x16x32_bf16 v[96:99], a[212:215], a[144:147], v[96:99]
ds_read_b64_tr_b16 a[200:201], v6 offset:33824
ds_read_b64_tr_b16 a[202:203], v6 offset:34336
v_mfma_f32_16x16x32_bf16 v[92:95], a[212:215], a[148:151], v[92:95]
v_mfma_f32_16x16x32_bf16 v[92:95], a[208:211], a[132:135], v[92:95]
v_mfma_f32_16x16x32_bf16 v[212:215], a[208:211], a[136:139], v[212:215]
v_accvgpr_read_b32 v10, a226
v_accvgpr_read_b32 v11, a227
v_mfma_f32_16x16x32_bf16 v[212:215], a[212:215], a[152:155], v[212:215]
ds_read_b64_tr_b16 a[204:205], v6 offset:50720
ds_read_b64_tr_b16 a[206:207], v6 offset:51232
v_mfma_f32_16x16x32_bf16 v[156:159], a[212:215], a[156:159], v[156:159]
v_mfma_f32_16x16x32_bf16 v[156:159], a[208:211], a[140:143], v[156:159]
s_waitcnt lgkmcnt(8)
v_mfma_f32_16x16x32_bf16 v[152:155], a[216:219], a[140:143], v[152:155]
v_mfma_f32_16x16x32_bf16 v[152:155], a[220:223], a[156:159], v[152:155]
ds_read_b64_tr_b16 a[208:209], v6 offset:34048
ds_read_b64_tr_b16 a[210:211], v6 offset:34560
v_mfma_f32_16x16x32_bf16 v[220:223], a[220:223], a[152:155], v[220:223]
v_mfma_f32_16x16x32_bf16 v[220:223], a[216:219], a[136:139], v[220:223]
v_mfma_f32_16x16x32_bf16 v[216:219], a[216:219], a[132:135], v[216:219]
v_mfma_f32_16x16x32_bf16 v[216:219], a[220:223], a[148:151], v[216:219]
ds_read_b64_tr_b16 a[212:213], v6 offset:50944
ds_read_b64_tr_b16 a[214:215], v6 offset:51456
v_mfma_f32_16x16x32_bf16 v[208:211], a[220:223], a[144:147], v[208:211]
global_load_dword a228, v[10:11], off
v_mfma_f32_16x16x32_bf16 v[208:211], a[216:219], a[128:131], v[208:211]
s_waitcnt vmcnt(13) lgkmcnt(8)
v_mfma_f32_16x16x32_bf16 a[240:243], a[192:195], a[160:163], a[240:243]
v_mfma_f32_16x16x32_bf16 a[240:243], a[196:199], a[176:179], a[240:243]
ds_read_b64_tr_b16 a[216:217], v6 offset:34080
ds_read_b64_tr_b16 a[218:219], v6 offset:34592
v_mfma_f32_16x16x32_bf16 a[244:247], a[196:199], a[180:183], a[244:247]
s_add_u32 m0, s67, 101376
s_add_u32 s79, s79, s70
v_mfma_f32_16x16x32_bf16 a[244:247], a[192:195], a[164:167], a[244:247]
buffer_load_dwordx4 v4, s[96:99], s79 offen lds
v_mfma_f32_16x16x32_bf16 a[248:251], a[192:195], a[168:171], a[248:251]
s_add_u32 m0, s67, 102432
v_mfma_f32_16x16x32_bf16 a[248:251], a[196:199], a[184:187], a[248:251]
ds_read_b64_tr_b16 a[220:221], v6 offset:50976
ds_read_b64_tr_b16 a[222:223], v6 offset:51488
v_mfma_f32_16x16x32_bf16 a[252:255], a[196:199], a[188:191], a[252:255]
s_add_u32 s79, s79, s70
v_mfma_f32_16x16x32_bf16 a[252:255], a[192:195], a[172:175], a[252:255]
s_waitcnt lgkmcnt(8)
v_mfma_f32_16x16x32_bf16 v[132:135], a[200:203], a[172:175], v[132:135]
buffer_load_dwordx4 v4, s[96:99], s79 offen lds
v_mfma_f32_16x16x32_bf16 v[132:135], a[204:207], a[188:191], v[132:135]
ds_read_b64_tr_b16 a[192:193], v6 offset:38016
ds_read_b64_tr_b16 a[194:195], v6 offset:38528
v_mfma_f32_16x16x32_bf16 v[128:131], a[204:207], a[184:187], v[128:131]
s_add_u32 m0, s67, 103488
s_add_u32 s79, s79, s70
v_mfma_f32_16x16x32_bf16 v[128:131], a[200:203], a[168:171], v[128:131]
buffer_load_dwordx4 v4, s[96:99], s79 offen lds
v_mfma_f32_16x16x32_bf16 v[164:167], a[200:203], a[164:167], v[164:167]
s_add_u32 m0, s67, 104544
v_mfma_f32_16x16x32_bf16 v[164:167], a[204:207], a[180:183], v[164:167]
ds_read_b64_tr_b16 a[196:197], v6 offset:54912
ds_read_b64_tr_b16 a[198:199], v6 offset:55424
v_mfma_f32_16x16x32_bf16 v[160:163], a[204:207], a[176:179], v[160:163]
s_add_u32 s79, s79, s70
v_mfma_f32_16x16x32_bf16 v[160:163], a[200:203], a[160:163], v[160:163]
s_waitcnt lgkmcnt(8)
v_mfma_f32_16x16x32_bf16 v[196:199], a[208:211], a[160:163], v[196:199]
buffer_load_dwordx4 v4, s[96:99], s79 offen lds
v_mfma_f32_16x16x32_bf16 v[196:199], a[212:215], a[176:179], v[196:199]
ds_read_b64_tr_b16 a[200:201], v6 offset:38048
ds_read_b64_tr_b16 a[202:203], v6 offset:38560
v_mfma_f32_16x16x32_bf16 v[192:195], a[212:215], a[180:183], v[192:195]
s_add_u32 m0, s67, 118272
v_mfma_f32_16x16x32_bf16 v[192:195], a[208:211], a[164:167], v[192:195]
s_add_u32 s79, s79, s70
v_mfma_f32_16x16x32_bf16 v[16:19], a[208:211], a[168:171], v[16:19]
buffer_load_dwordx4 v4, s[96:99], s79 offen lds
v_mfma_f32_16x16x32_bf16 v[16:19], a[212:215], a[184:187], v[16:19]
ds_read_b64_tr_b16 a[204:205], v6 offset:54944
ds_read_b64_tr_b16 a[206:207], v6 offset:55456
v_mfma_f32_16x16x32_bf16 v[228:231], a[212:215], a[188:191], v[228:231]
s_add_u32 m0, s67, 119328
v_mfma_f32_16x16x32_bf16 v[228:231], a[208:211], a[172:175], v[228:231]
s_waitcnt lgkmcnt(8)
v_mfma_f32_16x16x32_bf16 v[224:227], a[216:219], a[172:175], v[224:227]
s_add_u32 s79, s79, s70
v_mfma_f32_16x16x32_bf16 v[224:227], a[220:223], a[188:191], v[224:227]
ds_read_b64_tr_b16 a[208:209], v6 offset:38272
ds_read_b64_tr_b16 a[210:211], v6 offset:38784
v_mfma_f32_16x16x32_bf16 v[236:239], a[220:223], a[184:187], v[236:239]
buffer_load_dwordx4 v4, s[96:99], s79 offen lds
v_mfma_f32_16x16x32_bf16 v[236:239], a[216:219], a[168:171], v[236:239]
s_add_u32 m0, s67, 120384
v_mfma_f32_16x16x32_bf16 v[44:47], a[216:219], a[164:167], v[44:47]
s_add_u32 s79, s79, s70
v_mfma_f32_16x16x32_bf16 v[44:47], a[220:223], a[180:183], v[44:47]
ds_read_b64_tr_b16 a[212:213], v6 offset:55168
ds_read_b64_tr_b16 a[214:215], v6 offset:55680
v_mfma_f32_16x16x32_bf16 v[232:235], a[220:223], a[176:179], v[232:235]
buffer_load_dwordx4 v4, s[96:99], s79 offen lds
v_mfma_f32_16x16x32_bf16 v[232:235], a[216:219], a[160:163], v[232:235]
s_waitcnt lgkmcnt(8)
v_mfma_f32_16x16x32_bf16 v[204:207], a[192:195], a[160:163], v[204:207]
s_add_u32 m0, s67, 121440
s_add_u32 s79, s79, s70
v_mfma_f32_16x16x32_bf16 v[204:207], a[196:199], a[176:179], v[204:207]
ds_read_b64_tr_b16 a[216:217], v6 offset:38304
ds_read_b64_tr_b16 a[218:219], v6 offset:38816
v_mfma_f32_16x16x32_bf16 v[200:203], a[196:199], a[180:183], v[200:203]
buffer_load_dwordx4 v4, s[96:99], s79 offen lds
v_mfma_f32_16x16x32_bf16 v[200:203], a[192:195], a[164:167], v[200:203]
v_mfma_f32_16x16x32_bf16 v[72:75], a[192:195], a[168:171], v[72:75]
v_mfma_f32_16x16x32_bf16 v[72:75], a[196:199], a[184:187], v[72:75]
ds_read_b64_tr_b16 a[220:221], v6 offset:55200
ds_read_b64_tr_b16 a[222:223], v6 offset:55712
v_mfma_f32_16x16x32_bf16 v[172:175], a[196:199], a[188:191], v[172:175]
v_add_u32 v3, 18432, v1
v_mfma_f32_16x16x32_bf16 v[172:175], a[192:195], a[172:175], v[172:175]
s_waitcnt lgkmcnt(8)
v_mfma_f32_16x16x32_bf16 v[168:171], a[200:203], a[172:175], v[168:171]
buffer_load_dwordx4 a[104:107], v3, s[40:43], s74 offen offset:0 sc1
v_mfma_f32_16x16x32_bf16 v[168:171], a[204:207], a[188:191], v[168:171]
ds_read_b64_tr_b16 a[192:193], v6 offset:42240
ds_read_b64_tr_b16 a[194:195], v6 offset:42752
v_mfma_f32_16x16x32_bf16 v[140:143], a[204:207], a[184:187], v[140:143]
v_mfma_f32_16x16x32_bf16 v[140:143], a[200:203], a[168:171], v[140:143]
buffer_load_dwordx4 a[120:123], v3, s[40:43], s74 offen offset:1024 sc1
v_mfma_f32_16x16x32_bf16 v[100:103], a[200:203], a[164:167], v[100:103]
v_mfma_f32_16x16x32_bf16 v[100:103], a[204:207], a[180:183], v[100:103]
ds_read_b64_tr_b16 a[196:197], v6 offset:59136
ds_read_b64_tr_b16 a[198:199], v6 offset:59648
v_mfma_f32_16x16x32_bf16 v[136:139], a[204:207], a[176:179], v[136:139]
v_mfma_f32_16x16x32_bf16 v[136:139], a[200:203], a[160:163], v[136:139]
s_waitcnt lgkmcnt(8)
v_mfma_f32_16x16x32_bf16 v[108:111], a[208:211], a[160:163], v[108:111]
buffer_load_dwordx4 a[108:111], v3, s[40:43], s75 offen offset:0 sc1
v_mfma_f32_16x16x32_bf16 v[108:111], a[212:215], a[176:179], v[108:111]
ds_read_b64_tr_b16 a[200:201], v6 offset:42272
ds_read_b64_tr_b16 a[202:203], v6 offset:42784
v_mfma_f32_16x16x32_bf16 v[104:107], a[212:215], a[180:183], v[104:107]
v_mfma_f32_16x16x32_bf16 v[104:107], a[208:211], a[164:167], v[104:107]
buffer_load_dwordx4 a[124:127], v3, s[40:43], s75 offen offset:1024 sc1
v_mfma_f32_16x16x32_bf16 v[80:83], a[208:211], a[168:171], v[80:83]
v_mfma_f32_16x16x32_bf16 v[80:83], a[212:215], a[184:187], v[80:83]
ds_read_b64_tr_b16 a[204:205], v6 offset:59168
ds_read_b64_tr_b16 a[206:207], v6 offset:59680
v_mfma_f32_16x16x32_bf16 v[76:79], a[212:215], a[188:191], v[76:79]
v_add_u32 v3, 16384, v1
v_mfma_f32_16x16x32_bf16 v[76:79], a[208:211], a[172:175], v[76:79]
s_waitcnt lgkmcnt(8)
v_mfma_f32_16x16x32_bf16 v[52:55], a[216:219], a[172:175], v[52:55]
buffer_load_dwordx4 a[64:67], v3, s[40:43], s72 offen offset:0 sc1
v_mfma_f32_16x16x32_bf16 v[52:55], a[220:223], a[188:191], v[52:55]
ds_read_b64_tr_b16 a[208:209], v6 offset:42496
ds_read_b64_tr_b16 a[210:211], v6 offset:43008
v_mfma_f32_16x16x32_bf16 v[48:51], a[220:223], a[184:187], v[48:51]
v_mfma_f32_16x16x32_bf16 v[48:51], a[216:219], a[168:171], v[48:51]
buffer_load_dwordx4 a[80:83], v3, s[40:43], s72 offen offset:1024 sc1
v_mfma_f32_16x16x32_bf16 v[24:27], a[216:219], a[164:167], v[24:27]
v_mfma_f32_16x16x32_bf16 v[24:27], a[220:223], a[180:183], v[24:27]
ds_read_b64_tr_b16 a[212:213], v6 offset:59392
ds_read_b64_tr_b16 a[214:215], v6 offset:59904
v_mfma_f32_16x16x32_bf16 v[20:23], a[220:223], a[176:179], v[20:23]
v_mfma_f32_16x16x32_bf16 v[20:23], a[216:219], a[160:163], v[20:23]
s_waitcnt lgkmcnt(8)
v_mfma_f32_16x16x32_bf16 v[60:63], a[192:195], a[160:163], v[60:63]
buffer_load_dwordx4 a[68:71], v3, s[40:43], s73 offen offset:0 sc1
v_mfma_f32_16x16x32_bf16 v[60:63], a[196:199], a[176:179], v[60:63]
ds_read_b64_tr_b16 a[216:217], v6 offset:42528
ds_read_b64_tr_b16 a[218:219], v6 offset:43040
v_mfma_f32_16x16x32_bf16 v[32:35], a[196:199], a[180:183], v[32:35]
v_mfma_f32_16x16x32_bf16 v[32:35], a[192:195], a[164:167], v[32:35]
buffer_load_dwordx4 a[84:87], v3, s[40:43], s73 offen offset:1024 sc1
v_mfma_f32_16x16x32_bf16 v[56:59], a[192:195], a[168:171], v[56:59]
v_mfma_f32_16x16x32_bf16 v[56:59], a[196:199], a[184:187], v[56:59]
ds_read_b64_tr_b16 a[220:221], v6 offset:59424
ds_read_b64_tr_b16 a[222:223], v6 offset:59936
v_mfma_f32_16x16x32_bf16 v[28:31], a[196:199], a[188:191], v[28:31]
v_mfma_f32_16x16x32_bf16 v[28:31], a[192:195], a[172:175], v[28:31]
s_waitcnt lgkmcnt(8)
v_mfma_f32_16x16x32_bf16 v[116:119], a[200:203], a[172:175], v[116:119]
buffer_load_dwordx4 a[72:75], v3, s[40:43], s74 offen offset:0 sc1
v_mfma_f32_16x16x32_bf16 v[116:119], a[204:207], a[188:191], v[116:119]
ds_read_b64_tr_b16 a[192:193], v6 offset:46464
ds_read_b64_tr_b16 a[194:195], v6 offset:46976
v_mfma_f32_16x16x32_bf16 v[88:91], a[204:207], a[184:187], v[88:91]
v_mfma_f32_16x16x32_bf16 v[88:91], a[200:203], a[168:171], v[88:91]
buffer_load_dwordx4 a[88:91], v3, s[40:43], s74 offen offset:1024 sc1
v_mfma_f32_16x16x32_bf16 v[112:115], a[200:203], a[164:167], v[112:115]
v_mfma_f32_16x16x32_bf16 v[112:115], a[204:207], a[180:183], v[112:115]
ds_read_b64_tr_b16 a[196:197], v6 offset:63360
ds_read_b64_tr_b16 a[198:199], v6 offset:63872
v_mfma_f32_16x16x32_bf16 v[84:87], a[204:207], a[176:179], v[84:87]
v_mfma_f32_16x16x32_bf16 v[84:87], a[200:203], a[160:163], v[84:87]
s_waitcnt lgkmcnt(8)
v_mfma_f32_16x16x32_bf16 v[180:183], a[208:211], a[160:163], v[180:183]
buffer_load_dwordx4 a[76:79], v3, s[40:43], s75 offen offset:0 sc1
v_mfma_f32_16x16x32_bf16 v[180:183], a[212:215], a[176:179], v[180:183]
ds_read_b64_tr_b16 a[200:201], v6 offset:46496
ds_read_b64_tr_b16 a[202:203], v6 offset:47008
v_mfma_f32_16x16x32_bf16 v[176:179], a[212:215], a[180:183], v[176:179]
v_mfma_f32_16x16x32_bf16 v[176:179], a[208:211], a[164:167], v[176:179]
v_mfma_f32_16x16x32_bf16 v[244:247], a[208:211], a[168:171], v[244:247]
buffer_load_dwordx4 a[92:95], v3, s[40:43], s75 offen offset:1024 sc1
v_mfma_f32_16x16x32_bf16 v[244:247], a[212:215], a[184:187], v[244:247]
ds_read_b64_tr_b16 a[204:205], v6 offset:63392
ds_read_b64_tr_b16 a[206:207], v6 offset:63904
v_mfma_f32_16x16x32_bf16 v[240:243], a[212:215], a[188:191], v[240:243]
s_mov_b32 s98, 0x3c853526
s_lshl_b32 s52, s31, 20
s_sub_u32 s53, 16, s3
v_mfma_f32_16x16x32_bf16 v[240:243], a[208:211], a[172:175], v[240:243]
s_waitcnt lgkmcnt(8)
v_mfma_f32_16x16x32_bf16 v[148:151], a[216:219], a[172:175], v[148:151]
s_add_u32 s10, s9, 0
v_and_b32 v12, 15, v0
v_lshrrev_b32 v13, 4, v0
v_mfma_f32_16x16x32_bf16 v[148:151], a[220:223], a[188:191], v[148:151]
ds_read_b64_tr_b16 a[208:209], v6 offset:46720
ds_read_b64_tr_b16 a[210:211], v6 offset:47232
v_mfma_f32_16x16x32_bf16 v[68:71], a[220:223], a[184:187], v[68:71]
buffer_store_dwordx4 a[236:239], v1, s[44:47], s10 offen sc1
v_mfma_f32_16x16x32_bf16 v[68:71], a[216:219], a[168:171], v[68:71]
s_lshl_b32 s53, s53, 16
s_add_u32 s32, s28, 0x400000
s_addc_u32 s33, s29, 0
v_mfma_f32_16x16x32_bf16 v[64:67], a[216:219], a[164:167], v[64:67]
s_add_u32 s32, s32, s52
s_addc_u32 s33, s33, 0
s_mov_b32 s34, s53
v_mfma_f32_16x16x32_bf16 v[64:67], a[220:223], a[180:183], v[64:67]
ds_read_b64_tr_b16 a[212:213], v6 offset:63616
ds_read_b64_tr_b16 a[214:215], v6 offset:64128
v_mfma_f32_16x16x32_bf16 v[124:127], a[220:223], a[176:179], v[124:127]
s_mov_b32 s35, 0x20000
s_cmp_lt_u32 s62, 27
s_cselect_b32 s53, 0x6c0000, 0
v_mfma_f32_16x16x32_bf16 v[124:127], a[216:219], a[160:163], v[124:127]
s_waitcnt lgkmcnt(8)
v_lshlrev_b32 v13, 2, v13
v_sub_u32 v12, v12, v13
v_mfma_f32_16x16x32_bf16 v[120:123], a[192:195], a[160:163], v[120:123]
s_add_u32 s36, s28, 0x2400000
s_addc_u32 s37, s29, 0
s_mov_b32 s38, s53
v_mfma_f32_16x16x32_bf16 v[120:123], a[196:199], a[176:179], v[120:123]
ds_read_b64_tr_b16 a[216:217], v6 offset:46752
ds_read_b64_tr_b16 a[218:219], v6 offset:47264
v_mfma_f32_16x16x32_bf16 v[188:191], a[196:199], a[180:183], v[188:191]
s_mov_b32 s39, 0x20000
s_add_u32 s40, s28, 0x2c00000
s_addc_u32 s41, s29, 0
v_mfma_f32_16x16x32_bf16 v[188:191], a[192:195], a[164:167], v[188:191]
s_mov_b32 s42, 0x1000000
s_mov_b32 s43, 0x20000
s_lshl_b32 s52, s30, 10
v_mfma_f32_16x16x32_bf16 v[184:187], a[192:195], a[168:171], v[184:187]
s_lshl_b32 s53, s62, 14
s_add_u32 s54, s52, s53
s_lshl_b32 s53, s31, 15
v_mfma_f32_16x16x32_bf16 v[184:187], a[196:199], a[184:187], v[184:187]
ds_read_b64_tr_b16 a[220:221], v6 offset:63648
ds_read_b64_tr_b16 a[222:223], v6 offset:64160
v_mfma_f32_16x16x32_bf16 v[144:147], a[196:199], a[188:191], v[144:147]
s_add_u32 s55, s52, s53
s_sub_u32 s52, 15, s3
s_mul_i32 s56, s3, 442368
v_mfma_f32_16x16x32_bf16 v[144:147], a[192:195], a[172:175], v[144:147]
s_waitcnt lgkmcnt(8)
v_lshl_add_u32 v12, s30, 4, v12
v_and_b32 v13, 3, v0
v_mfma_f32_16x16x32_bf16 v[252:255], a[200:203], a[172:175], v[252:255]
s_add_u32 s56, s56, s54
s_lshl_b32 s58, s3, 20
s_add_u32 s58, s58, s55
v_mfma_f32_16x16x32_bf16 v[252:255], a[204:207], a[188:191], v[252:255]
s_mul_i32 s57, s52, 442368
s_add_u32 s57, s57, s54
s_lshl_b32 s59, s52, 20
v_mfma_f32_16x16x32_bf16 v[248:251], a[204:207], a[184:187], v[248:251]
s_add_u32 s10, s9, 1024
v_cmp_eq_u32 vcc, 0, v13
v_mov_b32 v13, 0x3f803f80
v_mfma_f32_16x16x32_bf16 v[248:251], a[200:203], a[168:171], v[248:251]
buffer_store_dwordx4 a[236:239], v1, s[44:47], s10 offen sc1
v_mfma_f32_16x16x32_bf16 v[40:43], a[200:203], a[164:167], v[40:43]
s_add_u32 s59, s59, s55
s_mov_b32 s96, 0xc2469614
s_mov_b32 s97, 0xc1906ebb
v_mfma_f32_16x16x32_bf16 v[40:43], a[204:207], a[180:183], v[40:43]
s_mov_b32 s26, 0
v_mov_b32 v4, 0xff800000
v_cndmask_b32 v13, 0, v13, vcc
v_mfma_f32_16x16x32_bf16 v[36:39], a[204:207], a[176:179], v[36:39]
v_cmp_le_i32 s[64:65], 0, v12
v_cmp_le_i32 s[66:67], 1, v12
v_mfma_f32_16x16x32_bf16 v[36:39], a[200:203], a[160:163], v[36:39]
s_waitcnt lgkmcnt(0)
v_cmp_le_i32 s[68:69], 2, v12
v_cmp_le_i32 s[70:71], 3, v12
v_mfma_f32_16x16x32_bf16 v[96:99], a[208:211], a[160:163], v[96:99]
s_waitcnt vmcnt(14)
s_barrier
s_cmp_lg_u32 s30, 0
s_cbranch_scc1 Lpk_np
v_mov_b32 v14, 1
s_mov_b64 exec, 1
buffer_store_dword v14, off, s[48:51], s16 offset:0 sc1
s_mov_b64 exec, -1
Lpk_np:
v_mfma_f32_16x16x32_bf16 v[96:99], a[212:215], a[176:179], v[96:99]
ds_read_b64_tr_b16 a[192:193], v7 offset:8448
ds_read_b64_tr_b16 a[194:195], v7 offset:8960
v_mfma_f32_16x16x32_bf16 v[92:95], a[212:215], a[180:183], v[92:95]
v_mfma_f32_16x16x32_bf16 v[92:95], a[208:211], a[164:167], v[92:95]
ds_read_b64_tr_b16 a[196:197], v7 offset:25344
ds_read_b64_tr_b16 a[198:199], v7 offset:25856
v_mfma_f32_16x16x32_bf16 v[212:215], a[208:211], a[168:171], v[212:215]
v_mfma_f32_16x16x32_bf16 v[212:215], a[212:215], a[184:187], v[212:215]
ds_read_b64_tr_b16 a[200:201], v7 offset:42240
ds_read_b64_tr_b16 a[202:203], v7 offset:42752
v_mfma_f32_16x16x32_bf16 v[156:159], a[212:215], a[188:191], v[156:159]
v_mfma_f32_16x16x32_bf16 v[156:159], a[208:211], a[172:175], v[156:159]
ds_read_b64_tr_b16 a[204:205], v7 offset:59136
ds_read_b64_tr_b16 a[206:207], v7 offset:59648
v_mfma_f32_16x16x32_bf16 v[152:155], a[216:219], a[172:175], v[152:155]
v_mfma_f32_16x16x32_bf16 v[152:155], a[220:223], a[188:191], v[152:155]
v_mfma_f32_16x16x32_bf16 v[220:223], a[220:223], a[184:187], v[220:223]
v_mfma_f32_16x16x32_bf16 v[220:223], a[216:219], a[168:171], v[220:223]
s_add_u32 s10, s9, 4096
v_cmp_le_i32 s[72:73], 16, v12
v_cmp_le_i32 s[74:75], 17, v12
v_mfma_f32_16x16x32_bf16 v[216:219], a[216:219], a[164:167], v[216:219]
buffer_store_dwordx4 a[236:239], v1, s[44:47], s10 offen sc1
v_mfma_f32_16x16x32_bf16 v[216:219], a[220:223], a[180:183], v[216:219]
v_cmp_le_i32 s[76:77], 18, v12
v_cmp_le_i32 s[78:79], 19, v12
v_mfma_f32_16x16x32_bf16 v[208:211], a[220:223], a[176:179], v[208:211]
v_cmp_le_i32 s[80:81], 32, v12
v_cmp_le_i32 s[82:83], 33, v12
v_mfma_f32_16x16x32_bf16 v[208:211], a[216:219], a[160:163], v[208:211]
s_waitcnt vmcnt(3) lgkmcnt(0)
v_cmp_le_i32 s[84:85], 34, v12
v_cmp_le_i32 s[86:87], 35, v12
v_mfma_f32_16x16x32_bf16 v[60:63], a[192:195], a[64:67], v[60:63]
v_cmp_le_i32 s[88:89], 48, v12
v_cmp_le_i32 s[90:91], 49, v12
v_mfma_f32_16x16x32_bf16 v[60:63], a[196:199], a[80:83], v[60:63]
ds_read_b64_tr_b16 a[208:209], v7 offset:12672
ds_read_b64_tr_b16 a[210:211], v7 offset:13184
v_mfma_f32_16x16x32_bf16 v[60:63], a[200:203], a[96:99], v[60:63]
v_cmp_le_i32 s[92:93], 50, v12
v_cmp_le_i32 s[94:95], 51, v12
v_mfma_f32_16x16x32_bf16 v[60:63], a[204:207], a[112:115], v[60:63]
v_accvgpr_write_b32 a144, v13
v_accvgpr_write_b32 a145, v13
v_mfma_f32_16x16x32_bf16 v[32:35], a[204:207], a[116:119], v[32:35]
ds_read_b64_tr_b16 a[212:213], v7 offset:29568
ds_read_b64_tr_b16 a[214:215], v7 offset:30080
v_mfma_f32_16x16x32_bf16 v[32:35], a[200:203], a[100:103], v[32:35]
v_accvgpr_write_b32 a146, v13
v_accvgpr_write_b32 a147, v13
v_mfma_f32_16x16x32_bf16 v[32:35], a[196:199], a[84:87], v[32:35]
v_accvgpr_write_b32 a128, 0
v_accvgpr_write_b32 a129, 0
v_mfma_f32_16x16x32_bf16 v[32:35], a[192:195], a[68:71], v[32:35]
ds_read_b64_tr_b16 a[216:217], v7 offset:46464
ds_read_b64_tr_b16 a[218:219], v7 offset:46976
v_mfma_f32_16x16x32_bf16 v[56:59], a[192:195], a[72:75], v[56:59]
v_accvgpr_write_b32 a130, 0
v_accvgpr_write_b32 a131, 0
v_mfma_f32_16x16x32_bf16 v[56:59], a[196:199], a[88:91], v[56:59]
v_accvgpr_write_b32 a132, 0
v_accvgpr_write_b32 a133, 0
v_mfma_f32_16x16x32_bf16 v[56:59], a[200:203], a[104:107], v[56:59]
ds_read_b64_tr_b16 a[220:221], v7 offset:63360
ds_read_b64_tr_b16 a[222:223], v7 offset:63872
v_mfma_f32_16x16x32_bf16 v[56:59], a[204:207], a[120:123], v[56:59]
v_accvgpr_write_b32 a134, 0
v_accvgpr_write_b32 a135, 0
v_mfma_f32_16x16x32_bf16 v[28:31], a[204:207], a[124:127], v[28:31]
v_accvgpr_write_b32 a136, 0
v_accvgpr_write_b32 a137, 0
v_mfma_f32_16x16x32_bf16 v[28:31], a[200:203], a[108:111], v[28:31]
s_add_u32 s10, s9, 5120
v_accvgpr_write_b32 a138, 0
v_accvgpr_write_b32 a139, 0
v_mfma_f32_16x16x32_bf16 v[28:31], a[196:199], a[92:95], v[28:31]
buffer_store_dwordx4 a[236:239], v1, s[44:47], s10 offen sc1
v_mfma_f32_16x16x32_bf16 v[28:31], a[192:195], a[76:79], v[28:31]
s_waitcnt lgkmcnt(0)
v_accvgpr_write_b32 a140, 0
v_accvgpr_write_b32 a141, 0
v_mfma_f32_16x16x32_bf16 v[144:147], a[208:211], a[76:79], v[144:147]
v_accvgpr_write_b32 a142, 0
v_accvgpr_write_b32 a143, 0
v_mfma_f32_16x16x32_bf16 v[144:147], a[212:215], a[92:95], v[144:147]
ds_read_b64_tr_b16 a[192:193], v7 offset:8480
ds_read_b64_tr_b16 a[194:195], v7 offset:8992
v_mfma_f32_16x16x32_bf16 v[144:147], a[216:219], a[108:111], v[144:147]
v_mov_b32 v12, 0xc2469614
v_add_u32 v2, 118784, v1
v_mfma_f32_16x16x32_bf16 v[144:147], a[220:223], a[124:127], v[144:147]
v_add_u32 v3, 4096, v1
v_mfma_f32_16x16x32_bf16 v[184:187], a[220:223], a[120:123], v[184:187]
ds_read_b64_tr_b16 a[196:197], v7 offset:25376
ds_read_b64_tr_b16 a[198:199], v7 offset:25888
v_mfma_f32_16x16x32_bf16 v[184:187], a[216:219], a[104:107], v[184:187]
v_mfma_f32_16x16x32_bf16 v[184:187], a[212:215], a[88:91], v[184:187]
v_mfma_f32_16x16x32_bf16 v[184:187], a[208:211], a[72:75], v[184:187]
ds_read_b64_tr_b16 a[200:201], v7 offset:42272
ds_read_b64_tr_b16 a[202:203], v7 offset:42784
v_mfma_f32_16x16x32_bf16 v[188:191], a[208:211], a[68:71], v[188:191]
v_mfma_f32_16x16x32_bf16 v[188:191], a[212:215], a[84:87], v[188:191]
v_mfma_f32_16x16x32_bf16 v[188:191], a[216:219], a[100:103], v[188:191]
ds_read_b64_tr_b16 a[204:205], v7 offset:59168
ds_read_b64_tr_b16 a[206:207], v7 offset:59680
v_mfma_f32_16x16x32_bf16 v[188:191], a[220:223], a[116:119], v[188:191]
v_mul_f32 v8, v28, v28
v_mul_f32 v9, v29, v29
v_mfma_f32_16x16x32_bf16 v[120:123], a[220:223], a[112:115], v[120:123]
v_mul_f32 v10, v30, v30
v_mul_f32 v11, v31, v31
v_mfma_f32_16x16x32_bf16 v[120:123], a[216:219], a[96:99], v[120:123]
Lpad5:
s_cbranch_execz Lhopback
v_fmaak_f32 v8, v8, v12, 0xc1906ebb
v_fmaak_f32 v9, v9, v12, 0xc1906ebb
v_mfma_f32_16x16x32_bf16 v[120:123], a[212:215], a[80:83], v[120:123]
v_fmaak_f32 v10, v10, v12, 0xc1906ebb
v_fmaak_f32 v11, v11, v12, 0xc1906ebb
v_mfma_f32_16x16x32_bf16 v[120:123], a[208:211], a[64:67], v[120:123]
s_waitcnt lgkmcnt(0)
v_mul_f32 v8, v8, v28
v_mul_f32 v9, v9, v29
v_mfma_f32_16x16x32_bf16 v[84:87], a[192:195], a[64:67], v[84:87]
v_mul_f32 v10, v10, v30
v_mul_f32 v11, v11, v31
v_mfma_f32_16x16x32_bf16 v[84:87], a[196:199], a[80:83], v[84:87]
ds_read_b64_tr_b16 a[208:209], v7 offset:12704
ds_read_b64_tr_b16 a[210:211], v7 offset:13216
v_mfma_f32_16x16x32_bf16 v[84:87], a[200:203], a[96:99], v[84:87]
v_exp_f32 v8, v8
v_mfma_f32_16x16x32_bf16 v[84:87], a[204:207], a[112:115], v[84:87]
v_exp_f32 v9, v9
v_mfma_f32_16x16x32_bf16 v[112:115], a[204:207], a[116:119], v[112:115]
ds_read_b64_tr_b16 a[212:213], v7 offset:29600
ds_read_b64_tr_b16 a[214:215], v7 offset:30112
v_mfma_f32_16x16x32_bf16 v[112:115], a[200:203], a[100:103], v[112:115]
v_exp_f32 v10, v10
v_mfma_f32_16x16x32_bf16 v[112:115], a[196:199], a[84:87], v[112:115]
v_exp_f32 v11, v11
v_mfma_f32_16x16x32_bf16 v[112:115], a[192:195], a[68:71], v[112:115]
ds_read_b64_tr_b16 a[216:217], v7 offset:46496
ds_read_b64_tr_b16 a[218:219], v7 offset:47008
v_mfma_f32_16x16x32_bf16 v[88:91], a[192:195], a[72:75], v[88:91]
v_mul_f32 v28, v28, v144
v_mul_f32 v29, v29, v145
v_mfma_f32_16x16x32_bf16 v[88:91], a[196:199], a[88:91], v[88:91]
v_mul_f32 v30, v30, v146
v_mul_f32 v31, v31, v147
v_mfma_f32_16x16x32_bf16 v[88:91], a[200:203], a[104:107], v[88:91]
ds_read_b64_tr_b16 a[220:221], v7 offset:63392
ds_read_b64_tr_b16 a[222:223], v7 offset:63904
v_mfma_f32_16x16x32_bf16 v[88:91], a[204:207], a[120:123], v[88:91]
v_fma_f32 v8, v8, s98, s98
v_fma_f32 v9, v9, s98, s98
v_mfma_f32_16x16x32_bf16 v[116:119], a[204:207], a[124:127], v[116:119]
v_fma_f32 v10, v10, s98, s98
v_fma_f32 v11, v11, s98, s98
v_mfma_f32_16x16x32_bf16 v[116:119], a[200:203], a[108:111], v[116:119]
v_rcp_f32 v8, v8
v_mfma_f32_16x16x32_bf16 v[116:119], a[196:199], a[92:95], v[116:119]
v_rcp_f32 v9, v9
v_mfma_f32_16x16x32_bf16 v[116:119], a[192:195], a[76:79], v[116:119]
s_waitcnt lgkmcnt(0)
v_rcp_f32 v10, v10
v_mfma_f32_16x16x32_bf16 v[252:255], a[208:211], a[76:79], v[252:255]
v_rcp_f32 v11, v11
v_mfma_f32_16x16x32_bf16 v[252:255], a[212:215], a[92:95], v[252:255]
ds_read_b64_tr_b16 a[192:193], v7 offset:0
ds_read_b64_tr_b16 a[194:195], v7 offset:512
v_mfma_f32_16x16x32_bf16 v[252:255], a[216:219], a[108:111], v[252:255]
v_mul_f32 v28, v28, v8
v_mul_f32 v29, v29, v9
v_mfma_f32_16x16x32_bf16 v[252:255], a[220:223], a[124:127], v[252:255]
v_mul_f32 v30, v30, v10
v_mul_f32 v31, v31, v11
v_mfma_f32_16x16x32_bf16 v[248:251], a[220:223], a[120:123], v[248:251]
ds_read_b64_tr_b16 a[196:197], v7 offset:16896
ds_read_b64_tr_b16 a[198:199], v7 offset:17408
v_mfma_f32_16x16x32_bf16 v[248:251], a[216:219], a[104:107], v[248:251]
v_mul_f32 v8, v56, v56
v_mul_f32 v9, v57, v57
v_mfma_f32_16x16x32_bf16 v[248:251], a[212:215], a[88:91], v[248:251]
v_mul_f32 v10, v58, v58
v_mul_f32 v11, v59, v59
v_mfma_f32_16x16x32_bf16 v[248:251], a[208:211], a[72:75], v[248:251]
ds_read_b64_tr_b16 a[200:201], v7 offset:33792
ds_read_b64_tr_b16 a[202:203], v7 offset:34304
v_mfma_f32_16x16x32_bf16 v[40:43], a[208:211], a[68:71], v[40:43]
v_fmaak_f32 v8, v8, v12, 0xc1906ebb
v_fmaak_f32 v9, v9, v12, 0xc1906ebb
v_mfma_f32_16x16x32_bf16 v[40:43], a[212:215], a[84:87], v[40:43]
v_fmaak_f32 v10, v10, v12, 0xc1906ebb
v_fmaak_f32 v11, v11, v12, 0xc1906ebb
v_mfma_f32_16x16x32_bf16 v[40:43], a[216:219], a[100:103], v[40:43]
ds_read_b64_tr_b16 a[204:205], v7 offset:50688
ds_read_b64_tr_b16 a[206:207], v7 offset:51200
v_mfma_f32_16x16x32_bf16 v[40:43], a[220:223], a[116:119], v[40:43]
v_mul_f32 v8, v8, v56
v_mul_f32 v9, v9, v57
v_mfma_f32_16x16x32_bf16 v[36:39], a[220:223], a[112:115], v[36:39]
v_mul_f32 v10, v10, v58
v_mul_f32 v11, v11, v59
v_mfma_f32_16x16x32_bf16 v[36:39], a[216:219], a[96:99], v[36:39]
v_exp_f32 v8, v8
v_mfma_f32_16x16x32_bf16 v[36:39], a[212:215], a[80:83], v[36:39]
v_exp_f32 v9, v9
v_mfma_f32_16x16x32_bf16 v[36:39], a[208:211], a[64:67], v[36:39]
s_waitcnt lgkmcnt(0)
v_exp_f32 v10, v10
v_mfma_f32_16x16x32_bf16 a[240:243], a[192:195], a[64:67], a[240:243]
v_exp_f32 v11, v11
v_mfma_f32_16x16x32_bf16 a[240:243], a[196:199], a[80:83], a[240:243]
ds_read_b64_tr_b16 a[208:209], v7 offset:32
ds_read_b64_tr_b16 a[210:211], v7 offset:544
v_mfma_f32_16x16x32_bf16 a[240:243], a[200:203], a[96:99], a[240:243]
v_mul_f32 v56, v56, v184
v_mul_f32 v57, v57, v185
v_mfma_f32_16x16x32_bf16 a[240:243], a[204:207], a[112:115], a[240:243]
v_mul_f32 v58, v58, v186
v_mul_f32 v59, v59, v187
v_mfma_f32_16x16x32_bf16 a[244:247], a[204:207], a[116:119], a[244:247]
ds_read_b64_tr_b16 a[212:213], v7 offset:16928
ds_read_b64_tr_b16 a[214:215], v7 offset:17440
v_mfma_f32_16x16x32_bf16 a[244:247], a[200:203], a[100:103], a[244:247]
v_fma_f32 v8, v8, s98, s98
v_fma_f32 v9, v9, s98, s98
v_mfma_f32_16x16x32_bf16 a[244:247], a[196:199], a[84:87], a[244:247]
v_fma_f32 v10, v10, s98, s98
v_fma_f32 v11, v11, s98, s98
v_mfma_f32_16x16x32_bf16 a[244:247], a[192:195], a[68:71], a[244:247]
ds_read_b64_tr_b16 a[216:217], v7 offset:33824
ds_read_b64_tr_b16 a[218:219], v7 offset:34336
v_mfma_f32_16x16x32_bf16 a[248:251], a[192:195], a[72:75], a[248:251]
v_rcp_f32 v8, v8
v_mfma_f32_16x16x32_bf16 a[248:251], a[196:199], a[88:91], a[248:251]
v_rcp_f32 v9, v9
v_mfma_f32_16x16x32_bf16 a[248:251], a[200:203], a[104:107], a[248:251]
ds_read_b64_tr_b16 a[220:221], v7 offset:50720
ds_read_b64_tr_b16 a[222:223], v7 offset:51232
v_mfma_f32_16x16x32_bf16 a[248:251], a[204:207], a[120:123], a[248:251]
v_rcp_f32 v10, v10
v_mfma_f32_16x16x32_bf16 a[252:255], a[204:207], a[124:127], a[252:255]
v_rcp_f32 v11, v11
v_mfma_f32_16x16x32_bf16 a[252:255], a[200:203], a[108:111], a[252:255]
buffer_load_dword v14, v5, s[48:51], 0 offen sc1
v_mfma_f32_16x16x32_bf16 a[252:255], a[196:199], a[92:95], a[252:255]
v_mul_f32 v56, v56, v8
v_mul_f32 v57, v57, v9
v_mfma_f32_16x16x32_bf16 a[252:255], a[192:195], a[76:79], a[252:255]
s_waitcnt lgkmcnt(0)
v_mul_f32 v58, v58, v10
v_mul_f32 v59, v59, v11
v_mfma_f32_16x16x32_bf16 v[132:135], a[208:211], a[76:79], v[132:135]
v_mul_f32 v8, v116, v116
v_mul_f32 v9, v117, v117
v_mfma_f32_16x16x32_bf16 v[132:135], a[212:215], a[92:95], v[132:135]
ds_read_b64_tr_b16 a[192:193], v7 offset:256
ds_read_b64_tr_b16 a[194:195], v7 offset:768
v_mfma_f32_16x16x32_bf16 v[132:135], a[216:219], a[108:111], v[132:135]
v_mul_f32 v10, v118, v118
v_mul_f32 v11, v119, v119
v_mfma_f32_16x16x32_bf16 v[132:135], a[220:223], a[124:127], v[132:135]
s_add_u32 s10, s9, 8192
v_fmaak_f32 v8, v8, v12, 0xc1906ebb
v_fmaak_f32 v9, v9, v12, 0xc1906ebb
v_mfma_f32_16x16x32_bf16 v[128:131], a[220:223], a[120:123], v[128:131]
ds_read_b64_tr_b16 a[196:197], v7 offset:17152
ds_read_b64_tr_b16 a[198:199], v7 offset:17664
v_mfma_f32_16x16x32_bf16 v[128:131], a[216:219], a[104:107], v[128:131]
buffer_store_dwordx4 a[236:239], v1, s[44:47], s10 offen sc1
v_mfma_f32_16x16x32_bf16 v[128:131], a[212:215], a[88:91], v[128:131]
v_fmaak_f32 v10, v10, v12, 0xc1906ebb
v_fmaak_f32 v11, v11, v12, 0xc1906ebb
v_mfma_f32_16x16x32_bf16 v[128:131], a[208:211], a[72:75], v[128:131]
ds_read_b64_tr_b16 a[200:201], v7 offset:34048
ds_read_b64_tr_b16 a[202:203], v7 offset:34560
v_mfma_f32_16x16x32_bf16 v[164:167], a[208:211], a[68:71], v[164:167]
v_mul_f32 v8, v8, v116
v_mul_f32 v9, v9, v117
v_mfma_f32_16x16x32_bf16 v[164:167], a[212:215], a[84:87], v[164:167]
v_mul_f32 v10, v10, v118
v_mul_f32 v11, v11, v119
v_mfma_f32_16x16x32_bf16 v[164:167], a[216:219], a[100:103], v[164:167]
ds_read_b64_tr_b16 a[204:205], v7 offset:50944
ds_read_b64_tr_b16 a[206:207], v7 offset:51456
v_mfma_f32_16x16x32_bf16 v[164:167], a[220:223], a[116:119], v[164:167]
v_exp_f32 v8, v8
v_mfma_f32_16x16x32_bf16 v[160:163], a[220:223], a[112:115], v[160:163]
v_exp_f32 v9, v9
v_mfma_f32_16x16x32_bf16 v[160:163], a[216:219], a[96:99], v[160:163]
v_exp_f32 v10, v10
v_mfma_f32_16x16x32_bf16 v[160:163], a[212:215], a[80:83], v[160:163]
v_exp_f32 v11, v11
v_mfma_f32_16x16x32_bf16 v[160:163], a[208:211], a[64:67], v[160:163]
s_waitcnt lgkmcnt(0)
v_mul_f32 v116, v116, v252
v_mul_f32 v117, v117, v253
v_mfma_f32_16x16x32_bf16 v[196:199], a[192:195], a[64:67], v[196:199]
v_mul_f32 v118, v118, v254
v_mul_f32 v119, v119, v255
v_mfma_f32_16x16x32_bf16 v[196:199], a[196:199], a[80:83], v[196:199]
ds_read_b64_tr_b16 a[208:209], v7 offset:288
ds_read_b64_tr_b16 a[210:211], v7 offset:800
v_mfma_f32_16x16x32_bf16 v[196:199], a[200:203], a[96:99], v[196:199]
v_fma_f32 v8, v8, s98, s98
v_fma_f32 v9, v9, s98, s98
v_mfma_f32_16x16x32_bf16 v[196:199], a[204:207], a[112:115], v[196:199]
v_fma_f32 v10, v10, s98, s98
v_fma_f32 v11, v11, s98, s98
v_mfma_f32_16x16x32_bf16 v[192:195], a[204:207], a[116:119], v[192:195]
ds_read_b64_tr_b16 a[212:213], v7 offset:17184
ds_read_b64_tr_b16 a[214:215], v7 offset:17696
v_mfma_f32_16x16x32_bf16 v[192:195], a[200:203], a[100:103], v[192:195]
v_rcp_f32 v8, v8
v_mfma_f32_16x16x32_bf16 v[192:195], a[196:199], a[84:87], v[192:195]
v_rcp_f32 v9, v9
v_mfma_f32_16x16x32_bf16 v[192:195], a[192:195], a[68:71], v[192:195]
ds_read_b64_tr_b16 a[216:217], v7 offset:34080
ds_read_b64_tr_b16 a[218:219], v7 offset:34592
v_mfma_f32_16x16x32_bf16 v[16:19], a[192:195], a[72:75], v[16:19]
v_rcp_f32 v10, v10
v_mfma_f32_16x16x32_bf16 v[16:19], a[196:199], a[88:91], v[16:19]
v_rcp_f32 v11, v11
v_mfma_f32_16x16x32_bf16 v[16:19], a[200:203], a[104:107], v[16:19]
ds_read_b64_tr_b16 a[220:221], v7 offset:50976
ds_read_b64_tr_b16 a[222:223], v7 offset:51488
v_mfma_f32_16x16x32_bf16 v[16:19], a[204:207], a[120:123], v[16:19]
v_mul_f32 v116, v116, v8
v_mul_f32 v117, v117, v9
v_mfma_f32_16x16x32_bf16 v[228:231], a[204:207], a[124:127], v[228:231]
v_mul_f32 v118, v118, v10
v_mul_f32 v119, v119, v11
v_mfma_f32_16x16x32_bf16 v[228:231], a[200:203], a[108:111], v[228:231]
v_cvt_pk_bf16_f32 v28, v28, v29
v_cvt_pk_bf16_f32 v29, v30, v31
v_mfma_f32_16x16x32_bf16 v[228:231], a[196:199], a[92:95], v[228:231]
v_cvt_pk_bf16_f32 v30, v116, v117
v_cvt_pk_bf16_f32 v31, v118, v119
v_mfma_f32_16x16x32_bf16 v[228:231], a[192:195], a[76:79], v[228:231]
s_waitcnt lgkmcnt(0)
v_mfma_f32_16x16x32_bf16 v[224:227], a[208:211], a[76:79], v[224:227]
buffer_store_dwordx4 v[28:31], v3, s[36:39], s57 offen sc1
v_mfma_f32_16x16x32_bf16 v[224:227], a[212:215], a[92:95], v[224:227]
ds_read_b64_tr_b16 a[192:193], v7 offset:4224
ds_read_b64_tr_b16 a[194:195], v7 offset:4736
v_mfma_f32_16x16x32_bf16 v[224:227], a[216:219], a[108:111], v[224:227]
v_accvgpr_read_b32 v8, a252
v_accvgpr_read_b32 v9, a253
v_mfma_f32_16x16x32_bf16 v[224:227], a[220:223], a[124:127], v[224:227]
v_accvgpr_read_b32 v10, a254
v_accvgpr_read_b32 v11, a255
v_mfma_f32_16x16x32_bf16 v[236:239], a[220:223], a[120:123], v[236:239]
ds_read_b64_tr_b16 a[196:197], v7 offset:21120
ds_read_b64_tr_b16 a[198:199], v7 offset:21632
v_mfma_f32_16x16x32_bf16 v[236:239], a[216:219], a[104:107], v[236:239]
v_cvt_pk_bf16_f32 v8, v8, v9
v_cvt_pk_bf16_f32 v9, v10, v11
v_mfma_f32_16x16x32_bf16 v[236:239], a[212:215], a[88:91], v[236:239]
v_cvt_pk_bf16_f32 v10, v132, v133
v_cvt_pk_bf16_f32 v11, v134, v135
v_mfma_f32_16x16x32_bf16 v[236:239], a[208:211], a[72:75], v[236:239]
ds_read_b64_tr_b16 a[200:201], v7 offset:38016
ds_read_b64_tr_b16 a[202:203], v7 offset:38528
v_mfma_f32_16x16x32_bf16 v[44:47], a[208:211], a[68:71], v[44:47]
v_accvgpr_write_b32 a48, v8
v_accvgpr_write_b32 a49, v9
v_mfma_f32_16x16x32_bf16 v[44:47], a[212:215], a[84:87], v[44:47]
v_accvgpr_write_b32 a50, v10
v_accvgpr_write_b32 a51, v11
v_mfma_f32_16x16x32_bf16 v[44:47], a[216:219], a[100:103], v[44:47]
ds_read_b64_tr_b16 a[204:205], v7 offset:54912
ds_read_b64_tr_b16 a[206:207], v7 offset:55424
v_mfma_f32_16x16x32_bf16 v[44:47], a[220:223], a[116:119], v[44:47]
s_add_u32 s10, s9, 9216
v_accvgpr_read_b32 v8, a248
v_accvgpr_read_b32 v9, a249
v_mfma_f32_16x16x32_bf16 v[232:235], a[220:223], a[112:115], v[232:235]
buffer_store_dwordx4 a[236:239], v1, s[44:47], s10 offen sc1
v_mfma_f32_16x16x32_bf16 v[232:235], a[216:219], a[96:99], v[232:235]
v_accvgpr_read_b32 v10, a250
v_accvgpr_read_b32 v11, a251
v_mfma_f32_16x16x32_bf16 v[232:235], a[212:215], a[80:83], v[232:235]
v_cvt_pk_bf16_f32 v8, v8, v9
v_cvt_pk_bf16_f32 v9, v10, v11
v_mfma_f32_16x16x32_bf16 v[232:235], a[208:211], a[64:67], v[232:235]
s_waitcnt lgkmcnt(0)
v_cvt_pk_bf16_f32 v10, v128, v129
v_cvt_pk_bf16_f32 v11, v130, v131
v_mfma_f32_16x16x32_bf16 v[204:207], a[192:195], a[64:67], v[204:207]
v_accvgpr_write_b32 a32, v8
v_accvgpr_write_b32 a33, v9
v_mfma_f32_16x16x32_bf16 v[204:207], a[196:199], a[80:83], v[204:207]
ds_read_b64_tr_b16 a[208:209], v7 offset:4256
ds_read_b64_tr_b16 a[210:211], v7 offset:4768
v_mfma_f32_16x16x32_bf16 v[204:207], a[200:203], a[96:99], v[204:207]
v_accvgpr_write_b32 a34, v10
v_accvgpr_write_b32 a35, v11
v_mfma_f32_16x16x32_bf16 v[204:207], a[204:207], a[112:115], v[204:207]
v_accvgpr_read_b32 v8, a244
v_accvgpr_read_b32 v9, a245
v_mfma_f32_16x16x32_bf16 v[200:203], a[204:207], a[116:119], v[200:203]
ds_read_b64_tr_b16 a[212:213], v7 offset:21152
ds_read_b64_tr_b16 a[214:215], v7 offset:21664
v_mfma_f32_16x16x32_bf16 v[200:203], a[200:203], a[100:103], v[200:203]
v_accvgpr_read_b32 v10, a246
v_accvgpr_read_b32 v11, a247
v_mfma_f32_16x16x32_bf16 v[200:203], a[196:199], a[84:87], v[200:203]
v_cvt_pk_bf16_f32 v8, v8, v9
v_cvt_pk_bf16_f32 v9, v10, v11
v_mfma_f32_16x16x32_bf16 v[200:203], a[192:195], a[68:71], v[200:203]
ds_read_b64_tr_b16 a[216:217], v7 offset:38048
ds_read_b64_tr_b16 a[218:219], v7 offset:38560
v_mfma_f32_16x16x32_bf16 v[72:75], a[192:195], a[72:75], v[72:75]
s_waitcnt vmcnt(3)
v_cmp_gt_u32 vcc, 1, v14
s_mov_b32 s55, 0x200000
s_nop 0
s_cbranch_vccnz Lkv_ld
Lkv_ok:
v_mfma_f32_16x16x32_bf16 v[72:75], a[196:199], a[88:91], v[72:75]
v_cvt_pk_bf16_f32 v10, v164, v165
v_cvt_pk_bf16_f32 v11, v166, v167
v_mfma_f32_16x16x32_bf16 v[72:75], a[200:203], a[104:107], v[72:75]
ds_read_b64_tr_b16 a[220:221], v7 offset:54944
ds_read_b64_tr_b16 a[222:223], v7 offset:55456
v_mfma_f32_16x16x32_bf16 v[72:75], a[204:207], a[120:123], v[72:75]
s_lshl_b32 s60, s30, 12
s_add_u32 m0, s60, 135168
v_mfma_f32_16x16x32_bf16 v[172:175], a[204:207], a[124:127], v[172:175]
buffer_load_dwordx4 v1, s[32:35], s60 offen offset:0 sc1 lds
v_mfma_f32_16x16x32_bf16 v[172:175], a[200:203], a[108:111], v[172:175]
v_accvgpr_write_b32 a16, v8
v_accvgpr_write_b32 a17, v9
v_mfma_f32_16x16x32_bf16 v[172:175], a[196:199], a[92:95], v[172:175]
v_accvgpr_write_b32 a18, v10
v_accvgpr_write_b32 a19, v11
v_mfma_f32_16x16x32_bf16 v[172:175], a[192:195], a[76:79], v[172:175]
s_waitcnt lgkmcnt(0)
v_accvgpr_read_b32 v8, a240
v_accvgpr_read_b32 v9, a241
v_mfma_f32_16x16x32_bf16 v[168:171], a[208:211], a[76:79], v[168:171]
v_accvgpr_read_b32 v10, a242
v_accvgpr_read_b32 v11, a243
v_mfma_f32_16x16x32_bf16 v[168:171], a[212:215], a[92:95], v[168:171]
ds_read_b64_tr_b16 a[192:193], v7 offset:4480
ds_read_b64_tr_b16 a[194:195], v7 offset:4992
v_mfma_f32_16x16x32_bf16 v[168:171], a[216:219], a[108:111], v[168:171]
buffer_load_dwordx4 v1, s[32:35], s60 offen offset:1024 sc1 lds
v_mfma_f32_16x16x32_bf16 v[168:171], a[220:223], a[124:127], v[168:171]
v_cvt_pk_bf16_f32 v8, v8, v9
v_cvt_pk_bf16_f32 v9, v10, v11
v_mfma_f32_16x16x32_bf16 v[140:143], a[220:223], a[120:123], v[140:143]
ds_read_b64_tr_b16 a[196:197], v7 offset:21376
ds_read_b64_tr_b16 a[198:199], v7 offset:21888
v_mfma_f32_16x16x32_bf16 v[140:143], a[216:219], a[104:107], v[140:143]
v_cvt_pk_bf16_f32 v10, v160, v161
v_cvt_pk_bf16_f32 v11, v162, v163
v_mfma_f32_16x16x32_bf16 v[140:143], a[212:215], a[88:91], v[140:143]
buffer_load_dwordx4 v1, s[32:35], s60 offen offset:2048 sc1 lds
v_mfma_f32_16x16x32_bf16 v[140:143], a[208:211], a[72:75], v[140:143]
ds_read_b64_tr_b16 a[200:201], v7 offset:38272
ds_read_b64_tr_b16 a[202:203], v7 offset:38784
v_mfma_f32_16x16x32_bf16 v[100:103], a[208:211], a[68:71], v[100:103]
v_accvgpr_write_b32 a0, v8
v_accvgpr_write_b32 a1, v9
v_mfma_f32_16x16x32_bf16 v[100:103], a[212:215], a[84:87], v[100:103]
v_accvgpr_write_b32 a2, v10
v_accvgpr_write_b32 a3, v11
v_mfma_f32_16x16x32_bf16 v[100:103], a[216:219], a[100:103], v[100:103]
ds_read_b64_tr_b16 a[204:205], v7 offset:55168
ds_read_b64_tr_b16 a[206:207], v7 offset:55680
v_mfma_f32_16x16x32_bf16 v[100:103], a[220:223], a[116:119], v[100:103]
buffer_load_dwordx4 v1, s[32:35], s60 offen offset:3072 sc1 lds
v_mfma_f32_16x16x32_bf16 v[136:139], a[220:223], a[112:115], v[136:139]
s_lshl_b32 s61, s30, 13
v_cvt_pk_bf16_f32 v228, v228, v229
v_cvt_pk_bf16_f32 v229, v230, v231
v_mfma_f32_16x16x32_bf16 v[136:139], a[216:219], a[96:99], v[136:139]
s_add_u32 s60, s61, 16384
v_cvt_pk_bf16_f32 v230, v224, v225
v_cvt_pk_bf16_f32 v231, v226, v227
v_mfma_f32_16x16x32_bf16 v[136:139], a[212:215], a[80:83], v[136:139]
s_add_u32 m0, s61, 0
v_accvgpr_write_b32 a52, v228
v_accvgpr_write_b32 a53, v229
v_mfma_f32_16x16x32_bf16 v[136:139], a[208:211], a[64:67], v[136:139]
s_waitcnt lgkmcnt(0)
v_accvgpr_write_b32 a54, v230
v_accvgpr_write_b32 a55, v231
v_mfma_f32_16x16x32_bf16 v[108:111], a[192:195], a[64:67], v[108:111]
buffer_load_dwordx4 v1, s[32:35], s60 offen offset:0 sc1 lds
v_mfma_f32_16x16x32_bf16 v[108:111], a[196:199], a[80:83], v[108:111]
ds_read_b64_tr_b16 a[208:209], v7 offset:4512
ds_read_b64_tr_b16 a[210:211], v7 offset:5024
v_mfma_f32_16x16x32_bf16 v[108:111], a[200:203], a[96:99], v[108:111]
v_cvt_pk_bf16_f32 v16, v16, v17
v_cvt_pk_bf16_f32 v17, v18, v19
v_mfma_f32_16x16x32_bf16 v[108:111], a[204:207], a[112:115], v[108:111]
v_cvt_pk_bf16_f32 v18, v236, v237
v_cvt_pk_bf16_f32 v19, v238, v239
v_mfma_f32_16x16x32_bf16 v[104:107], a[204:207], a[116:119], v[104:107]
ds_read_b64_tr_b16 a[212:213], v7 offset:21408
ds_read_b64_tr_b16 a[214:215], v7 offset:21920
v_mfma_f32_16x16x32_bf16 v[104:107], a[200:203], a[100:103], v[104:107]
buffer_load_dwordx4 v1, s[32:35], s60 offen offset:1024 sc1 lds
v_mfma_f32_16x16x32_bf16 v[104:107], a[196:199], a[84:87], v[104:107]
v_accvgpr_write_b32 a36, v16
v_accvgpr_write_b32 a37, v17
v_mfma_f32_16x16x32_bf16 v[104:107], a[192:195], a[68:71], v[104:107]
ds_read_b64_tr_b16 a[216:217], v7 offset:38304
ds_read_b64_tr_b16 a[218:219], v7 offset:38816
v_mfma_f32_16x16x32_bf16 v[80:83], a[192:195], a[72:75], v[80:83]
v_accvgpr_write_b32 a38, v18
v_accvgpr_write_b32 a39, v19
v_mfma_f32_16x16x32_bf16 v[80:83], a[196:199], a[88:91], v[80:83]
v_cvt_pk_bf16_f32 v192, v192, v193
v_cvt_pk_bf16_f32 v193, v194, v195
v_mfma_f32_16x16x32_bf16 v[80:83], a[200:203], a[104:107], v[80:83]
ds_read_b64_tr_b16 a[220:221], v7 offset:55200
ds_read_b64_tr_b16 a[222:223], v7 offset:55712
v_mfma_f32_16x16x32_bf16 v[80:83], a[204:207], a[120:123], v[80:83]
buffer_load_dwordx4 v1, s[32:35], s60 offen offset:2048 sc1 lds
v_mfma_f32_16x16x32_bf16 v[76:79], a[204:207], a[124:127], v[76:79]
v_cvt_pk_bf16_f32 v194, v44, v45
v_cvt_pk_bf16_f32 v195, v46, v47
v_mfma_f32_16x16x32_bf16 v[76:79], a[200:203], a[108:111], v[76:79]
v_accvgpr_write_b32 a20, v192
v_accvgpr_write_b32 a21, v193
v_mfma_f32_16x16x32_bf16 v[76:79], a[196:199], a[92:95], v[76:79]
v_accvgpr_write_b32 a22, v194
v_accvgpr_write_b32 a23, v195
v_mfma_f32_16x16x32_bf16 v[76:79], a[192:195], a[76:79], v[76:79]
s_waitcnt lgkmcnt(0)
v_cvt_pk_bf16_f32 v196, v196, v197
v_cvt_pk_bf16_f32 v197, v198, v199
v_mfma_f32_16x16x32_bf16 v[52:55], a[208:211], a[76:79], v[52:55]
buffer_load_dwordx4 v1, s[32:35], s60 offen offset:3072 sc1 lds
v_mfma_f32_16x16x32_bf16 v[52:55], a[212:215], a[92:95], v[52:55]
ds_read_b64_tr_b16 a[192:193], v7 offset:8704
ds_read_b64_tr_b16 a[194:195], v7 offset:9216
v_mfma_f32_16x16x32_bf16 v[52:55], a[216:219], a[108:111], v[52:55]
s_add_u32 s60, s60, 4096
v_cvt_pk_bf16_f32 v198, v232, v233
v_cvt_pk_bf16_f32 v199, v234, v235
v_mfma_f32_16x16x32_bf16 v[52:55], a[220:223], a[124:127], v[52:55]
s_add_u32 m0, s61, 4096
v_accvgpr_write_b32 a4, v196
v_accvgpr_write_b32 a5, v197
v_mfma_f32_16x16x32_bf16 v[48:51], a[220:223], a[120:123], v[48:51]
ds_read_b64_tr_b16 a[196:197], v7 offset:25600
ds_read_b64_tr_b16 a[198:199], v7 offset:26112
v_mfma_f32_16x16x32_bf16 v[48:51], a[216:219], a[104:107], v[48:51]
buffer_load_dwordx4 v1, s[32:35], s60 offen offset:0 sc1 lds
v_mfma_f32_16x16x32_bf16 v[48:51], a[212:215], a[88:91], v[48:51]
v_accvgpr_write_b32 a6, v198
v_accvgpr_write_b32 a7, v199
v_mfma_f32_16x16x32_bf16 v[48:51], a[208:211], a[72:75], v[48:51]
ds_read_b64_tr_b16 a[200:201], v7 offset:42496
ds_read_b64_tr_b16 a[202:203], v7 offset:43008
v_mfma_f32_16x16x32_bf16 v[24:27], a[208:211], a[68:71], v[24:27]
v_cvt_pk_bf16_f32 v172, v172, v173
v_cvt_pk_bf16_f32 v173, v174, v175
v_mfma_f32_16x16x32_bf16 v[24:27], a[212:215], a[84:87], v[24:27]
buffer_load_dwordx4 v1, s[32:35], s60 offen offset:1024 sc1 lds
v_mfma_f32_16x16x32_bf16 v[24:27], a[216:219], a[100:103], v[24:27]
ds_read_b64_tr_b16 a[204:205], v7 offset:59392
ds_read_b64_tr_b16 a[206:207], v7 offset:59904
v_mfma_f32_16x16x32_bf16 v[24:27], a[220:223], a[116:119], v[24:27]
v_cvt_pk_bf16_f32 v174, v168, v169
v_cvt_pk_bf16_f32 v175, v170, v171
v_mfma_f32_16x16x32_bf16 v[20:23], a[220:223], a[112:115], v[20:23]
v_accvgpr_write_b32 a56, v172
v_accvgpr_write_b32 a57, v173
v_mfma_f32_16x16x32_bf16 v[20:23], a[216:219], a[96:99], v[20:23]
v_accvgpr_write_b32 a58, v174
v_accvgpr_write_b32 a59, v175
v_mfma_f32_16x16x32_bf16 v[20:23], a[212:215], a[80:83], v[20:23]
buffer_load_dwordx4 v1, s[32:35], s60 offen offset:2048 sc1 lds
v_mfma_f32_16x16x32_bf16 v[20:23], a[208:211], a[64:67], v[20:23]
s_waitcnt lgkmcnt(0)
v_cvt_pk_bf16_f32 v72, v72, v73
v_cvt_pk_bf16_f32 v73, v74, v75
v_mfma_f32_16x16x32_bf16 v[180:183], a[192:195], a[64:67], v[180:183]
v_cvt_pk_bf16_f32 v74, v140, v141
v_cvt_pk_bf16_f32 v75, v142, v143
v_mfma_f32_16x16x32_bf16 v[180:183], a[196:199], a[80:83], v[180:183]
ds_read_b64_tr_b16 a[208:209], v7 offset:12928
ds_read_b64_tr_b16 a[210:211], v7 offset:13440
v_mfma_f32_16x16x32_bf16 v[180:183], a[200:203], a[96:99], v[180:183]
v_accvgpr_write_b32 a40, v72
v_accvgpr_write_b32 a41, v73
v_mfma_f32_16x16x32_bf16 v[180:183], a[204:207], a[112:115], v[180:183]
v_accvgpr_write_b32 a42, v74
v_accvgpr_write_b32 a43, v75
v_mfma_f32_16x16x32_bf16 v[176:179], a[204:207], a[116:119], v[176:179]
ds_read_b64_tr_b16 a[212:213], v7 offset:29824
ds_read_b64_tr_b16 a[214:215], v7 offset:30336
v_mfma_f32_16x16x32_bf16 v[176:179], a[200:203], a[100:103], v[176:179]
buffer_load_dwordx4 v1, s[32:35], s60 offen offset:3072 sc1 lds
v_mfma_f32_16x16x32_bf16 v[176:179], a[196:199], a[84:87], v[176:179]
v_cvt_pk_bf16_f32 v200, v200, v201
v_cvt_pk_bf16_f32 v201, v202, v203
v_mfma_f32_16x16x32_bf16 v[176:179], a[192:195], a[68:71], v[176:179]
ds_read_b64_tr_b16 a[216:217], v7 offset:46720
ds_read_b64_tr_b16 a[218:219], v7 offset:47232
v_mfma_f32_16x16x32_bf16 v[244:247], a[192:195], a[72:75], v[244:247]
v_cvt_pk_bf16_f32 v202, v100, v101
v_cvt_pk_bf16_f32 v203, v102, v103
v_mfma_f32_16x16x32_bf16 v[244:247], a[196:199], a[88:91], v[244:247]
v_accvgpr_write_b32 a24, v200
v_accvgpr_write_b32 a25, v201
v_mfma_f32_16x16x32_bf16 v[244:247], a[200:203], a[104:107], v[244:247]
ds_read_b64_tr_b16 a[220:221], v7 offset:63616
ds_read_b64_tr_b16 a[222:223], v7 offset:64128
v_mfma_f32_16x16x32_bf16 v[244:247], a[204:207], a[120:123], v[244:247]
v_accvgpr_write_b32 a26, v202
v_accvgpr_write_b32 a27, v203
v_mfma_f32_16x16x32_bf16 v[240:243], a[204:207], a[124:127], v[240:243]
v_cvt_pk_bf16_f32 v204, v204, v205
v_cvt_pk_bf16_f32 v205, v206, v207
v_mfma_f32_16x16x32_bf16 v[240:243], a[200:203], a[108:111], v[240:243]
s_add_u32 s10, s9, 10240
v_cvt_pk_bf16_f32 v206, v136, v137
v_cvt_pk_bf16_f32 v207, v138, v139
v_mfma_f32_16x16x32_bf16 v[240:243], a[196:199], a[92:95], v[240:243]
buffer_store_dwordx4 a[236:239], v1, s[44:47], s10 offen sc1
v_mfma_f32_16x16x32_bf16 v[240:243], a[192:195], a[76:79], v[240:243]
s_waitcnt lgkmcnt(0)
v_accvgpr_write_b32 a8, v204
v_accvgpr_write_b32 a9, v205
v_mfma_f32_16x16x32_bf16 v[156:159], a[208:211], a[76:79], v[156:159]
v_accvgpr_write_b32 a10, v206
v_accvgpr_write_b32 a11, v207
v_mfma_f32_16x16x32_bf16 v[156:159], a[212:215], a[92:95], v[156:159]
ds_read_b64_tr_b16 a[192:193], v7 offset:8736
ds_read_b64_tr_b16 a[194:195], v7 offset:9248
v_mfma_f32_16x16x32_bf16 v[156:159], a[216:219], a[108:111], v[156:159]
v_cvt_pk_bf16_f32 v76, v76, v77
v_cvt_pk_bf16_f32 v77, v78, v79
v_mfma_f32_16x16x32_bf16 v[156:159], a[220:223], a[124:127], v[156:159]
v_cvt_pk_bf16_f32 v78, v52, v53
v_cvt_pk_bf16_f32 v79, v54, v55
v_mfma_f32_16x16x32_bf16 v[212:215], a[220:223], a[120:123], v[212:215]
ds_read_b64_tr_b16 a[196:197], v7 offset:25632
ds_read_b64_tr_b16 a[198:199], v7 offset:26144
v_mfma_f32_16x16x32_bf16 v[212:215], a[216:219], a[104:107], v[212:215]
v_accvgpr_write_b32 a60, v76
v_accvgpr_write_b32 a61, v77
v_mfma_f32_16x16x32_bf16 v[212:215], a[212:215], a[88:91], v[212:215]
v_accvgpr_write_b32 a62, v78
v_accvgpr_write_b32 a63, v79
v_mfma_f32_16x16x32_bf16 v[212:215], a[208:211], a[72:75], v[212:215]
ds_read_b64_tr_b16 a[200:201], v7 offset:42528
ds_read_b64_tr_b16 a[202:203], v7 offset:43040
v_mfma_f32_16x16x32_bf16 v[92:95], a[208:211], a[68:71], v[92:95]
v_cvt_pk_bf16_f32 v80, v80, v81
v_cvt_pk_bf16_f32 v81, v82, v83
v_mfma_f32_16x16x32_bf16 v[92:95], a[212:215], a[84:87], v[92:95]
v_cvt_pk_bf16_f32 v82, v48, v49
v_cvt_pk_bf16_f32 v83, v50, v51
v_mfma_f32_16x16x32_bf16 v[92:95], a[216:219], a[100:103], v[92:95]
ds_read_b64_tr_b16 a[204:205], v7 offset:59424
ds_read_b64_tr_b16 a[206:207], v7 offset:59936
v_mfma_f32_16x16x32_bf16 v[92:95], a[220:223], a[116:119], v[92:95]
v_accvgpr_write_b32 a44, v80
v_accvgpr_write_b32 a45, v81
v_mfma_f32_16x16x32_bf16 v[96:99], a[220:223], a[112:115], v[96:99]
v_accvgpr_write_b32 a46, v82
v_accvgpr_write_b32 a47, v83
v_mfma_f32_16x16x32_bf16 v[96:99], a[216:219], a[96:99], v[96:99]
Lpad6:
s_cbranch_execz Lhopback
v_cvt_pk_bf16_f32 v104, v104, v105
v_cvt_pk_bf16_f32 v105, v106, v107
v_mfma_f32_16x16x32_bf16 v[96:99], a[212:215], a[80:83], v[96:99]
v_cvt_pk_bf16_f32 v106, v24, v25
v_cvt_pk_bf16_f32 v107, v26, v27
v_mfma_f32_16x16x32_bf16 v[96:99], a[208:211], a[64:67], v[96:99]
s_waitcnt lgkmcnt(0)
v_accvgpr_write_b32 a28, v104
v_accvgpr_write_b32 a29, v105
v_mfma_f32_16x16x32_bf16 v[124:127], a[192:195], a[64:67], v[124:127]
v_accvgpr_write_b32 a30, v106
v_accvgpr_write_b32 a31, v107
v_mfma_f32_16x16x32_bf16 v[124:127], a[196:199], a[80:83], v[124:127]
ds_read_b64_tr_b16 a[208:209], v7 offset:12960
ds_read_b64_tr_b16 a[210:211], v7 offset:13472
v_mfma_f32_16x16x32_bf16 v[124:127], a[200:203], a[96:99], v[124:127]
v_cvt_pk_bf16_f32 v108, v108, v109
v_cvt_pk_bf16_f32 v109, v110, v111
v_mfma_f32_16x16x32_bf16 v[124:127], a[204:207], a[112:115], v[124:127]
v_cvt_pk_bf16_f32 v110, v20, v21
v_cvt_pk_bf16_f32 v111, v22, v23
v_mfma_f32_16x16x32_bf16 v[64:67], a[204:207], a[116:119], v[64:67]
ds_read_b64_tr_b16 a[212:213], v7 offset:29856
ds_read_b64_tr_b16 a[214:215], v7 offset:30368
v_mfma_f32_16x16x32_bf16 v[64:67], a[200:203], a[100:103], v[64:67]
v_accvgpr_write_b32 a12, v108
v_accvgpr_write_b32 a13, v109
v_mfma_f32_16x16x32_bf16 v[64:67], a[196:199], a[84:87], v[64:67]
s_add_u32 s10, s9, 11264
v_accvgpr_write_b32 a14, v110
v_accvgpr_write_b32 a15, v111
v_mfma_f32_16x16x32_bf16 v[64:67], a[192:195], a[68:71], v[64:67]
ds_read_b64_tr_b16 a[216:217], v7 offset:46752
ds_read_b64_tr_b16 a[218:219], v7 offset:47264
v_mfma_f32_16x16x32_bf16 v[68:71], a[192:195], a[72:75], v[68:71]
buffer_store_dwordx4 a[236:239], v1, s[44:47], s10 offen sc1
v_mfma_f32_16x16x32_bf16 v[68:71], a[196:199], a[88:91], v[68:71]
v_mul_f32 v8, v88, v88
v_mul_f32 v9, v89, v89
v_mfma_f32_16x16x32_bf16 v[68:71], a[200:203], a[104:107], v[68:71]
ds_read_b64_tr_b16 a[220:221], v7 offset:63648
ds_read_b64_tr_b16 a[222:223], v7 offset:64160
v_mfma_f32_16x16x32_bf16 v[68:71], a[204:207], a[120:123], v[68:71]
v_mul_f32 v10, v90, v90
v_mul_f32 v11, v91, v91
v_mfma_f32_16x16x32_bf16 v[148:151], a[204:207], a[124:127], v[148:151]
v_fmaak_f32 v8, v8, v12, 0xc1906ebb
v_fmaak_f32 v9, v9, v12, 0xc1906ebb
v_mfma_f32_16x16x32_bf16 v[148:151], a[200:203], a[108:111], v[148:151]
v_fmaak_f32 v10, v10, v12, 0xc1906ebb
v_fmaak_f32 v11, v11, v12, 0xc1906ebb
v_mfma_f32_16x16x32_bf16 v[148:151], a[196:199], a[92:95], v[148:151]
v_mul_f32 v8, v8, v88
v_mul_f32 v9, v9, v89
v_mfma_f32_16x16x32_bf16 v[148:151], a[192:195], a[76:79], v[148:151]
s_waitcnt vmcnt(10) lgkmcnt(0)
s_barrier
v_mfma_f32_16x16x32_bf16 v[152:155], a[208:211], a[76:79], v[152:155]
v_mfma_f32_16x16x32_bf16 v[152:155], a[212:215], a[92:95], v[152:155]
v_mfma_f32_16x16x32_bf16 v[152:155], a[216:219], a[108:111], v[152:155]
v_mfma_f32_16x16x32_bf16 v[152:155], a[220:223], a[124:127], v[152:155]
s_add_u32 s61, s61, s0
s_and_b32 s61, s61, 0x1ffff
s_add_u32 s60, s60, 28672
s_add_u32 m0, s61, 0
v_mfma_f32_16x16x32_bf16 v[220:223], a[220:223], a[120:123], v[220:223]
buffer_load_dwordx4 v1, s[32:35], s60 offen offset:0 sc1 lds
v_mfma_f32_16x16x32_bf16 v[220:223], a[216:219], a[104:107], v[220:223]
v_mfma_f32_16x16x32_bf16 v[220:223], a[212:215], a[88:91], v[220:223]
v_mfma_f32_16x16x32_bf16 v[220:223], a[208:211], a[72:75], v[220:223]
v_mfma_f32_16x16x32_bf16 v[216:219], a[208:211], a[68:71], v[216:219]
v_mfma_f32_16x16x32_bf16 v[216:219], a[212:215], a[84:87], v[216:219]
buffer_load_dwordx4 v1, s[32:35], s60 offen offset:1024 sc1 lds
v_mfma_f32_16x16x32_bf16 v[216:219], a[216:219], a[100:103], v[216:219]
v_mul_f32 v10, v10, v90
v_mul_f32 v11, v11, v91
v_mfma_f32_16x16x32_bf16 v[216:219], a[220:223], a[116:119], v[216:219]
v_exp_f32 v8, v8
v_mfma_f32_16x16x32_bf16 v[208:211], a[220:223], a[112:115], v[208:211]
v_exp_f32 v9, v9
v_mfma_f32_16x16x32_bf16 v[208:211], a[216:219], a[96:99], v[208:211]
v_exp_f32 v10, v10
v_mfma_f32_16x16x32_bf16 v[208:211], a[212:215], a[80:83], v[208:211]
buffer_load_dwordx4 v1, s[32:35], s60 offen offset:2048 sc1 lds
v_mfma_f32_16x16x32_bf16 v[208:211], a[208:211], a[64:67], v[208:211]
v_exp_f32 v11, v11
ds_read_b128 a[64:67], v2 offset:16384
ds_read_b128 a[68:71], v2 offset:17408
ds_read_b128 a[72:75], v2 offset:18432
ds_read_b128 a[76:79], v2 offset:19456
ds_read_b128 a[80:83], v2 offset:20480
ds_read_b128 a[84:87], v2 offset:21504
ds_read_b128 a[88:91], v2 offset:22528
ds_read_b128 a[92:95], v2 offset:23552
v_mul_f32 v88, v88, v248
v_mul_f32 v89, v89, v249
v_mul_f32 v90, v90, v250
v_mul_f32 v91, v91, v251
v_fma_f32 v8, v8, s98, s98
v_fma_f32 v9, v9, s98, s98
v_fma_f32 v10, v10, s98, s98
v_fma_f32 v11, v11, s98, s98
v_rcp_f32 v8, v8
v_rcp_f32 v9, v9
v_rcp_f32 v10, v10
v_rcp_f32 v11, v11
v_mul_f32 v88, v88, v8
v_mul_f32 v89, v89, v9
v_mul_f32 v90, v90, v10
v_mul_f32 v91, v91, v11
v_cvt_pk_bf16_f32 v56, v56, v57
v_cvt_pk_bf16_f32 v57, v58, v59
v_cvt_pk_bf16_f32 v58, v88, v89
v_cvt_pk_bf16_f32 v59, v90, v91
buffer_store_dwordx4 v[56:59], v1, s[36:39], s57 offen sc1
s_cmp_eq_u32 s38, 0
s_cbranch_scc1 Lnogu
buffer_load_dwordx4 v1, s[32:35], s60 offen offset:3072 sc1 lds
v_pk_mul_f32 v[6:7], v[60:61], v[60:61]
v_pk_mul_f32 v[8:9], v[62:63], v[62:63]
v_pk_mul_f32 v[10:11], v[84:85], v[84:85]
v_pk_mul_f32 v[12:13], v[86:87], v[86:87]
v_pk_fma_f32 v[6:7], v[6:7], s[96:97], s[96:97] op_sel:[0,0,1] op_sel_hi:[1,0,1]
v_pk_fma_f32 v[8:9], v[8:9], s[96:97], s[96:97] op_sel:[0,0,1] op_sel_hi:[1,0,1]
v_pk_fma_f32 v[10:11], v[10:11], s[96:97], s[96:97] op_sel:[0,0,1] op_sel_hi:[1,0,1]
v_pk_fma_f32 v[12:13], v[12:13], s[96:97], s[96:97] op_sel:[0,0,1] op_sel_hi:[1,0,1]
v_pk_mul_f32 v[6:7], v[6:7], v[60:61]
v_pk_mul_f32 v[8:9], v[8:9], v[62:63]
v_pk_mul_f32 v[10:11], v[10:11], v[84:85]
v_pk_mul_f32 v[12:13], v[12:13], v[86:87]
v_mfma_f32_32x32x16_bf16 v[128:143], a[128:131], a[128:131], 0
v_exp_f32 v6, v6
v_exp_f32 v7, v7
v_exp_f32 v8, v8
v_exp_f32 v9, v9
v_mfma_f32_32x32x16_bf16 v[160:175], a[128:131], a[128:131], 0
v_exp_f32 v10, v10
v_exp_f32 v11, v11
v_exp_f32 v12, v12
v_exp_f32 v13, v13
v_pk_mul_f32 v[60:61], v[60:61], v[120:121]
v_pk_mul_f32 v[62:63], v[62:63], v[122:123]
v_pk_mul_f32 v[84:85], v[84:85], v[36:37]
v_pk_mul_f32 v[86:87], v[86:87], v[38:39]
v_pk_fma_f32 v[6:7], v[6:7], s[98:99], s[98:99] op_sel_hi:[1,0,0]
v_pk_fma_f32 v[8:9], v[8:9], s[98:99], s[98:99] op_sel_hi:[1,0,0]
v_pk_fma_f32 v[10:11], v[10:11], s[98:99], s[98:99] op_sel_hi:[1,0,0]
v_pk_fma_f32 v[12:13], v[12:13], s[98:99], s[98:99] op_sel_hi:[1,0,0]
v_mfma_f32_32x32x16_bf16 v[192:207], a[128:131], a[128:131], 0
v_rcp_f32 v6, v6
v_rcp_f32 v7, v7
v_rcp_f32 v8, v8
v_rcp_f32 v9, v9
v_mfma_f32_32x32x16_bf16 v[224:239], a[128:131], a[128:131], 0
v_rcp_f32 v10, v10
v_rcp_f32 v11, v11
v_rcp_f32 v12, v12
v_rcp_f32 v13, v13
s_add_u32 s52, s56, 0
v_pk_mul_f32 v[60:61], v[60:61], v[6:7]
v_pk_mul_f32 v[62:63], v[62:63], v[8:9]
v_pk_mul_f32 v[84:85], v[84:85], v[10:11]
v_pk_mul_f32 v[86:87], v[86:87], v[12:13]
v_cvt_pk_bf16_f32 v60, v60, v61
v_cvt_pk_bf16_f32 v61, v62, v63
v_cvt_pk_bf16_f32 v62, v84, v85
v_cvt_pk_bf16_f32 v63, v86, v87
buffer_store_dwordx4 v[60:63], v1, s[36:39], s52 offen sc1
s_add_u32 s60, s60, 4096
s_add_u32 m0, s61, 4096
s_nop 0
buffer_load_dwordx4 v1, s[32:35], s60 offen offset:0 sc1 lds
v_pk_mul_f32 v[6:7], v[32:33], v[32:33]
v_pk_mul_f32 v[8:9], v[34:35], v[34:35]
v_pk_mul_f32 v[10:11], v[112:113], v[112:113]
v_pk_mul_f32 v[12:13], v[114:115], v[114:115]
v_pk_fma_f32 v[6:7], v[6:7], s[96:97], s[96:97] op_sel:[0,0,1] op_sel_hi:[1,0,1]
v_pk_fma_f32 v[8:9], v[8:9], s[96:97], s[96:97] op_sel:[0,0,1] op_sel_hi:[1,0,1]
v_pk_fma_f32 v[10:11], v[10:11], s[96:97], s[96:97] op_sel:[0,0,1] op_sel_hi:[1,0,1]
v_pk_fma_f32 v[12:13], v[12:13], s[96:97], s[96:97] op_sel:[0,0,1] op_sel_hi:[1,0,1]
v_pk_mul_f32 v[6:7], v[6:7], v[32:33]
v_pk_mul_f32 v[8:9], v[8:9], v[34:35]
v_pk_mul_f32 v[10:11], v[10:11], v[112:113]
v_pk_mul_f32 v[12:13], v[12:13], v[114:115]
v_exp_f32 v6, v6
v_exp_f32 v7, v7
v_exp_f32 v8, v8
v_exp_f32 v9, v9
v_exp_f32 v10, v10
v_exp_f32 v11, v11
v_exp_f32 v12, v12
v_exp_f32 v13, v13
v_pk_mul_f32 v[32:33], v[32:33], v[188:189]
v_pk_mul_f32 v[34:35], v[34:35], v[190:191]
v_pk_mul_f32 v[112:113], v[112:113], v[40:41]
v_pk_mul_f32 v[114:115], v[114:115], v[42:43]
v_pk_fma_f32 v[6:7], v[6:7], s[98:99], s[98:99] op_sel_hi:[1,0,0]
v_pk_fma_f32 v[8:9], v[8:9], s[98:99], s[98:99] op_sel_hi:[1,0,0]
v_pk_fma_f32 v[10:11], v[10:11], s[98:99], s[98:99] op_sel_hi:[1,0,0]
v_pk_fma_f32 v[12:13], v[12:13], s[98:99], s[98:99] op_sel_hi:[1,0,0]
v_rcp_f32 v6, v6
v_rcp_f32 v7, v7
v_rcp_f32 v8, v8
v_rcp_f32 v9, v9
v_rcp_f32 v10, v10
v_rcp_f32 v11, v11
v_rcp_f32 v12, v12
v_rcp_f32 v13, v13
s_add_u32 s52, s56, 4096
v_pk_mul_f32 v[32:33], v[32:33], v[6:7]
v_pk_mul_f32 v[34:35], v[34:35], v[8:9]
v_pk_mul_f32 v[112:113], v[112:113], v[10:11]
v_pk_mul_f32 v[114:115], v[114:115], v[12:13]
v_cvt_pk_bf16_f32 v32, v32, v33
v_cvt_pk_bf16_f32 v33, v34, v35
v_cvt_pk_bf16_f32 v34, v112, v113
v_cvt_pk_bf16_f32 v35, v114, v115
buffer_store_dwordx4 v[32:35], v1, s[36:39], s52 offen sc1
v_pk_mul_f32 v[6:7], v[240:241], v[240:241]
v_pk_mul_f32 v[8:9], v[242:243], v[242:243]
v_pk_mul_f32 v[10:11], v[148:149], v[148:149]
v_pk_mul_f32 v[12:13], v[150:151], v[150:151]
v_pk_fma_f32 v[6:7], v[6:7], s[96:97], s[96:97] op_sel:[0,0,1] op_sel_hi:[1,0,1]
buffer_load_dwordx4 v1, s[32:35], s60 offen offset:1024 sc1 lds
v_pk_fma_f32 v[8:9], v[8:9], s[96:97], s[96:97] op_sel:[0,0,1] op_sel_hi:[1,0,1]
v_pk_fma_f32 v[10:11], v[10:11], s[96:97], s[96:97] op_sel:[0,0,1] op_sel_hi:[1,0,1]
v_pk_fma_f32 v[12:13], v[12:13], s[96:97], s[96:97] op_sel:[0,0,1] op_sel_hi:[1,0,1]
v_pk_mul_f32 v[6:7], v[6:7], v[240:241]
v_pk_mul_f32 v[8:9], v[8:9], v[242:243]
v_pk_mul_f32 v[10:11], v[10:11], v[148:149]
v_pk_mul_f32 v[12:13], v[12:13], v[150:151]
v_exp_f32 v6, v6
v_exp_f32 v7, v7
v_exp_f32 v8, v8
v_exp_f32 v9, v9
v_exp_f32 v10, v10
v_exp_f32 v11, v11
v_exp_f32 v12, v12
v_exp_f32 v13, v13
v_pk_mul_f32 v[240:241], v[240:241], v[156:157]
v_pk_mul_f32 v[242:243], v[242:243], v[158:159]
v_pk_mul_f32 v[148:149], v[148:149], v[152:153]
v_pk_mul_f32 v[150:151], v[150:151], v[154:155]
v_pk_fma_f32 v[6:7], v[6:7], s[98:99], s[98:99] op_sel_hi:[1,0,0]
v_pk_fma_f32 v[8:9], v[8:9], s[98:99], s[98:99] op_sel_hi:[1,0,0]
v_pk_fma_f32 v[10:11], v[10:11], s[98:99], s[98:99] op_sel_hi:[1,0,0]
v_pk_fma_f32 v[12:13], v[12:13], s[98:99], s[98:99] op_sel_hi:[1,0,0]
v_rcp_f32 v6, v6
v_rcp_f32 v7, v7
v_rcp_f32 v8, v8
v_rcp_f32 v9, v9
v_rcp_f32 v10, v10
v_rcp_f32 v11, v11
v_rcp_f32 v12, v12
v_rcp_f32 v13, v13
s_add_u32 s52, s57, 12288
v_pk_mul_f32 v[240:241], v[240:241], v[6:7]
v_pk_mul_f32 v[242:243], v[242:243], v[8:9]
v_pk_mul_f32 v[148:149], v[148:149], v[10:11]
v_pk_mul_f32 v[150:151], v[150:151], v[12:13]
v_cvt_pk_bf16_f32 v240, v240, v241
v_cvt_pk_bf16_f32 v241, v242, v243
v_cvt_pk_bf16_f32 v242, v148, v149
v_cvt_pk_bf16_f32 v243, v150, v151
buffer_store_dwordx4 v[240:243], v1, s[36:39], s52 offen sc1
v_pk_mul_f32 v[6:7], v[244:245], v[244:245]
v_pk_mul_f32 v[8:9], v[246:247], v[246:247]
v_pk_mul_f32 v[10:11], v[68:69], v[68:69]
v_pk_mul_f32 v[12:13], v[70:71], v[70:71]
v_pk_fma_f32 v[6:7], v[6:7], s[96:97], s[96:97] op_sel:[0,0,1] op_sel_hi:[1,0,1]
v_pk_fma_f32 v[8:9], v[8:9], s[96:97], s[96:97] op_sel:[0,0,1] op_sel_hi:[1,0,1]
v_pk_fma_f32 v[10:11], v[10:11], s[96:97], s[96:97] op_sel:[0,0,1] op_sel_hi:[1,0,1]
v_pk_fma_f32 v[12:13], v[12:13], s[96:97], s[96:97] op_sel:[0,0,1] op_sel_hi:[1,0,1]
v_pk_mul_f32 v[6:7], v[6:7], v[244:245]
buffer_load_dwordx4 v1, s[32:35], s60 offen offset:2048 sc1 lds
v_pk_mul_f32 v[8:9], v[8:9], v[246:247]
v_pk_mul_f32 v[10:11], v[10:11], v[68:69]
v_pk_mul_f32 v[12:13], v[12:13], v[70:71]
v_mfma_f32_32x32x16_bf16 v[144:159], a[128:131], a[128:131], 0
v_exp_f32 v6, v6
v_exp_f32 v7, v7
v_exp_f32 v8, v8
v_exp_f32 v9, v9
v_exp_f32 v10, v10
v_exp_f32 v11, v11
v_exp_f32 v12, v12
v_exp_f32 v13, v13
v_pk_mul_f32 v[244:245], v[244:245], v[212:213]
v_pk_mul_f32 v[246:247], v[246:247], v[214:215]
v_pk_mul_f32 v[68:69], v[68:69], v[220:221]
v_pk_mul_f32 v[70:71], v[70:71], v[222:223]
v_pk_fma_f32 v[6:7], v[6:7], s[98:99], s[98:99] op_sel_hi:[1,0,0]
v_pk_fma_f32 v[8:9], v[8:9], s[98:99], s[98:99] op_sel_hi:[1,0,0]
v_pk_fma_f32 v[10:11], v[10:11], s[98:99], s[98:99] op_sel_hi:[1,0,0]
v_pk_fma_f32 v[12:13], v[12:13], s[98:99], s[98:99] op_sel_hi:[1,0,0]
v_rcp_f32 v6, v6
v_rcp_f32 v7, v7
v_rcp_f32 v8, v8
v_rcp_f32 v9, v9
v_rcp_f32 v10, v10
v_rcp_f32 v11, v11
v_rcp_f32 v12, v12
v_rcp_f32 v13, v13
s_add_u32 s52, s57, 8192
v_pk_mul_f32 v[244:245], v[244:245], v[6:7]
v_pk_mul_f32 v[246:247], v[246:247], v[8:9]
v_pk_mul_f32 v[68:69], v[68:69], v[10:11]
v_pk_mul_f32 v[70:71], v[70:71], v[12:13]
v_cvt_pk_bf16_f32 v244, v244, v245
v_cvt_pk_bf16_f32 v245, v246, v247
v_cvt_pk_bf16_f32 v246, v68, v69
v_cvt_pk_bf16_f32 v247, v70, v71
buffer_store_dwordx4 v[244:247], v1, s[36:39], s52 offen sc1
v_pk_mul_f32 v[6:7], v[176:177], v[176:177]
v_pk_mul_f32 v[8:9], v[178:179], v[178:179]
v_pk_mul_f32 v[10:11], v[64:65], v[64:65]
v_pk_mul_f32 v[12:13], v[66:67], v[66:67]
v_pk_fma_f32 v[6:7], v[6:7], s[96:97], s[96:97] op_sel:[0,0,1] op_sel_hi:[1,0,1]
v_pk_fma_f32 v[8:9], v[8:9], s[96:97], s[96:97] op_sel:[0,0,1] op_sel_hi:[1,0,1]
v_pk_fma_f32 v[10:11], v[10:11], s[96:97], s[96:97] op_sel:[0,0,1] op_sel_hi:[1,0,1]
v_pk_fma_f32 v[12:13], v[12:13], s[96:97], s[96:97] op_sel:[0,0,1] op_sel_hi:[1,0,1]
v_pk_mul_f32 v[6:7], v[6:7], v[176:177]
v_pk_mul_f32 v[8:9], v[8:9], v[178:179]
v_pk_mul_f32 v[10:11], v[10:11], v[64:65]
v_pk_mul_f32 v[12:13], v[12:13], v[66:67]
v_exp_f32 v6, v6
buffer_load_dwordx4 v1, s[32:35], s60 offen offset:3072 sc1 lds
v_exp_f32 v7, v7
v_exp_f32 v8, v8
v_exp_f32 v9, v9
v_exp_f32 v10, v10
v_exp_f32 v11, v11
v_exp_f32 v12, v12
v_exp_f32 v13, v13
v_pk_mul_f32 v[176:177], v[176:177], v[92:93]
v_pk_mul_f32 v[178:179], v[178:179], v[94:95]
v_pk_mul_f32 v[64:65], v[64:65], v[216:217]
v_pk_mul_f32 v[66:67], v[66:67], v[218:219]
v_pk_fma_f32 v[6:7], v[6:7], s[98:99], s[98:99] op_sel_hi:[1,0,0]
v_pk_fma_f32 v[8:9], v[8:9], s[98:99], s[98:99] op_sel_hi:[1,0,0]
v_pk_fma_f32 v[10:11], v[10:11], s[98:99], s[98:99] op_sel_hi:[1,0,0]
v_pk_fma_f32 v[12:13], v[12:13], s[98:99], s[98:99] op_sel_hi:[1,0,0]
v_rcp_f32 v6, v6
v_rcp_f32 v7, v7
v_rcp_f32 v8, v8
v_rcp_f32 v9, v9
v_rcp_f32 v10, v10
v_rcp_f32 v11, v11
v_rcp_f32 v12, v12
v_rcp_f32 v13, v13
s_add_u32 s52, s56, 12288
v_pk_mul_f32 v[176:177], v[176:177], v[6:7]
v_pk_mul_f32 v[178:179], v[178:179], v[8:9]
v_pk_mul_f32 v[64:65], v[64:65], v[10:11]
v_pk_mul_f32 v[66:67], v[66:67], v[12:13]
v_cvt_pk_bf16_f32 v176, v176, v177
v_cvt_pk_bf16_f32 v177, v178, v179
v_cvt_pk_bf16_f32 v178, v64, v65
v_cvt_pk_bf16_f32 v179, v66, v67
buffer_store_dwordx4 v[176:179], v1, s[36:39], s52 offen sc1
v_pk_mul_f32 v[6:7], v[180:181], v[180:181]
v_pk_mul_f32 v[8:9], v[182:183], v[182:183]
v_pk_mul_f32 v[10:11], v[124:125], v[124:125]
v_pk_mul_f32 v[12:13], v[126:127], v[126:127]
v_pk_fma_f32 v[6:7], v[6:7], s[96:97], s[96:97] op_sel:[0,0,1] op_sel_hi:[1,0,1]
v_pk_fma_f32 v[8:9], v[8:9], s[96:97], s[96:97] op_sel:[0,0,1] op_sel_hi:[1,0,1]
v_pk_fma_f32 v[10:11], v[10:11], s[96:97], s[96:97] op_sel:[0,0,1] op_sel_hi:[1,0,1]
v_pk_fma_f32 v[12:13], v[12:13], s[96:97], s[96:97] op_sel:[0,0,1] op_sel_hi:[1,0,1]
v_pk_mul_f32 v[6:7], v[6:7], v[180:181]
v_pk_mul_f32 v[8:9], v[8:9], v[182:183]
v_pk_mul_f32 v[10:11], v[10:11], v[124:125]
v_pk_mul_f32 v[12:13], v[12:13], v[126:127]
v_exp_f32 v6, v6
v_exp_f32 v7, v7
v_exp_f32 v8, v8
v_exp_f32 v9, v9
v_exp_f32 v10, v10
v_exp_f32 v11, v11
v_exp_f32 v12, v12
v_exp_f32 v13, v13
v_pk_mul_f32 v[180:181], v[180:181], v[96:97]
v_pk_mul_f32 v[182:183], v[182:183], v[98:99]
v_pk_mul_f32 v[124:125], v[124:125], v[208:209]
v_pk_mul_f32 v[126:127], v[126:127], v[210:211]
v_pk_fma_f32 v[6:7], v[6:7], s[98:99], s[98:99] op_sel_hi:[1,0,0]
v_pk_fma_f32 v[8:9], v[8:9], s[98:99], s[98:99] op_sel_hi:[1,0,0]
v_pk_fma_f32 v[10:11], v[10:11], s[98:99], s[98:99] op_sel_hi:[1,0,0]
v_pk_fma_f32 v[12:13], v[12:13], s[98:99], s[98:99] op_sel_hi:[1,0,0]
v_rcp_f32 v6, v6
v_rcp_f32 v7, v7
v_rcp_f32 v8, v8
v_rcp_f32 v9, v9
v_rcp_f32 v10, v10
v_rcp_f32 v11, v11
v_rcp_f32 v12, v12
v_rcp_f32 v13, v13
s_add_u32 s52, s56, 8192
v_pk_mul_f32 v[180:181], v[180:181], v[6:7]
v_pk_mul_f32 v[182:183], v[182:183], v[8:9]
v_pk_mul_f32 v[124:125], v[124:125], v[10:11]
v_pk_mul_f32 v[126:127], v[126:127], v[12:13]
v_cvt_pk_bf16_f32 v180, v180, v181
v_cvt_pk_bf16_f32 v181, v182, v183
v_cvt_pk_bf16_f32 v182, v124, v125
v_cvt_pk_bf16_f32 v183, v126, v127
buffer_store_dwordx4 v[180:183], v1, s[36:39], s52 offen sc1
Lgud:
s_nop 0
v_mov_b64 v[16:17], 0
v_mov_b64 v[18:19], 0
v_mov_b64 v[20:21], 0
v_mov_b64 v[22:23], 0
v_mov_b64 v[24:25], 0
v_mov_b64 v[26:27], 0
v_mov_b64 v[28:29], 0
v_mov_b64 v[30:31], 0
Lp3:
s_mov_b32 s27, 0
v_mfma_f32_32x32x16_bf16 v[112:127], a[128:131], a[128:131], 0
v_mov_b32 v32, v16
v_mov_b32 v33, v16
v_mov_b32 v34, v16
v_mov_b32 v35, v16
v_mov_b32 v36, v16
v_mfma_f32_32x32x16_bf16 v[176:191], a[128:131], a[128:131], 0
v_mov_b32 v37, v16
v_mov_b32 v38, v16
v_mov_b32 v39, v16
v_cndmask_b32 v40, v4, v16, s[80:81]
v_cndmask_b32 v41, v4, v16, s[82:83]
v_mfma_f32_32x32x16_bf16 v[208:223], a[128:131], a[128:131], 0
v_cndmask_b32 v42, v4, v16, s[84:85]
v_cndmask_b32 v43, v4, v16, s[86:87]
v_cndmask_b32 v44, v4, v16, s[88:89]
v_cndmask_b32 v45, v4, v16, s[90:91]
v_cndmask_b32 v46, v4, v16, s[92:93]
v_cndmask_b32 v47, v4, v16, s[94:95]
s_cmp_lg_u32 s3, 0
s_cbranch_scc1 Lz0
v_cndmask_b32 v32, v4, v16, s[64:65]
v_cndmask_b32 v33, v4, v16, s[66:67]
v_cndmask_b32 v34, v4, v16, s[68:69]
v_cndmask_b32 v35, v4, v16, s[70:71]
v_cndmask_b32 v36, v4, v16, s[72:73]
v_cndmask_b32 v37, v4, v16, s[74:75]
v_cndmask_b32 v38, v4, v16, s[76:77]
v_cndmask_b32 v39, v4, v16, s[78:79]
s_nop 0
Lz0:
s_waitcnt lgkmcnt(0)
v_mfma_f32_16x16x32_bf16 v[48:51], a[64:67], a[0:3], v[32:35]
s_add_u32 s61, s61, s0
s_and_b32 s61, s61, 0x1ffff
s_add_u32 s60, s60, 28672
s_add_u32 m0, s61, 0
v_mfma_f32_16x16x32_bf16 v[48:51], a[68:71], a[4:7], v[48:51]
buffer_load_dwordx4 v1, s[32:35], s60 offen offset:0 sc1 lds
v_mfma_f32_16x16x32_bf16 v[48:51], a[72:75], a[8:11], v[48:51]
s_mul_i32 s52, s7, 442368
s_add_u32 s36, s28, 0x2400000
s_addc_u32 s37, s29, 0
v_mfma_f32_16x16x32_bf16 v[48:51], a[76:79], a[12:15], v[48:51]
buffer_load_dwordx4 v1, s[32:35], s60 offen offset:1024 sc1 lds
v_mfma_f32_16x16x32_bf16 v[56:59], a[76:79], a[28:31], v[20:23]
s_add_u32 s36, s36, s52
s_addc_u32 s37, s37, 0
s_mov_b32 s38, 0x6c000
v_mfma_f32_16x16x32_bf16 v[56:59], a[72:75], a[24:27], v[56:59]
buffer_load_dwordx4 v1, s[32:35], s60 offen offset:2048 sc1 lds
v_mfma_f32_16x16x32_bf16 v[56:59], a[68:71], a[20:23], v[56:59]
s_mov_b32 s39, 0x20000
s_mov_b32 s44, s22
s_mov_b32 s45, s23
v_mfma_f32_16x16x32_bf16 v[56:59], a[64:67], a[16:19], v[56:59]
buffer_load_dwordx4 v1, s[32:35], s60 offen offset:3072 sc1 lds
v_mfma_f32_16x16x32_bf16 v[64:67], a[64:67], a[32:35], v[24:27]
s_mov_b32 s46, 0x21c000
v_exp_f32 v48, v48
v_mfma_f32_16x16x32_bf16 v[64:67], a[68:71], a[36:39], v[64:67]
s_mov_b32 s47, 0x20000
v_exp_f32 v49, v49
v_mfma_f32_16x16x32_bf16 v[64:67], a[72:75], a[40:43], v[64:67]
s_lshl_b32 s52, s6, 3
v_exp_f32 v50, v50
v_mfma_f32_16x16x32_bf16 v[64:67], a[76:79], a[44:47], v[64:67]
s_add_u32 s60, s60, 4096
v_exp_f32 v51, v51
v_mfma_f32_16x16x32_bf16 v[72:75], a[76:79], a[60:63], v[28:31]
s_add_u32 m0, s61, 4096
v_cvt_pk_bf16_f32 v48, v48, v49
v_cvt_pk_bf16_f32 v49, v50, v51
v_mfma_f32_16x16x32_bf16 v[72:75], a[72:75], a[56:59], v[72:75]
buffer_load_dwordx4 v1, s[32:35], s60 offen offset:0 sc1 lds
v_mfma_f32_16x16x32_bf16 v[72:75], a[68:71], a[52:55], v[72:75]
s_lshr_b32 s52, 0x58382000, s52
v_exp_f32 v56, v56
v_mfma_f32_16x16x32_bf16 v[72:75], a[64:67], a[48:51], v[72:75]
s_and_b32 s52, s52, 0xff
v_exp_f32 v57, v57
v_mfma_f32_16x16x32_bf16 v[76:79], a[80:83], a[48:51], v[28:31]
s_add_u32 s52, s52, s30
v_exp_f32 v58, v58
v_mfma_f32_16x16x32_bf16 v[76:79], a[84:87], a[52:55], v[76:79]
s_lshl_b32 s9, s52, 12
v_exp_f32 v59, v59
v_mfma_f32_16x16x32_bf16 v[76:79], a[88:91], a[56:59], v[76:79]
buffer_load_dwordx4 v1, s[32:35], s60 offen offset:1024 sc1 lds
v_mfma_f32_16x16x32_bf16 v[76:79], a[92:95], a[60:63], v[76:79]
s_lshr_b32 s53, s52, 1
v_cvt_pk_bf16_f32 v56, v56, v57
v_cvt_pk_bf16_f32 v57, v58, v59
v_mfma_f32_16x16x32_bf16 v[68:71], a[92:95], a[44:47], v[24:27]
s_lshl_b32 s53, s53, 3
v_exp_f32 v64, v64
v_mfma_f32_16x16x32_bf16 v[68:71], a[88:91], a[40:43], v[68:71]
ds_read_b128 a[64:67], v2 offset:24576
ds_read_b128 a[68:71], v2 offset:25600
v_mfma_f32_16x16x32_bf16 v[68:71], a[84:87], a[36:39], v[68:71]
s_and_b32 s52, s30, 1
v_exp_f32 v65, v65
v_mfma_f32_16x16x32_bf16 v[68:71], a[80:83], a[32:35], v[68:71]
buffer_load_dwordx4 v1, s[32:35], s60 offen offset:2048 sc1 lds
v_mfma_f32_16x16x32_bf16 v[60:63], a[80:83], a[16:19], v[20:23]
s_add_u32 s53, s53, s52
v_exp_f32 v66, v66
v_mfma_f32_16x16x32_bf16 v[60:63], a[84:87], a[20:23], v[60:63]
s_mul_i32 s53, s53, 5120
v_exp_f32 v67, v67
v_mfma_f32_16x16x32_bf16 v[60:63], a[88:91], a[24:27], v[60:63]
ds_read_b128 a[72:75], v2 offset:26624
ds_read_b128 a[76:79], v2 offset:27648
v_mfma_f32_16x16x32_bf16 v[60:63], a[92:95], a[28:31], v[60:63]
s_mul_i32 s52, s8, 320
v_cvt_pk_bf16_f32 v64, v64, v65
v_cvt_pk_bf16_f32 v65, v66, v67
v_mfma_f32_16x16x32_bf16 v[52:55], a[92:95], a[12:15], v[36:39]
buffer_load_dwordx4 v1, s[32:35], s60 offen offset:3072 sc1 lds
v_mfma_f32_16x16x32_bf16 v[52:55], a[88:91], a[8:11], v[52:55]
s_add_u32 s52, s52, 64
v_exp_f32 v72, v72
v_mfma_f32_16x16x32_bf16 v[52:55], a[84:87], a[4:7], v[52:55]
s_and_b32 s52, s52, 0x780
v_exp_f32 v73, v73
v_mfma_f32_16x16x32_bf16 v[52:55], a[80:83], a[0:3], v[52:55]
s_add_u32 s10, s53, s52
v_exp_f32 v74, v74
ds_read_b128 a[80:83], v2 offset:28672
ds_read_b128 a[84:87], v2 offset:29696
ds_read_b128 a[88:91], v2 offset:30720
ds_read_b128 a[92:95], v2 offset:31744
s_add_u32 s61, s61, s0
s_and_b32 s61, s61, 0x1ffff
s_add_u32 s60, s60, 28672
s_mov_b32 m0, s61
s_mov_b32 s62, 0
s_mul_i32 s11, s30, 5152
s_add_u32 s11, s11, 126816
s_add_u32 s55, s17, s30
s_mov_b32 s53, 0x500000
s_cmp_lt_u32 s55, 640
s_cselect_b32 s96, s14, s22
s_cselect_b32 s97, s15, s23
s_cselect_b32 s98, s53, 0x21c000
s_cselect_b32 s53, 0, 640
s_sub_u32 s55, s55, s53
s_lshl_b32 s55, s55, 13
s_lshr_b32 s52, s30, 1
s_lshl_b32 s52, s52, 12
s_add_u32 s52, s52, 147424
s_and_b32 s54, s30, 1
s_lshl_b32 s53, s54, 9
s_add_u32 s53, s53, 126816
s_mul_i32 s54, s54, 480
s_sub_u32 s54, 4096, s54
v_exp_f32 v75, v75
s_nop 0
v_cvt_pk_bf16_f32 v72, v72, v73
v_cvt_pk_bf16_f32 v73, v74, v75
v_or_b32 v2, s62, v1
v_lshl_add_u32 v3, v0, 7, s55
v_bfe_i32 v14, v0, 0, 1
v_bfe_i32 v9, v0, 1, 1
v_and_b32 v14, 0xaaaaaaaa, v14
v_and_b32 v9, 0x3f803f80, v9
v_or_b32 v14, 0x44444444, v14
v_xor_b32 v9, 0x3f803f80, v9
v_accvgpr_write_b32 a212, v9
v_accvgpr_write_b32 a213, v9
v_accvgpr_write_b32 a214, v9
v_accvgpr_write_b32 a215, v9
s_lshl_b32 s63, s3, 1
s_sub_u32 s16, s3, 1
s_and_b32 s16, s16, 6
s_waitcnt vmcnt(25) lgkmcnt(0)
s_barrier
s_cmp_eq_u32 s3, 0
s_cbranch_scc1 Lt43
.p2align 6
Lt44:
v_mfma_f32_16x16x32_bf16 v[80:83], a[64:67], a[0:3], v[16:19]
ds_read_b128 a[148:151], v2 offset:16384
v_mfma_f32_16x16x32_bf16 v[80:83], a[68:71], a[4:7], v[80:83]
ds_read_b128 a[152:155], v2 offset:17408
v_mfma_f32_16x16x32_bf16 v[80:83], a[72:75], a[8:11], v[80:83]
buffer_load_dwordx4 v1, s[32:35], s60 offen offset:0 sc1 lds
v_mfma_f32_16x16x32_bf16 v[80:83], a[76:79], a[12:15], v[80:83]
ds_read_b128 a[156:159], v2 offset:18432
v_mfma_f32_16x16x32_bf16 v[88:91], a[76:79], a[28:31], v[20:23]
ds_read_b128 a[160:163], v2 offset:19456
v_mfma_f32_16x16x32_bf16 v[88:91], a[72:75], a[24:27], v[88:91]
ds_read_b128 a[164:167], v2 offset:20480
v_mfma_f32_16x16x32_bf16 v[88:91], a[68:71], a[20:23], v[88:91]
buffer_load_dwordx4 v1, s[32:35], s60 offen offset:1024 sc1 lds
v_mfma_f32_16x16x32_bf16 v[88:91], a[64:67], a[16:19], v[88:91]
ds_read_b128 a[168:171], v2 offset:21504
v_mfma_f32_16x16x32_bf16 v[92:95], a[80:83], a[16:19], v[20:23]
ds_read_b128 a[172:175], v2 offset:22528
v_mfma_f32_16x16x32_bf16 v[92:95], a[84:87], a[20:23], v[92:95]
ds_read_b128 a[176:179], v2 offset:23552
v_mfma_f32_16x16x32_bf16 v[92:95], a[88:91], a[24:27], v[92:95]
v_exp_f32 v52, v52
v_mfma_f32_16x16x32_bf16 v[92:95], a[92:95], a[28:31], v[92:95]
v_exp_f32 v53, v53
v_mfma_f32_16x16x32_bf16 v[84:87], a[92:95], a[12:15], v[16:19]
v_exp_f32 v54, v54
v_mfma_f32_16x16x32_bf16 v[84:87], a[88:91], a[8:11], v[84:87]
v_exp_f32 v55, v55
v_mfma_f32_16x16x32_bf16 v[84:87], a[84:87], a[4:7], v[84:87]
ds_read_b128 a[96:99], v2 offset:0
ds_read_b128 a[180:183], v2 offset:8192
v_mfma_f32_16x16x32_bf16 v[84:87], a[80:83], a[0:3], v[84:87]
v_cvt_pk_bf16_f32 v50, v52, v53
v_cvt_pk_bf16_f32 v51, v54, v55
v_mfma_f32_16x16x32_bf16 v[96:99], a[64:67], a[32:35], v[24:27]
v_exp_f32 v60, v60
v_mfma_f32_16x16x32_bf16 v[96:99], a[68:71], a[36:39], v[96:99]
v_exp_f32 v61, v61
v_mfma_f32_16x16x32_bf16 v[96:99], a[72:75], a[40:43], v[96:99]
v_exp_f32 v62, v62
v_mfma_f32_16x16x32_bf16 v[96:99], a[76:79], a[44:47], v[96:99]
v_exp_f32 v63, v63
v_mfma_f32_16x16x32_bf16 v[104:107], a[76:79], a[60:63], v[28:31]
buffer_load_dwordx4 v1, s[32:35], s60 offen offset:2048 sc1 lds
v_mfma_f32_16x16x32_bf16 v[104:107], a[72:75], a[56:59], v[104:107]
v_cvt_pk_bf16_f32 v58, v60, v61
v_cvt_pk_bf16_f32 v59, v62, v63
v_mfma_f32_16x16x32_bf16 v[104:107], a[68:71], a[52:55], v[104:107]
v_exp_f32 v80, v80
v_mfma_f32_16x16x32_bf16 v[104:107], a[64:67], a[48:51], v[104:107]
v_exp_f32 v81, v81
v_mfma_f32_16x16x32_bf16 v[108:111], a[80:83], a[48:51], v[28:31]
v_exp_f32 v82, v82
v_mfma_f32_16x16x32_bf16 v[108:111], a[84:87], a[52:55], v[108:111]
ds_read_b128 a[100:103], v2 offset:1024
ds_read_b128 a[184:187], v2 offset:9216
v_mfma_f32_16x16x32_bf16 v[108:111], a[88:91], a[56:59], v[108:111]
v_exp_f32 v83, v83
v_mfma_f32_16x16x32_bf16 v[108:111], a[92:95], a[60:63], v[108:111]
v_cvt_pk_bf16_f32 v52, v80, v81
v_cvt_pk_bf16_f32 v53, v82, v83
v_mfma_f32_16x16x32_bf16 v[100:103], a[92:95], a[44:47], v[24:27]
v_exp_f32 v88, v88
v_mfma_f32_16x16x32_bf16 v[100:103], a[88:91], a[40:43], v[100:103]
v_exp_f32 v89, v89
v_mfma_f32_16x16x32_bf16 v[100:103], a[84:87], a[36:39], v[100:103]
s_waitcnt lgkmcnt(2)
v_exp_f32 v90, v90
v_mfma_f32_16x16x32_bf16 v[100:103], a[80:83], a[32:35], v[100:103]
ds_read_b128 a[104:107], v2 offset:2048
ds_read_b128 a[188:191], v2 offset:10240
v_mfma_f32_16x16x32_bf16 v[240:243], a[148:151], a[32:35], v[24:27]
v_exp_f32 v91, v91
v_mfma_f32_16x16x32_bf16 v[240:243], a[152:155], a[36:39], v[240:243]
v_cvt_pk_bf16_f32 v60, v88, v89
v_cvt_pk_bf16_f32 v61, v90, v91
v_mfma_f32_16x16x32_bf16 v[240:243], a[156:159], a[40:43], v[240:243]
v_exp_f32 v84, v84
v_mfma_f32_16x16x32_bf16 v[240:243], a[160:163], a[44:47], v[240:243]
v_exp_f32 v85, v85
v_mfma_f32_16x16x32_bf16 v[248:251], a[160:163], a[60:63], v[28:31]
buffer_load_dwordx4 v1, s[32:35], s60 offen offset:3072 sc1 lds
v_mfma_f32_16x16x32_bf16 v[248:251], a[156:159], a[56:59], v[248:251]
s_add_u32 s60, s60, 4096
v_exp_f32 v86, v86
v_mfma_f32_16x16x32_bf16 v[248:251], a[152:155], a[52:55], v[248:251]
s_add_u32 m0, s61, 4096
v_exp_f32 v87, v87
v_mfma_f32_16x16x32_bf16 v[248:251], a[148:151], a[48:51], v[248:251]
v_cvt_pk_bf16_f32 v54, v84, v85
v_cvt_pk_bf16_f32 v55, v86, v87
v_mfma_f32_16x16x32_bf16 v[252:255], a[164:167], a[48:51], v[28:31]
v_exp_f32 v92, v92
v_mfma_f32_16x16x32_bf16 v[252:255], a[168:171], a[52:55], v[252:255]
ds_read_b128 a[108:111], v2 offset:3072
ds_read_b128 a[192:195], v2 offset:11264
v_mfma_f32_16x16x32_bf16 v[252:255], a[172:175], a[56:59], v[252:255]
v_exp_f32 v93, v93
v_mfma_f32_16x16x32_bf16 v[252:255], a[176:179], a[60:63], v[252:255]
v_exp_f32 v94, v94
v_mfma_f32_16x16x32_bf16 v[244:247], a[176:179], a[44:47], v[24:27]
v_exp_f32 v95, v95
v_mfma_f32_16x16x32_bf16 v[244:247], a[172:175], a[40:43], v[244:247]
v_cvt_pk_bf16_f32 v62, v92, v93
v_cvt_pk_bf16_f32 v63, v94, v95
v_mfma_f32_16x16x32_bf16 v[244:247], a[168:171], a[36:39], v[244:247]
v_mfma_f32_16x16x32_bf16 v[244:247], a[164:167], a[32:35], v[244:247]
v_mfma_f32_16x16x32_bf16 v[112:115], a[96:99], v[48:51], v[112:115]
v_exp_f32 v68, v68
v_mfma_f32_16x16x32_bf16 v[112:115], a[180:183], v[52:55], v[112:115]
ds_read_b128 a[112:115], v2 offset:4096
v_mfma_f32_16x16x32_bf16 v[144:147], a[180:183], v[60:63], v[144:147]
v_exp_f32 v69, v69
v_mfma_f32_16x16x32_bf16 v[144:147], a[96:99], v[56:59], v[144:147]
s_waitcnt lgkmcnt(1)
ds_read_b128 a[196:199], v2 offset:12288
v_mfma_f32_16x16x32_bf16 v[148:151], a[100:103], v[56:59], v[148:151]
v_exp_f32 v70, v70
v_mfma_f32_16x16x32_bf16 v[148:151], a[184:187], v[60:63], v[148:151]
v_exp_f32 v71, v71
v_mfma_f32_16x16x32_bf16 v[116:119], a[184:187], v[52:55], v[116:119]
ds_read_b128 a[116:119], v2 offset:5120
v_mfma_f32_16x16x32_bf16 v[116:119], a[100:103], v[48:51], v[116:119]
v_cvt_pk_bf16_f32 v66, v68, v69
v_cvt_pk_bf16_f32 v67, v70, v71
v_mfma_f32_16x16x32_bf16 v[120:123], a[104:107], v[48:51], v[120:123]
ds_read_b128 a[200:203], v2 offset:13312
v_mfma_f32_16x16x32_bf16 v[120:123], a[188:191], v[52:55], v[120:123]
v_exp_f32 v76, v76
v_mfma_f32_16x16x32_bf16 v[152:155], a[188:191], v[60:63], v[152:155]
v_exp_f32 v77, v77
v_mfma_f32_16x16x32_bf16 v[152:155], a[104:107], v[56:59], v[152:155]
buffer_load_dwordx4 v1, s[32:35], s60 offen offset:0 sc1 lds
v_mfma_f32_16x16x32_bf16 v[156:159], a[108:111], v[56:59], v[156:159]
v_exp_f32 v78, v78
v_mfma_f32_16x16x32_bf16 v[156:159], a[192:195], v[60:63], v[156:159]
ds_read_b128 a[120:123], v2 offset:6144
v_mfma_f32_16x16x32_bf16 v[124:127], a[192:195], v[52:55], v[124:127]
v_exp_f32 v79, v79
v_mfma_f32_16x16x32_bf16 v[124:127], a[108:111], v[48:51], v[124:127]
s_waitcnt lgkmcnt(1)
ds_read_b128 a[204:207], v2 offset:14336
v_mfma_f32_16x16x32_bf16 v[128:131], a[112:115], v[48:51], v[128:131]
v_cvt_pk_bf16_f32 v74, v76, v77
v_cvt_pk_bf16_f32 v75, v78, v79
v_mfma_f32_16x16x32_bf16 v[128:131], a[196:199], v[52:55], v[128:131]
v_exp_f32 v96, v96
v_mfma_f32_16x16x32_bf16 v[160:163], a[196:199], v[60:63], v[160:163]
ds_read_b128 a[124:127], v2 offset:7168
v_mfma_f32_16x16x32_bf16 v[160:163], a[112:115], v[56:59], v[160:163]
v_exp_f32 v97, v97
v_mfma_f32_16x16x32_bf16 v[164:167], a[116:119], v[56:59], v[164:167]
ds_read_b128 a[208:211], v2 offset:15360
v_smfmac_f32_16x16x64_bf16 a[132:135], a[212:215], v[56:63], v14
v_mfma_f32_16x16x32_bf16 v[164:167], a[200:203], v[60:63], v[164:167]
v_exp_f32 v98, v98
v_mfma_f32_16x16x32_bf16 v[132:135], a[200:203], v[52:55], v[132:135]
s_waitcnt lgkmcnt(2)
v_exp_f32 v99, v99
v_mfma_f32_16x16x32_bf16 v[132:135], a[116:119], v[48:51], v[132:135]
buffer_load_dwordx4 v1, s[32:35], s60 offen offset:1024 sc1 lds
v_mfma_f32_16x16x32_bf16 v[136:139], a[120:123], v[48:51], v[136:139]
s_add_u32 s62, s62, s0
v_cvt_pk_bf16_f32 v68, v96, v97
v_cvt_pk_bf16_f32 v69, v98, v99
v_mfma_f32_16x16x32_bf16 v[136:139], a[204:207], v[52:55], v[136:139]
s_and_b32 s62, s62, 0x18000
v_exp_f32 v104, v104
v_mfma_f32_16x16x32_bf16 v[168:171], a[204:207], v[60:63], v[168:171]
ds_read_b128 a[64:67], v2 offset:24576
v_mfma_f32_16x16x32_bf16 v[168:171], a[120:123], v[56:59], v[168:171]
v_exp_f32 v105, v105
v_smfmac_f32_16x16x64_bf16 a[128:131], a[212:215], v[48:55], v14
s_waitcnt lgkmcnt(1)
v_mfma_f32_16x16x32_bf16 v[172:175], a[124:127], v[56:59], v[172:175]
v_exp_f32 v106, v106
v_mfma_f32_16x16x32_bf16 v[172:175], a[208:211], v[60:63], v[172:175]
ds_read_b128 a[68:71], v2 offset:25600
v_mfma_f32_16x16x32_bf16 v[140:143], a[208:211], v[52:55], v[140:143]
v_exp_f32 v107, v107
v_mfma_f32_16x16x32_bf16 v[140:143], a[124:127], v[48:51], v[140:143]
v_cvt_pk_bf16_f32 v76, v104, v105
v_cvt_pk_bf16_f32 v77, v106, v107
v_mfma_f32_16x16x32_bf16 v[48:51], a[148:151], a[0:3], v[32:35]
ds_read_b128 a[72:75], v2 offset:26624
v_mfma_f32_16x16x32_bf16 v[48:51], a[152:155], a[4:7], v[48:51]
v_exp_f32 v100, v100
v_mfma_f32_16x16x32_bf16 v[48:51], a[156:159], a[8:11], v[48:51]
v_exp_f32 v101, v101
v_mfma_f32_16x16x32_bf16 v[48:51], a[160:163], a[12:15], v[48:51]
ds_read_b128 a[76:79], v2 offset:27648
v_mfma_f32_16x16x32_bf16 v[56:59], a[160:163], a[28:31], v[20:23]
v_exp_f32 v102, v102
v_mfma_f32_16x16x32_bf16 v[56:59], a[156:159], a[24:27], v[56:59]
buffer_load_dwordx4 v1, s[32:35], s60 offen offset:2048 sc1 lds
v_mfma_f32_16x16x32_bf16 v[56:59], a[152:155], a[20:23], v[56:59]
v_exp_f32 v103, v103
v_mfma_f32_16x16x32_bf16 v[56:59], a[148:151], a[16:19], v[56:59]
v_cvt_pk_bf16_f32 v70, v100, v101
v_cvt_pk_bf16_f32 v71, v102, v103
v_mfma_f32_16x16x32_bf16 v[60:63], a[164:167], a[16:19], v[20:23]
ds_read_b128 a[80:83], v2 offset:28672
v_mfma_f32_16x16x32_bf16 v[60:63], a[168:171], a[20:23], v[60:63]
v_exp_f32 v108, v108
v_mfma_f32_16x16x32_bf16 v[60:63], a[172:175], a[24:27], v[60:63]
v_exp_f32 v109, v109
v_mfma_f32_16x16x32_bf16 v[60:63], a[176:179], a[28:31], v[60:63]
ds_read_b128 a[84:87], v2 offset:29696
v_mfma_f32_16x16x32_bf16 v[52:55], a[176:179], a[12:15], v[36:39]
v_exp_f32 v110, v110
v_mfma_f32_16x16x32_bf16 v[52:55], a[172:175], a[8:11], v[52:55]
v_exp_f32 v111, v111
v_mfma_f32_16x16x32_bf16 v[52:55], a[168:171], a[4:7], v[52:55]
ds_read_b128 a[88:91], v2 offset:30720
v_mfma_f32_16x16x32_bf16 v[52:55], a[164:167], a[0:3], v[52:55]
v_cvt_pk_bf16_f32 v78, v108, v109
v_cvt_pk_bf16_f32 v79, v110, v111
v_mfma_f32_16x16x32_bf16 v[176:179], a[96:99], v[64:67], v[176:179]
v_exp_f32 v240, v240
v_mfma_f32_16x16x32_bf16 v[176:179], a[180:183], v[68:71], v[176:179]
ds_read_b128 a[92:95], v2 offset:31744
v_mfma_f32_16x16x32_bf16 v[208:211], a[180:183], v[76:79], v[208:211]
v_exp_f32 v241, v241
v_mfma_f32_16x16x32_bf16 v[208:211], a[96:99], v[72:75], v[208:211]
v_mfma_f32_16x16x32_bf16 v[212:215], a[100:103], v[72:75], v[212:215]
v_exp_f32 v242, v242
v_mfma_f32_16x16x32_bf16 v[212:215], a[184:187], v[76:79], v[212:215]
v_exp_f32 v243, v243
v_mfma_f32_16x16x32_bf16 v[180:183], a[184:187], v[68:71], v[180:183]
v_cvt_pk_bf16_f32 v240, v240, v241
v_cvt_pk_bf16_f32 v241, v242, v243
v_mfma_f32_16x16x32_bf16 v[180:183], a[100:103], v[64:67], v[180:183]
buffer_load_dwordx4 v1, s[32:35], s60 offen offset:3072 sc1 lds
v_mfma_f32_16x16x32_bf16 v[184:187], a[104:107], v[64:67], v[184:187]
s_add_u32 s60, s60, 28672
v_exp_f32 v248, v248
v_mfma_f32_16x16x32_bf16 v[184:187], a[188:191], v[68:71], v[184:187]
s_add_u32 s61, s61, s0
v_exp_f32 v249, v249
v_mfma_f32_16x16x32_bf16 v[216:219], a[188:191], v[76:79], v[216:219]
s_and_b32 s61, s61, 0x1ffff
v_exp_f32 v250, v250
v_mfma_f32_16x16x32_bf16 v[216:219], a[104:107], v[72:75], v[216:219]
s_mov_b32 m0, s61
v_mfma_f32_16x16x32_bf16 v[220:223], a[108:111], v[72:75], v[220:223]
v_exp_f32 v251, v251
v_mfma_f32_16x16x32_bf16 v[220:223], a[192:195], v[76:79], v[220:223]
v_cvt_pk_bf16_f32 v248, v248, v249
v_cvt_pk_bf16_f32 v249, v250, v251
v_mfma_f32_16x16x32_bf16 v[188:191], a[192:195], v[68:71], v[188:191]
v_exp_f32 v48, v48
v_mfma_f32_16x16x32_bf16 v[188:191], a[108:111], v[64:67], v[188:191]
v_mfma_f32_16x16x32_bf16 v[192:195], a[112:115], v[64:67], v[192:195]
v_exp_f32 v49, v49
v_mfma_f32_16x16x32_bf16 v[192:195], a[196:199], v[68:71], v[192:195]
v_exp_f32 v50, v50
v_mfma_f32_16x16x32_bf16 v[224:227], a[196:199], v[76:79], v[224:227]
v_exp_f32 v51, v51
v_mfma_f32_16x16x32_bf16 v[224:227], a[112:115], v[72:75], v[224:227]
v_cvt_pk_bf16_f32 v48, v48, v49
v_cvt_pk_bf16_f32 v49, v50, v51
v_mfma_f32_16x16x32_bf16 v[228:231], a[116:119], v[72:75], v[228:231]
v_exp_f32 v56, v56
v_smfmac_f32_16x16x64_bf16 a[140:143], a[212:215], v[72:79], v14
v_mfma_f32_16x16x32_bf16 v[228:231], a[200:203], v[76:79], v[228:231]
v_exp_f32 v57, v57
v_mfma_f32_16x16x32_bf16 v[196:199], a[200:203], v[68:71], v[196:199]
v_exp_f32 v58, v58
v_mfma_f32_16x16x32_bf16 v[196:199], a[116:119], v[64:67], v[196:199]
v_mfma_f32_16x16x32_bf16 v[200:203], a[120:123], v[64:67], v[200:203]
v_exp_f32 v59, v59
v_mfma_f32_16x16x32_bf16 v[200:203], a[204:207], v[68:71], v[200:203]
v_cvt_pk_bf16_f32 v56, v56, v57
v_cvt_pk_bf16_f32 v57, v58, v59
v_mfma_f32_16x16x32_bf16 v[232:235], a[204:207], v[76:79], v[232:235]
v_mfma_f32_16x16x32_bf16 v[232:235], a[120:123], v[72:75], v[232:235]
v_or_b32 v2, s62, v1
v_smfmac_f32_16x16x64_bf16 a[136:139], a[212:215], v[64:71], v14
v_mfma_f32_16x16x32_bf16 v[236:239], a[124:127], v[72:75], v[236:239]
v_mfma_f32_16x16x32_bf16 v[236:239], a[208:211], v[76:79], v[236:239]
v_mfma_f32_16x16x32_bf16 v[204:207], a[208:211], v[68:71], v[204:207]
v_mfma_f32_16x16x32_bf16 v[204:207], a[124:127], v[64:67], v[204:207]
s_waitcnt vmcnt(16) lgkmcnt(0)
s_barrier
v_mfma_f32_16x16x32_bf16 v[80:83], a[64:67], a[0:3], v[16:19]
ds_read_b128 a[148:151], v2 offset:16384
v_mfma_f32_16x16x32_bf16 v[80:83], a[68:71], a[4:7], v[80:83]
ds_read_b128 a[152:155], v2 offset:17408
v_mfma_f32_16x16x32_bf16 v[80:83], a[72:75], a[8:11], v[80:83]
buffer_load_dwordx4 v1, s[32:35], s60 offen offset:0 sc1 lds
v_mfma_f32_16x16x32_bf16 v[80:83], a[76:79], a[12:15], v[80:83]
ds_read_b128 a[156:159], v2 offset:18432
v_mfma_f32_16x16x32_bf16 v[88:91], a[76:79], a[28:31], v[20:23]
ds_read_b128 a[160:163], v2 offset:19456
v_mfma_f32_16x16x32_bf16 v[88:91], a[72:75], a[24:27], v[88:91]
ds_read_b128 a[164:167], v2 offset:20480
v_mfma_f32_16x16x32_bf16 v[88:91], a[68:71], a[20:23], v[88:91]
buffer_load_dwordx4 v1, s[32:35], s60 offen offset:1024 sc1 lds
v_mfma_f32_16x16x32_bf16 v[88:91], a[64:67], a[16:19], v[88:91]
ds_read_b128 a[168:171], v2 offset:21504
v_mfma_f32_16x16x32_bf16 v[92:95], a[80:83], a[16:19], v[20:23]
ds_read_b128 a[172:175], v2 offset:22528
v_mfma_f32_16x16x32_bf16 v[92:95], a[84:87], a[20:23], v[92:95]
ds_read_b128 a[176:179], v2 offset:23552
v_mfma_f32_16x16x32_bf16 v[92:95], a[88:91], a[24:27], v[92:95]
v_exp_f32 v52, v52
v_mfma_f32_16x16x32_bf16 v[92:95], a[92:95], a[28:31], v[92:95]
v_exp_f32 v53, v53
v_mfma_f32_16x16x32_bf16 v[84:87], a[92:95], a[12:15], v[16:19]
s_sub_u32 s63, s63, 2
v_exp_f32 v54, v54
v_mfma_f32_16x16x32_bf16 v[84:87], a[88:91], a[8:11], v[84:87]
s_cmp_eq_u32 s63, s16
v_exp_f32 v55, v55
v_mfma_f32_16x16x32_bf16 v[84:87], a[84:87], a[4:7], v[84:87]
ds_read_b128 a[96:99], v2 offset:0
ds_read_b128 a[180:183], v2 offset:8192
v_mfma_f32_16x16x32_bf16 v[84:87], a[80:83], a[0:3], v[84:87]
s_cbranch_scc1 Lt44_m
Lt44_r:
v_cvt_pk_bf16_f32 v50, v52, v53
v_cvt_pk_bf16_f32 v51, v54, v55
v_mfma_f32_16x16x32_bf16 v[96:99], a[64:67], a[32:35], v[24:27]
v_exp_f32 v60, v60
v_mfma_f32_16x16x32_bf16 v[96:99], a[68:71], a[36:39], v[96:99]
v_exp_f32 v61, v61
v_mfma_f32_16x16x32_bf16 v[96:99], a[72:75], a[40:43], v[96:99]
v_exp_f32 v62, v62
v_mfma_f32_16x16x32_bf16 v[96:99], a[76:79], a[44:47], v[96:99]
v_exp_f32 v63, v63
v_mfma_f32_16x16x32_bf16 v[104:107], a[76:79], a[60:63], v[28:31]
buffer_load_dwordx4 v1, s[32:35], s60 offen offset:2048 sc1 lds
v_mfma_f32_16x16x32_bf16 v[104:107], a[72:75], a[56:59], v[104:107]
v_cvt_pk_bf16_f32 v58, v60, v61
v_cvt_pk_bf16_f32 v59, v62, v63
v_mfma_f32_16x16x32_bf16 v[104:107], a[68:71], a[52:55], v[104:107]
v_exp_f32 v80, v80
v_mfma_f32_16x16x32_bf16 v[104:107], a[64:67], a[48:51], v[104:107]
v_exp_f32 v81, v81
v_mfma_f32_16x16x32_bf16 v[108:111], a[80:83], a[48:51], v[28:31]
v_exp_f32 v82, v82
v_mfma_f32_16x16x32_bf16 v[108:111], a[84:87], a[52:55], v[108:111]
ds_read_b128 a[100:103], v2 offset:1024
ds_read_b128 a[184:187], v2 offset:9216
v_mfma_f32_16x16x32_bf16 v[108:111], a[88:91], a[56:59], v[108:111]
v_exp_f32 v83, v83
v_mfma_f32_16x16x32_bf16 v[108:111], a[92:95], a[60:63], v[108:111]
v_cvt_pk_bf16_f32 v52, v80, v81
v_cvt_pk_bf16_f32 v53, v82, v83
v_mfma_f32_16x16x32_bf16 v[100:103], a[92:95], a[44:47], v[24:27]
v_exp_f32 v88, v88
v_mfma_f32_16x16x32_bf16 v[100:103], a[88:91], a[40:43], v[100:103]
v_exp_f32 v89, v89
v_mfma_f32_16x16x32_bf16 v[100:103], a[84:87], a[36:39], v[100:103]
s_waitcnt lgkmcnt(2)
v_exp_f32 v90, v90
v_mfma_f32_16x16x32_bf16 v[100:103], a[80:83], a[32:35], v[100:103]
ds_read_b128 a[104:107], v2 offset:2048
ds_read_b128 a[188:191], v2 offset:10240
v_mfma_f32_16x16x32_bf16 v[64:67], a[148:151], a[32:35], v[24:27]
v_exp_f32 v91, v91
v_mfma_f32_16x16x32_bf16 v[64:67], a[152:155], a[36:39], v[64:67]
v_cvt_pk_bf16_f32 v60, v88, v89
v_cvt_pk_bf16_f32 v61, v90, v91
v_mfma_f32_16x16x32_bf16 v[64:67], a[156:159], a[40:43], v[64:67]
v_exp_f32 v84, v84
v_mfma_f32_16x16x32_bf16 v[64:67], a[160:163], a[44:47], v[64:67]
v_exp_f32 v85, v85
v_mfma_f32_16x16x32_bf16 v[72:75], a[160:163], a[60:63], v[28:31]
buffer_load_dwordx4 v1, s[32:35], s60 offen offset:3072 sc1 lds
v_mfma_f32_16x16x32_bf16 v[72:75], a[156:159], a[56:59], v[72:75]
s_add_u32 s60, s60, 4096
v_exp_f32 v86, v86
v_mfma_f32_16x16x32_bf16 v[72:75], a[152:155], a[52:55], v[72:75]
s_add_u32 m0, s61, 4096
v_exp_f32 v87, v87
v_mfma_f32_16x16x32_bf16 v[72:75], a[148:151], a[48:51], v[72:75]
v_cvt_pk_bf16_f32 v54, v84, v85
v_cvt_pk_bf16_f32 v55, v86, v87
v_mfma_f32_16x16x32_bf16 v[76:79], a[164:167], a[48:51], v[28:31]
v_exp_f32 v92, v92
v_mfma_f32_16x16x32_bf16 v[76:79], a[168:171], a[52:55], v[76:79]
ds_read_b128 a[108:111], v2 offset:3072
ds_read_b128 a[192:195], v2 offset:11264
v_mfma_f32_16x16x32_bf16 v[76:79], a[172:175], a[56:59], v[76:79]
v_exp_f32 v93, v93
v_mfma_f32_16x16x32_bf16 v[76:79], a[176:179], a[60:63], v[76:79]
v_exp_f32 v94, v94
v_mfma_f32_16x16x32_bf16 v[68:71], a[176:179], a[44:47], v[24:27]
v_exp_f32 v95, v95
v_mfma_f32_16x16x32_bf16 v[68:71], a[172:175], a[40:43], v[68:71]
v_cvt_pk_bf16_f32 v62, v92, v93
v_cvt_pk_bf16_f32 v63, v94, v95
v_mfma_f32_16x16x32_bf16 v[68:71], a[168:171], a[36:39], v[68:71]
v_mfma_f32_16x16x32_bf16 v[68:71], a[164:167], a[32:35], v[68:71]
v_mfma_f32_16x16x32_bf16 v[112:115], a[96:99], v[48:51], v[112:115]
v_exp_f32 v244, v244
v_mfma_f32_16x16x32_bf16 v[112:115], a[180:183], v[52:55], v[112:115]
ds_read_b128 a[112:115], v2 offset:4096
v_mfma_f32_16x16x32_bf16 v[144:147], a[180:183], v[60:63], v[144:147]
v_exp_f32 v245, v245
v_mfma_f32_16x16x32_bf16 v[144:147], a[96:99], v[56:59], v[144:147]
s_waitcnt lgkmcnt(1)
ds_read_b128 a[196:199], v2 offset:12288
v_mfma_f32_16x16x32_bf16 v[148:151], a[100:103], v[56:59], v[148:151]
v_exp_f32 v246, v246
v_mfma_f32_16x16x32_bf16 v[148:151], a[184:187], v[60:63], v[148:151]
v_exp_f32 v247, v247
v_mfma_f32_16x16x32_bf16 v[116:119], a[184:187], v[52:55], v[116:119]
ds_read_b128 a[116:119], v2 offset:5120
v_mfma_f32_16x16x32_bf16 v[116:119], a[100:103], v[48:51], v[116:119]
v_cvt_pk_bf16_f32 v242, v244, v245
v_cvt_pk_bf16_f32 v243, v246, v247
v_mfma_f32_16x16x32_bf16 v[120:123], a[104:107], v[48:51], v[120:123]
ds_read_b128 a[200:203], v2 offset:13312
v_mfma_f32_16x16x32_bf16 v[120:123], a[188:191], v[52:55], v[120:123]
v_exp_f32 v252, v252
v_mfma_f32_16x16x32_bf16 v[152:155], a[188:191], v[60:63], v[152:155]
v_exp_f32 v253, v253
v_mfma_f32_16x16x32_bf16 v[152:155], a[104:107], v[56:59], v[152:155]
buffer_load_dwordx4 v1, s[32:35], s60 offen offset:0 sc1 lds
v_mfma_f32_16x16x32_bf16 v[156:159], a[108:111], v[56:59], v[156:159]
v_exp_f32 v254, v254
v_mfma_f32_16x16x32_bf16 v[156:159], a[192:195], v[60:63], v[156:159]
ds_read_b128 a[120:123], v2 offset:6144
v_mfma_f32_16x16x32_bf16 v[124:127], a[192:195], v[52:55], v[124:127]
v_exp_f32 v255, v255
v_mfma_f32_16x16x32_bf16 v[124:127], a[108:111], v[48:51], v[124:127]
s_waitcnt lgkmcnt(1)
ds_read_b128 a[204:207], v2 offset:14336
v_mfma_f32_16x16x32_bf16 v[128:131], a[112:115], v[48:51], v[128:131]
v_cvt_pk_bf16_f32 v250, v252, v253
v_cvt_pk_bf16_f32 v251, v254, v255
v_mfma_f32_16x16x32_bf16 v[128:131], a[196:199], v[52:55], v[128:131]
v_exp_f32 v96, v96
v_mfma_f32_16x16x32_bf16 v[160:163], a[196:199], v[60:63], v[160:163]
ds_read_b128 a[124:127], v2 offset:7168
v_mfma_f32_16x16x32_bf16 v[160:163], a[112:115], v[56:59], v[160:163]
v_exp_f32 v97, v97
v_mfma_f32_16x16x32_bf16 v[164:167], a[116:119], v[56:59], v[164:167]
ds_read_b128 a[208:211], v2 offset:15360
v_smfmac_f32_16x16x64_bf16 a[132:135], a[212:215], v[56:63], v14
v_mfma_f32_16x16x32_bf16 v[164:167], a[200:203], v[60:63], v[164:167]
v_exp_f32 v98, v98
v_mfma_f32_16x16x32_bf16 v[132:135], a[200:203], v[52:55], v[132:135]
s_waitcnt lgkmcnt(2)
v_exp_f32 v99, v99
v_mfma_f32_16x16x32_bf16 v[132:135], a[116:119], v[48:51], v[132:135]
buffer_load_dwordx4 v1, s[32:35], s60 offen offset:1024 sc1 lds
v_mfma_f32_16x16x32_bf16 v[136:139], a[120:123], v[48:51], v[136:139]
s_add_u32 s62, s62, s0
v_cvt_pk_bf16_f32 v244, v96, v97
v_cvt_pk_bf16_f32 v245, v98, v99
v_mfma_f32_16x16x32_bf16 v[136:139], a[204:207], v[52:55], v[136:139]
s_and_b32 s62, s62, 0x18000
v_exp_f32 v104, v104
v_mfma_f32_16x16x32_bf16 v[168:171], a[204:207], v[60:63], v[168:171]
ds_read_b128 a[64:67], v2 offset:24576
v_mfma_f32_16x16x32_bf16 v[168:171], a[120:123], v[56:59], v[168:171]
v_exp_f32 v105, v105
v_smfmac_f32_16x16x64_bf16 a[128:131], a[212:215], v[48:55], v14
s_waitcnt lgkmcnt(1)
v_mfma_f32_16x16x32_bf16 v[172:175], a[124:127], v[56:59], v[172:175]
v_exp_f32 v106, v106
v_mfma_f32_16x16x32_bf16 v[172:175], a[208:211], v[60:63], v[172:175]
ds_read_b128 a[68:71], v2 offset:25600
v_mfma_f32_16x16x32_bf16 v[140:143], a[208:211], v[52:55], v[140:143]
v_exp_f32 v107, v107
v_mfma_f32_16x16x32_bf16 v[140:143], a[124:127], v[48:51], v[140:143]
v_cvt_pk_bf16_f32 v252, v104, v105
v_cvt_pk_bf16_f32 v253, v106, v107
v_mfma_f32_16x16x32_bf16 v[48:51], a[148:151], a[0:3], v[32:35]
ds_read_b128 a[72:75], v2 offset:26624
v_mfma_f32_16x16x32_bf16 v[48:51], a[152:155], a[4:7], v[48:51]
v_exp_f32 v100, v100
v_mfma_f32_16x16x32_bf16 v[48:51], a[156:159], a[8:11], v[48:51]
v_exp_f32 v101, v101
v_mfma_f32_16x16x32_bf16 v[48:51], a[160:163], a[12:15], v[48:51]
ds_read_b128 a[76:79], v2 offset:27648
v_mfma_f32_16x16x32_bf16 v[56:59], a[160:163], a[28:31], v[20:23]
v_exp_f32 v102, v102
v_mfma_f32_16x16x32_bf16 v[56:59], a[156:159], a[24:27], v[56:59]
buffer_load_dwordx4 v1, s[32:35], s60 offen offset:2048 sc1 lds
v_mfma_f32_16x16x32_bf16 v[56:59], a[152:155], a[20:23], v[56:59]
v_exp_f32 v103, v103
v_mfma_f32_16x16x32_bf16 v[56:59], a[148:151], a[16:19], v[56:59]
v_cvt_pk_bf16_f32 v246, v100, v101
v_cvt_pk_bf16_f32 v247, v102, v103
v_mfma_f32_16x16x32_bf16 v[60:63], a[164:167], a[16:19], v[20:23]
ds_read_b128 a[80:83], v2 offset:28672
v_mfma_f32_16x16x32_bf16 v[60:63], a[168:171], a[20:23], v[60:63]
v_exp_f32 v108, v108
v_mfma_f32_16x16x32_bf16 v[60:63], a[172:175], a[24:27], v[60:63]
v_exp_f32 v109, v109
v_mfma_f32_16x16x32_bf16 v[60:63], a[176:179], a[28:31], v[60:63]
ds_read_b128 a[84:87], v2 offset:29696
v_mfma_f32_16x16x32_bf16 v[52:55], a[176:179], a[12:15], v[36:39]
v_exp_f32 v110, v110
v_mfma_f32_16x16x32_bf16 v[52:55], a[172:175], a[8:11], v[52:55]
v_exp_f32 v111, v111
v_mfma_f32_16x16x32_bf16 v[52:55], a[168:171], a[4:7], v[52:55]
ds_read_b128 a[88:91], v2 offset:30720
v_mfma_f32_16x16x32_bf16 v[52:55], a[164:167], a[0:3], v[52:55]
v_cvt_pk_bf16_f32 v254, v108, v109
v_cvt_pk_bf16_f32 v255, v110, v111
v_mfma_f32_16x16x32_bf16 v[176:179], a[96:99], v[240:243], v[176:179]
v_exp_f32 v64, v64
v_mfma_f32_16x16x32_bf16 v[176:179], a[180:183], v[244:247], v[176:179]
ds_read_b128 a[92:95], v2 offset:31744
v_mfma_f32_16x16x32_bf16 v[208:211], a[180:183], v[252:255], v[208:211]
v_exp_f32 v65, v65
v_mfma_f32_16x16x32_bf16 v[208:211], a[96:99], v[248:251], v[208:211]
v_mfma_f32_16x16x32_bf16 v[212:215], a[100:103], v[248:251], v[212:215]
v_exp_f32 v66, v66
v_mfma_f32_16x16x32_bf16 v[212:215], a[184:187], v[252:255], v[212:215]
v_exp_f32 v67, v67
v_mfma_f32_16x16x32_bf16 v[180:183], a[184:187], v[244:247], v[180:183]
v_cvt_pk_bf16_f32 v64, v64, v65
v_cvt_pk_bf16_f32 v65, v66, v67
v_mfma_f32_16x16x32_bf16 v[180:183], a[100:103], v[240:243], v[180:183]
buffer_load_dwordx4 v1, s[32:35], s60 offen offset:3072 sc1 lds
v_mfma_f32_16x16x32_bf16 v[184:187], a[104:107], v[240:243], v[184:187]
s_add_u32 s60, s60, 28672
v_exp_f32 v72, v72
v_mfma_f32_16x16x32_bf16 v[184:187], a[188:191], v[244:247], v[184:187]
s_add_u32 s61, s61, s0
v_exp_f32 v73, v73
v_mfma_f32_16x16x32_bf16 v[216:219], a[188:191], v[252:255], v[216:219]
s_and_b32 s61, s61, 0x1ffff
v_exp_f32 v74, v74
v_mfma_f32_16x16x32_bf16 v[216:219], a[104:107], v[248:251], v[216:219]
s_mov_b32 m0, s61
s_cmp_lg_u32 s63, 0
v_mfma_f32_16x16x32_bf16 v[220:223], a[108:111], v[248:251], v[220:223]
v_exp_f32 v75, v75
v_mfma_f32_16x16x32_bf16 v[220:223], a[192:195], v[252:255], v[220:223]
v_cvt_pk_bf16_f32 v72, v72, v73
v_cvt_pk_bf16_f32 v73, v74, v75
v_mfma_f32_16x16x32_bf16 v[188:191], a[192:195], v[244:247], v[188:191]
v_exp_f32 v48, v48
v_mfma_f32_16x16x32_bf16 v[188:191], a[108:111], v[240:243], v[188:191]
v_mfma_f32_16x16x32_bf16 v[192:195], a[112:115], v[240:243], v[192:195]
v_exp_f32 v49, v49
v_mfma_f32_16x16x32_bf16 v[192:195], a[196:199], v[244:247], v[192:195]
v_exp_f32 v50, v50
v_mfma_f32_16x16x32_bf16 v[224:227], a[196:199], v[252:255], v[224:227]
v_exp_f32 v51, v51
v_mfma_f32_16x16x32_bf16 v[224:227], a[112:115], v[248:251], v[224:227]
v_cvt_pk_bf16_f32 v48, v48, v49
v_cvt_pk_bf16_f32 v49, v50, v51
v_mfma_f32_16x16x32_bf16 v[228:231], a[116:119], v[248:251], v[228:231]
v_exp_f32 v56, v56
v_smfmac_f32_16x16x64_bf16 a[140:143], a[212:215], v[248:255], v14
v_mfma_f32_16x16x32_bf16 v[228:231], a[200:203], v[252:255], v[228:231]
v_exp_f32 v57, v57
v_mfma_f32_16x16x32_bf16 v[196:199], a[200:203], v[244:247], v[196:199]
v_exp_f32 v58, v58
v_mfma_f32_16x16x32_bf16 v[196:199], a[116:119], v[240:243], v[196:199]
v_mfma_f32_16x16x32_bf16 v[200:203], a[120:123], v[240:243], v[200:203]
v_exp_f32 v59, v59
v_mfma_f32_16x16x32_bf16 v[200:203], a[204:207], v[244:247], v[200:203]
v_cvt_pk_bf16_f32 v56, v56, v57
v_cvt_pk_bf16_f32 v57, v58, v59
v_mfma_f32_16x16x32_bf16 v[232:235], a[204:207], v[252:255], v[232:235]
v_mfma_f32_16x16x32_bf16 v[232:235], a[120:123], v[248:251], v[232:235]
v_or_b32 v2, s62, v1
v_smfmac_f32_16x16x64_bf16 a[136:139], a[212:215], v[240:247], v14
v_mfma_f32_16x16x32_bf16 v[236:239], a[124:127], v[248:251], v[236:239]
v_mfma_f32_16x16x32_bf16 v[236:239], a[208:211], v[252:255], v[236:239]
v_mfma_f32_16x16x32_bf16 v[204:207], a[208:211], v[244:247], v[204:207]
v_mfma_f32_16x16x32_bf16 v[204:207], a[124:127], v[240:243], v[204:207]
s_waitcnt vmcnt(16) lgkmcnt(0)
s_barrier
s_cbranch_scc1 Lt44
s_cmp_lg_u32 s30, 0
s_cbranch_scc1 Lph_np
v_mov_b32 v8, 1
s_mov_b64 exec, 1
buffer_store_dword v8, off, s[48:51], s17 offset:1024 sc1
s_mov_b64 exec, -1
Lph_np:
Lt43:
v_mfma_f32_16x16x32_bf16 v[80:83], a[64:67], a[0:3], v[40:43]
ds_read_b128 a[96:99], v2 offset:0
ds_read_b128 a[180:183], v2 offset:8192
v_mfma_f32_16x16x32_bf16 v[80:83], a[68:71], a[4:7], v[80:83]
buffer_load_dword a224, v3, s[96:99], 0 offen
v_mfma_f32_16x16x32_bf16 v[80:83], a[72:75], a[8:11], v[80:83]
ds_read_b128 a[100:103], v2 offset:1024
ds_read_b128 a[184:187], v2 offset:9216
v_mfma_f32_16x16x32_bf16 v[80:83], a[76:79], a[12:15], v[80:83]
ds_read_b128 a[104:107], v2 offset:2048
ds_read_b128 a[188:191], v2 offset:10240
v_mfma_f32_16x16x32_bf16 v[88:91], a[76:79], a[28:31], v[20:23]
ds_read_b128 a[108:111], v2 offset:3072
ds_read_b128 a[192:195], v2 offset:11264
v_mfma_f32_16x16x32_bf16 v[88:91], a[72:75], a[24:27], v[88:91]
buffer_load_dwordx4 v1, s[32:35], s60 offen offset:0 sc1 lds
v_mfma_f32_16x16x32_bf16 v[88:91], a[68:71], a[20:23], v[88:91]
ds_read_b128 a[112:115], v2 offset:4096
ds_read_b128 a[196:199], v2 offset:12288
v_mfma_f32_16x16x32_bf16 v[88:91], a[64:67], a[16:19], v[88:91]
ds_read_b128 a[116:119], v2 offset:5120
ds_read_b128 a[200:203], v2 offset:13312
v_mfma_f32_16x16x32_bf16 v[92:95], a[80:83], a[16:19], v[20:23]
ds_read_b128 a[120:123], v2 offset:6144
ds_read_b128 a[204:207], v2 offset:14336
v_mfma_f32_16x16x32_bf16 v[92:95], a[84:87], a[20:23], v[92:95]
v_exp_f32 v52, v52
v_exp_f32 v53, v53
v_exp_f32 v54, v54
v_mfma_f32_16x16x32_bf16 v[92:95], a[88:91], a[24:27], v[92:95]
v_exp_f32 v55, v55
s_nop 0
v_cvt_pk_bf16_f32 v50, v52, v53
v_cvt_pk_bf16_f32 v51, v54, v55
v_exp_f32 v80, v80
v_mfma_f32_16x16x32_bf16 v[92:95], a[92:95], a[28:31], v[92:95]
s_mov_b32 s96, s4
v_exp_f32 v81, v81
v_exp_f32 v82, v82
v_exp_f32 v83, v83
v_mfma_f32_16x16x32_bf16 v[84:87], a[92:95], a[12:15], v[44:47]
s_mov_b32 s97, s5
v_cvt_pk_bf16_f32 v52, v80, v81
v_cvt_pk_bf16_f32 v53, v82, v83
v_mfma_f32_16x16x32_bf16 v[84:87], a[88:91], a[8:11], v[84:87]
ds_read_b128 a[148:151], v2 offset:16384
ds_read_b128 a[152:155], v2 offset:17408
v_mfma_f32_16x16x32_bf16 v[84:87], a[84:87], a[4:7], v[84:87]
s_mov_b32 s98, 0x280000
v_cndmask_b32 v32, v4, v20, s[64:65]
v_cndmask_b32 v33, v4, v20, s[66:67]
v_mfma_f32_16x16x32_bf16 v[84:87], a[80:83], a[0:3], v[84:87]
ds_read_b128 a[124:127], v2 offset:7168
ds_read_b128 a[208:211], v2 offset:15360
v_mfma_f32_16x16x32_bf16 v[96:99], a[64:67], a[32:35], v[24:27]
v_cndmask_b32 v34, v4, v20, s[68:69]
v_cndmask_b32 v35, v4, v20, s[70:71]
v_mfma_f32_16x16x32_bf16 v[96:99], a[68:71], a[36:39], v[96:99]
ds_read_b128 a[156:159], v2 offset:18432
ds_read_b128 a[160:163], v2 offset:19456
v_mfma_f32_16x16x32_bf16 v[96:99], a[72:75], a[40:43], v[96:99]
buffer_load_dwordx4 v1, s[32:35], s60 offen offset:1024 sc1 lds
v_mfma_f32_16x16x32_bf16 v[96:99], a[76:79], a[44:47], v[96:99]
ds_read_b128 a[164:167], v2 offset:20480
ds_read_b128 a[168:171], v2 offset:21504
v_mfma_f32_16x16x32_bf16 v[104:107], a[76:79], a[60:63], v[28:31]
v_cndmask_b32 v36, v4, v20, s[72:73]
v_cndmask_b32 v37, v4, v20, s[74:75]
v_mfma_f32_16x16x32_bf16 v[104:107], a[72:75], a[56:59], v[104:107]
v_exp_f32 v84, v84
v_mfma_f32_16x16x32_bf16 v[104:107], a[68:71], a[52:55], v[104:107]
v_exp_f32 v85, v85
v_mfma_f32_16x16x32_bf16 v[104:107], a[64:67], a[48:51], v[104:107]
v_exp_f32 v86, v86
v_mfma_f32_16x16x32_bf16 v[108:111], a[80:83], a[48:51], v[28:31]
v_exp_f32 v87, v87
v_mfma_f32_16x16x32_bf16 v[108:111], a[84:87], a[52:55], v[108:111]
v_cvt_pk_bf16_f32 v54, v84, v85
v_cvt_pk_bf16_f32 v55, v86, v87
v_mfma_f32_16x16x32_bf16 v[108:111], a[88:91], a[56:59], v[108:111]
v_exp_f32 v60, v60
v_mfma_f32_16x16x32_bf16 v[108:111], a[92:95], a[60:63], v[108:111]
v_exp_f32 v61, v61
v_mfma_f32_16x16x32_bf16 v[100:103], a[92:95], a[44:47], v[24:27]
v_exp_f32 v62, v62
v_mfma_f32_16x16x32_bf16 v[100:103], a[88:91], a[40:43], v[100:103]
v_exp_f32 v63, v63
v_mfma_f32_16x16x32_bf16 v[100:103], a[84:87], a[36:39], v[100:103]
ds_read_b128 a[172:175], v2 offset:22528
ds_read_b128 a[176:179], v2 offset:23552
v_mfma_f32_16x16x32_bf16 v[100:103], a[80:83], a[32:35], v[100:103]
s_waitcnt lgkmcnt(2)
v_cvt_pk_bf16_f32 v58, v60, v61
v_cvt_pk_bf16_f32 v59, v62, v63
v_mfma_f32_16x16x32_bf16 v[112:115], a[96:99], v[48:51], v[112:115]
v_exp_f32 v88, v88
v_mfma_f32_16x16x32_bf16 v[112:115], a[180:183], v[52:55], v[112:115]
v_exp_f32 v89, v89
v_mfma_f32_16x16x32_bf16 v[116:119], a[184:187], v[52:55], v[116:119]
buffer_load_dwordx4 v1, s[32:35], s60 offen offset:2048 sc1 lds
v_mfma_f32_16x16x32_bf16 v[116:119], a[100:103], v[48:51], v[116:119]
v_exp_f32 v90, v90
v_mfma_f32_16x16x32_bf16 v[120:123], a[104:107], v[48:51], v[120:123]
v_exp_f32 v91, v91
v_mfma_f32_16x16x32_bf16 v[120:123], a[188:191], v[52:55], v[120:123]
v_cvt_pk_bf16_f32 v60, v88, v89
v_cvt_pk_bf16_f32 v61, v90, v91
v_mfma_f32_16x16x32_bf16 v[124:127], a[192:195], v[52:55], v[124:127]
v_exp_f32 v92, v92
v_mfma_f32_16x16x32_bf16 v[124:127], a[108:111], v[48:51], v[124:127]
v_exp_f32 v93, v93
v_mfma_f32_16x16x32_bf16 v[128:131], a[112:115], v[48:51], v[128:131]
v_exp_f32 v94, v94
v_mfma_f32_16x16x32_bf16 v[128:131], a[196:199], v[52:55], v[128:131]
v_exp_f32 v95, v95
v_mfma_f32_16x16x32_bf16 v[132:135], a[200:203], v[52:55], v[132:135]
v_cvt_pk_bf16_f32 v62, v92, v93
v_cvt_pk_bf16_f32 v63, v94, v95
v_mfma_f32_16x16x32_bf16 v[132:135], a[116:119], v[48:51], v[132:135]
v_exp_f32 v68, v68
v_smfmac_f32_16x16x64_bf16 a[128:131], a[212:215], v[48:55], v14
buffer_load_dwordx4 v1, s[32:35], s60 offen offset:3072 sc1 lds
v_mfma_f32_16x16x32_bf16 v[136:139], a[120:123], v[48:51], v[136:139]
s_add_u32 s60, s60, 4096
v_exp_f32 v69, v69
v_mfma_f32_16x16x32_bf16 v[136:139], a[204:207], v[52:55], v[136:139]
s_add_u32 m0, s61, 4096
v_exp_f32 v70, v70
v_mfma_f32_16x16x32_bf16 v[140:143], a[208:211], v[52:55], v[140:143]
v_exp_f32 v71, v71
v_mfma_f32_16x16x32_bf16 v[140:143], a[124:127], v[48:51], v[140:143]
v_cvt_pk_bf16_f32 v66, v68, v69
v_cvt_pk_bf16_f32 v67, v70, v71
v_mfma_f32_16x16x32_bf16 v[80:83], a[148:151], a[32:35], v[24:27]
v_exp_f32 v96, v96
v_mfma_f32_16x16x32_bf16 v[80:83], a[152:155], a[36:39], v[80:83]
v_exp_f32 v97, v97
v_mfma_f32_16x16x32_bf16 v[80:83], a[156:159], a[40:43], v[80:83]
v_exp_f32 v98, v98
v_mfma_f32_16x16x32_bf16 v[80:83], a[160:163], a[44:47], v[80:83]
v_exp_f32 v99, v99
v_mfma_f32_16x16x32_bf16 v[48:51], a[160:163], a[60:63], v[28:31]
v_cvt_pk_bf16_f32 v68, v96, v97
v_cvt_pk_bf16_f32 v69, v98, v99
v_mfma_f32_16x16x32_bf16 v[48:51], a[156:159], a[56:59], v[48:51]
v_exp_f32 v100, v100
v_mfma_f32_16x16x32_bf16 v[48:51], a[152:155], a[52:55], v[48:51]
v_exp_f32 v101, v101
v_mfma_f32_16x16x32_bf16 v[48:51], a[148:151], a[48:51], v[48:51]
v_exp_f32 v102, v102
v_mfma_f32_16x16x32_bf16 v[52:55], a[164:167], a[48:51], v[28:31]
v_exp_f32 v103, v103
v_mfma_f32_16x16x32_bf16 v[52:55], a[168:171], a[52:55], v[52:55]
s_waitcnt lgkmcnt(0)
v_cvt_pk_bf16_f32 v70, v100, v101
v_cvt_pk_bf16_f32 v71, v102, v103
v_mfma_f32_16x16x32_bf16 v[52:55], a[172:175], a[56:59], v[52:55]
v_exp_f32 v76, v76
v_mfma_f32_16x16x32_bf16 v[52:55], a[176:179], a[60:63], v[52:55]
v_exp_f32 v77, v77
v_mfma_f32_16x16x32_bf16 v[84:87], a[176:179], a[44:47], v[24:27]
v_exp_f32 v78, v78
v_mfma_f32_16x16x32_bf16 v[84:87], a[172:175], a[40:43], v[84:87]
v_exp_f32 v79, v79
v_mfma_f32_16x16x32_bf16 v[84:87], a[168:171], a[36:39], v[84:87]
v_cvt_pk_bf16_f32 v74, v76, v77
v_cvt_pk_bf16_f32 v75, v78, v79
v_mfma_f32_16x16x32_bf16 v[84:87], a[164:167], a[32:35], v[84:87]
buffer_load_dwordx4 v1, s[32:35], s60 offen offset:0 sc1 lds
v_mfma_f32_16x16x32_bf16 v[144:147], a[96:99], v[56:59], v[144:147]
s_add_u32 s62, s62, s0
v_exp_f32 v104, v104
v_mfma_f32_16x16x32_bf16 v[144:147], a[180:183], v[60:63], v[144:147]
s_and_b32 s62, s62, 0x18000
v_cndmask_b32 v38, v4, v20, s[76:77]
v_cndmask_b32 v39, v4, v20, s[78:79]
v_mfma_f32_16x16x32_bf16 v[148:151], a[184:187], v[60:63], v[148:151]
v_exp_f32 v105, v105
v_mfma_f32_16x16x32_bf16 v[148:151], a[100:103], v[56:59], v[148:151]
v_exp_f32 v106, v106
v_mfma_f32_16x16x32_bf16 v[152:155], a[104:107], v[56:59], v[152:155]
v_exp_f32 v107, v107
v_mfma_f32_16x16x32_bf16 v[152:155], a[188:191], v[60:63], v[152:155]
v_cvt_pk_bf16_f32 v76, v104, v105
v_cvt_pk_bf16_f32 v77, v106, v107
v_mfma_f32_16x16x32_bf16 v[156:159], a[192:195], v[60:63], v[156:159]
v_exp_f32 v108, v108
v_mfma_f32_16x16x32_bf16 v[156:159], a[108:111], v[56:59], v[156:159]
v_exp_f32 v109, v109
v_mfma_f32_16x16x32_bf16 v[160:163], a[112:115], v[56:59], v[160:163]
v_exp_f32 v110, v110
v_mfma_f32_16x16x32_bf16 v[160:163], a[196:199], v[60:63], v[160:163]
v_exp_f32 v111, v111
v_mfma_f32_16x16x32_bf16 v[164:167], a[200:203], v[60:63], v[164:167]
v_cvt_pk_bf16_f32 v78, v108, v109
v_cvt_pk_bf16_f32 v79, v110, v111
v_mfma_f32_16x16x32_bf16 v[164:167], a[116:119], v[56:59], v[164:167]
buffer_load_dwordx4 v1, s[32:35], s60 offen offset:1024 sc1 lds
v_smfmac_f32_16x16x64_bf16 a[132:135], a[212:215], v[56:63], v14
ds_read_b128 a[64:67], v2 offset:24576
ds_read_b128 a[68:71], v2 offset:25600
v_mfma_f32_16x16x32_bf16 v[168:171], a[120:123], v[56:59], v[168:171]
v_lshrrev_b32 v250, 4, v0
v_and_b32 v253, 15, v0
v_mfma_f32_16x16x32_bf16 v[168:171], a[204:207], v[60:63], v[168:171]
v_mul_u32_u24 v253, 1280, v253
v_lshl_add_u32 v248, v250, 3, v253
v_mfma_f32_16x16x32_bf16 v[172:175], a[208:211], v[60:63], v[172:175]
v_bfe_u32 v251, v0, 2, 2
v_and_b32 v252, 3, v0
v_mfma_f32_16x16x32_bf16 v[172:175], a[124:127], v[56:59], v[172:175]
v_add_u32 v245, s52, v1
v_lshl_add_u32 v246, v252, 3, s53
v_mfma_f32_16x16x32_bf16 v[56:59], a[148:151], a[16:19], v[32:35]
v_lshl_add_u32 v246, v251, 6, v246
v_and_b32 v253, 1, v250
v_mfma_f32_16x16x32_bf16 v[56:59], a[152:155], a[20:23], v[56:59]
buffer_load_dwordx4 v1, s[32:35], s60 offen offset:2048 sc1 lds
v_mfma_f32_16x16x32_bf16 v[56:59], a[156:159], a[24:27], v[56:59]
v_mul_u32_u24 v253, 5152, v253
v_add_u32 v253, v246, v253
v_mfma_f32_16x16x32_bf16 v[56:59], a[160:163], a[28:31], v[56:59]
ds_read_b128 a[72:75], v2 offset:26624
ds_read_b128 a[76:79], v2 offset:27648
v_mfma_f32_16x16x32_bf16 v[60:63], a[176:179], a[28:31], v[36:39]
v_lshrrev_b32 v254, 1, v250
v_lshl_add_u32 v246, v254, 11, v253
v_mfma_f32_16x16x32_bf16 v[60:63], a[172:175], a[24:27], v[60:63]
v_lshl_add_u32 v247, v254, 9, v253
v_add_u32 v247, s54, v247
v_mfma_f32_16x16x32_bf16 v[60:63], a[168:171], a[20:23], v[60:63]
ds_read_b128 a[80:83], v2 offset:28672
ds_read_b128 a[84:87], v2 offset:29696
v_mfma_f32_16x16x32_bf16 v[60:63], a[164:167], a[16:19], v[60:63]
s_and_b32 s53, s30, 1
v_cndmask_b32 v40, v4, v20, s[80:81]
v_cndmask_b32 v41, v4, v20, s[82:83]
v_mfma_f32_16x16x32_bf16 v[176:179], a[96:99], v[64:67], v[176:179]
s_lshl_b32 s52, s53, 7
v_cndmask_b32 v42, v4, v20, s[84:85]
v_cndmask_b32 v43, v4, v20, s[86:87]
v_mfma_f32_16x16x32_bf16 v[176:179], a[180:183], v[68:71], v[176:179]
ds_read_b128 a[88:91], v2 offset:30720
ds_read_b128 a[92:95], v2 offset:31744
v_mfma_f32_16x16x32_bf16 v[208:211], a[180:183], v[76:79], v[208:211]
s_lshl_b32 s53, s53, 5
v_cndmask_b32 v44, v4, v20, s[88:89]
v_cndmask_b32 v45, v4, v20, s[90:91]
v_mfma_f32_16x16x32_bf16 v[208:211], a[96:99], v[72:75], v[208:211]
v_cndmask_b32 v46, v4, v20, s[92:93]
v_cndmask_b32 v47, v4, v20, s[94:95]
v_mfma_f32_16x16x32_bf16 v[212:215], a[100:103], v[72:75], v[212:215]
v_mov_b32 v32, v24
v_mov_b32 v33, v24
v_mfma_f32_16x16x32_bf16 v[212:215], a[184:187], v[76:79], v[212:215]
v_mov_b32 v34, v24
v_mov_b32 v35, v24
v_mfma_f32_16x16x32_bf16 v[180:183], a[184:187], v[68:71], v[180:183]
v_exp_f32 v56, v56
v_mfma_f32_16x16x32_bf16 v[180:183], a[100:103], v[64:67], v[180:183]
v_mov_b32 v36, v24
v_mov_b32 v37, v24
v_mfma_f32_16x16x32_bf16 v[184:187], a[104:107], v[64:67], v[184:187]
buffer_load_dwordx4 v1, s[32:35], s60 offen offset:3072 sc1 lds
v_mfma_f32_16x16x32_bf16 v[184:187], a[188:191], v[68:71], v[184:187]
s_add_u32 s60, s60, 28672
v_exp_f32 v57, v57
v_mfma_f32_16x16x32_bf16 v[216:219], a[188:191], v[76:79], v[216:219]
s_add_u32 s61, s61, s0
v_mov_b32 v38, v24
v_mov_b32 v39, v24
v_mfma_f32_16x16x32_bf16 v[216:219], a[104:107], v[72:75], v[216:219]
s_and_b32 s61, s61, 0x1ffff
v_or_b32 v2, s62, v1
v_mfma_f32_16x16x32_bf16 v[220:223], a[108:111], v[72:75], v[220:223]
s_mov_b32 m0, s61
v_exp_f32 v58, v58
v_mfma_f32_16x16x32_bf16 v[220:223], a[192:195], v[76:79], v[220:223]
v_exp_f32 v59, v59
v_mfma_f32_16x16x32_bf16 v[188:191], a[192:195], v[68:71], v[188:191]
v_cvt_pk_bf16_f32 v56, v56, v57
v_cvt_pk_bf16_f32 v57, v58, v59
v_mfma_f32_16x16x32_bf16 v[188:191], a[108:111], v[64:67], v[188:191]
v_exp_f32 v60, v60
v_mfma_f32_16x16x32_bf16 v[192:195], a[112:115], v[64:67], v[192:195]
v_exp_f32 v61, v61
v_mfma_f32_16x16x32_bf16 v[192:195], a[196:199], v[68:71], v[192:195]
v_exp_f32 v62, v62
v_mfma_f32_16x16x32_bf16 v[224:227], a[196:199], v[76:79], v[224:227]
v_exp_f32 v63, v63
v_mfma_f32_16x16x32_bf16 v[224:227], a[112:115], v[72:75], v[224:227]
v_cvt_pk_bf16_f32 v58, v60, v61
v_cvt_pk_bf16_f32 v59, v62, v63
v_mfma_f32_16x16x32_bf16 v[228:231], a[116:119], v[72:75], v[228:231]
v_exp_f32 v80, v80
v_smfmac_f32_16x16x64_bf16 a[140:143], a[212:215], v[72:79], v14
v_exp_f32 v81, v81
v_mfma_f32_16x16x32_bf16 v[228:231], a[200:203], v[76:79], v[228:231]
v_exp_f32 v82, v82
v_mfma_f32_16x16x32_bf16 v[196:199], a[200:203], v[68:71], v[196:199]
v_exp_f32 v83, v83
v_mfma_f32_16x16x32_bf16 v[196:199], a[116:119], v[64:67], v[196:199]
v_cvt_pk_bf16_f32 v80, v80, v81
v_cvt_pk_bf16_f32 v81, v82, v83
v_mfma_f32_16x16x32_bf16 v[200:203], a[120:123], v[64:67], v[200:203]
v_exp_f32 v84, v84
v_mfma_f32_16x16x32_bf16 v[200:203], a[204:207], v[68:71], v[200:203]
v_exp_f32 v85, v85
v_mfma_f32_16x16x32_bf16 v[232:235], a[204:207], v[76:79], v[232:235]
v_exp_f32 v86, v86
v_mfma_f32_16x16x32_bf16 v[232:235], a[120:123], v[72:75], v[232:235]
v_exp_f32 v87, v87
v_smfmac_f32_16x16x64_bf16 a[136:139], a[212:215], v[64:71], v14
v_cvt_pk_bf16_f32 v82, v84, v85
v_cvt_pk_bf16_f32 v83, v86, v87
v_mfma_f32_16x16x32_bf16 v[236:239], a[124:127], v[72:75], v[236:239]
v_exp_f32 v48, v48
v_mfma_f32_16x16x32_bf16 v[236:239], a[208:211], v[76:79], v[236:239]
v_exp_f32 v49, v49
v_mfma_f32_16x16x32_bf16 v[204:207], a[208:211], v[68:71], v[204:207]
v_exp_f32 v50, v50
v_mfma_f32_16x16x32_bf16 v[204:207], a[124:127], v[64:67], v[204:207]
s_bitcmp1_b32 s8, 0
s_cselect_b32 s54, 64, 0
s_cselect_b32 s55, 0, 0x100
s_add_u32 s52, s52, s54
s_add_u32 s53, s53, s55
s_add_u32 s52, s52, s13
s_add_u32 s53, s53, s13
s_cmp_eq_u32 s3, 7
s_waitcnt vmcnt(17) lgkmcnt(0)
s_barrier
s_cbranch_scc1 Lt32m
Lt32:
v_mfma_f32_16x16x32_bf16 v[88:91], a[64:67], a[16:19], v[40:43]
ds_read_b128 a[148:151], v2 offset:16384
ds_read_b128 a[152:155], v2 offset:17408
v_mfma_f32_16x16x32_bf16 v[88:91], a[68:71], a[20:23], v[88:91]
buffer_load_dwordx4 v1, s[32:35], s60 offen offset:0 sc1 lds
v_mfma_f32_16x16x32_bf16 v[88:91], a[72:75], a[24:27], v[88:91]
ds_read_b128 a[156:159], v2 offset:18432
ds_read_b128 a[160:163], v2 offset:19456
v_mfma_f32_16x16x32_bf16 v[88:91], a[76:79], a[28:31], v[88:91]
ds_read_b128 a[164:167], v2 offset:20480
ds_read_b128 a[168:171], v2 offset:21504
v_mfma_f32_16x16x32_bf16 v[92:95], a[92:95], a[28:31], v[44:47]
ds_read_b128 a[172:175], v2 offset:22528
ds_read_b128 a[176:179], v2 offset:23552
v_mfma_f32_16x16x32_bf16 v[92:95], a[88:91], a[24:27], v[92:95]
buffer_load_dwordx4 v1, s[32:35], s60 offen offset:1024 sc1 lds
v_mfma_f32_16x16x32_bf16 v[92:95], a[84:87], a[20:23], v[92:95]
ds_read_b128 a[96:99], v2 offset:0
ds_read_b128 a[180:183], v2 offset:8192
v_mfma_f32_16x16x32_bf16 v[92:95], a[80:83], a[16:19], v[92:95]
ds_read_b128 a[100:103], v2 offset:1024
ds_read_b128 a[184:187], v2 offset:9216
v_mfma_f32_16x16x32_bf16 v[96:99], a[64:67], a[32:35], v[24:27]
ds_read_b128 a[104:107], v2 offset:2048
ds_read_b128 a[188:191], v2 offset:10240
v_mfma_f32_16x16x32_bf16 v[96:99], a[68:71], a[36:39], v[96:99]
buffer_load_dwordx2 a[230:231], v248, s[96:99], s52 offen offset:0
v_mfma_f32_16x16x32_bf16 v[96:99], a[72:75], a[40:43], v[96:99]
v_exp_f32 v51, v51
s_nop 0
v_cvt_pk_bf16_f32 v48, v48, v49
v_cvt_pk_bf16_f32 v49, v50, v51
v_mfma_f32_16x16x32_bf16 v[96:99], a[76:79], a[44:47], v[96:99]
v_exp_f32 v52, v52
v_mfma_f32_16x16x32_bf16 v[104:107], a[76:79], a[60:63], v[28:31]
v_exp_f32 v53, v53
v_mfma_f32_16x16x32_bf16 v[104:107], a[72:75], a[56:59], v[104:107]
v_exp_f32 v54, v54
v_mfma_f32_16x16x32_bf16 v[104:107], a[68:71], a[52:55], v[104:107]
v_exp_f32 v55, v55
v_mfma_f32_16x16x32_bf16 v[104:107], a[64:67], a[48:51], v[104:107]
v_cvt_pk_bf16_f32 v50, v52, v53
v_cvt_pk_bf16_f32 v51, v54, v55
v_mfma_f32_16x16x32_bf16 v[108:111], a[80:83], a[48:51], v[28:31]
v_exp_f32 v88, v88
v_mfma_f32_16x16x32_bf16 v[108:111], a[84:87], a[52:55], v[108:111]
v_exp_f32 v89, v89
v_mfma_f32_16x16x32_bf16 v[108:111], a[88:91], a[56:59], v[108:111]
v_exp_f32 v90, v90
v_mfma_f32_16x16x32_bf16 v[108:111], a[92:95], a[60:63], v[108:111]
v_exp_f32 v91, v91
v_mfma_f32_16x16x32_bf16 v[100:103], a[92:95], a[44:47], v[24:27]
v_cvt_pk_bf16_f32 v60, v88, v89
v_cvt_pk_bf16_f32 v61, v90, v91
v_mfma_f32_16x16x32_bf16 v[100:103], a[88:91], a[40:43], v[100:103]
buffer_load_dwordx4 v1, s[32:35], s60 offen offset:2048 sc1 lds
v_mfma_f32_16x16x32_bf16 v[100:103], a[84:87], a[36:39], v[100:103]
v_exp_f32 v92, v92
v_mfma_f32_16x16x32_bf16 v[100:103], a[80:83], a[32:35], v[100:103]
s_waitcnt lgkmcnt(0)
v_exp_f32 v93, v93
v_mfma_f32_16x16x32_bf16 v[64:67], a[148:151], a[32:35], v[32:35]
v_exp_f32 v94, v94
v_mfma_f32_16x16x32_bf16 v[64:67], a[152:155], a[36:39], v[64:67]
v_exp_f32 v95, v95
v_mfma_f32_16x16x32_bf16 v[64:67], a[156:159], a[40:43], v[64:67]
v_cvt_pk_bf16_f32 v62, v92, v93
v_cvt_pk_bf16_f32 v63, v94, v95
v_mfma_f32_16x16x32_bf16 v[64:67], a[160:163], a[44:47], v[64:67]
v_exp_f32 v96, v96
v_mfma_f32_16x16x32_bf16 v[72:75], a[160:163], a[60:63], v[28:31]
buffer_load_dwordx2 a[232:233], v248, s[96:99], s52 offen offset:32
v_mfma_f32_16x16x32_bf16 v[72:75], a[156:159], a[56:59], v[72:75]
v_exp_f32 v97, v97
v_mfma_f32_16x16x32_bf16 v[72:75], a[152:155], a[52:55], v[72:75]
ds_read_b128 a[108:111], v2 offset:3072
ds_read_b128 a[192:195], v2 offset:11264
v_mfma_f32_16x16x32_bf16 v[72:75], a[148:151], a[48:51], v[72:75]
v_exp_f32 v98, v98
v_mfma_f32_16x16x32_bf16 v[76:79], a[164:167], a[48:51], v[28:31]
v_exp_f32 v99, v99
v_mfma_f32_16x16x32_bf16 v[76:79], a[168:171], a[52:55], v[76:79]
ds_read_b128 a[112:115], v2 offset:4096
ds_read_b128 a[196:199], v2 offset:12288
v_mfma_f32_16x16x32_bf16 v[76:79], a[172:175], a[56:59], v[76:79]
v_cvt_pk_bf16_f32 v84, v96, v97
v_cvt_pk_bf16_f32 v85, v98, v99
v_mfma_f32_16x16x32_bf16 v[76:79], a[176:179], a[60:63], v[76:79]
v_exp_f32 v100, v100
v_mfma_f32_16x16x32_bf16 v[68:71], a[176:179], a[44:47], v[36:39]
ds_read_b128 a[116:119], v2 offset:5120
ds_read_b128 a[200:203], v2 offset:13312
v_mfma_f32_16x16x32_bf16 v[68:71], a[172:175], a[40:43], v[68:71]
v_exp_f32 v101, v101
v_mfma_f32_16x16x32_bf16 v[68:71], a[168:171], a[36:39], v[68:71]
buffer_load_dwordx4 v1, s[32:35], s60 offen offset:3072 sc1 lds
v_mfma_f32_16x16x32_bf16 v[68:71], a[164:167], a[32:35], v[68:71]
s_add_u32 s60, s60, 4096
v_exp_f32 v102, v102
v_mfma_f32_16x16x32_bf16 v[144:147], a[96:99], v[56:59], v[144:147]
ds_read_b128 a[120:123], v2 offset:6144
ds_read_b128 a[204:207], v2 offset:14336
v_mfma_f32_16x16x32_bf16 v[144:147], a[180:183], v[60:63], v[144:147]
s_add_u32 m0, s61, 4096
v_exp_f32 v103, v103
v_mfma_f32_16x16x32_bf16 v[148:151], a[184:187], v[60:63], v[148:151]
v_cvt_pk_bf16_f32 v86, v100, v101
v_cvt_pk_bf16_f32 v87, v102, v103
v_mfma_f32_16x16x32_bf16 v[148:151], a[100:103], v[56:59], v[148:151]
ds_read_b128 a[124:127], v2 offset:7168
ds_read_b128 a[208:211], v2 offset:15360
v_mfma_f32_16x16x32_bf16 v[152:155], a[104:107], v[56:59], v[152:155]
v_exp_f32 v104, v104
v_mfma_f32_16x16x32_bf16 v[152:155], a[188:191], v[60:63], v[152:155]
s_waitcnt lgkmcnt(4)
v_exp_f32 v105, v105
v_mfma_f32_16x16x32_bf16 v[156:159], a[192:195], v[60:63], v[156:159]
v_exp_f32 v106, v106
v_mfma_f32_16x16x32_bf16 v[156:159], a[108:111], v[56:59], v[156:159]
buffer_load_dwordx2 a[234:235], v248, s[96:99], s52 offen offset:64
v_mfma_f32_16x16x32_bf16 v[160:163], a[112:115], v[56:59], v[160:163]
v_exp_f32 v107, v107
v_mfma_f32_16x16x32_bf16 v[160:163], a[196:199], v[60:63], v[160:163]
v_cvt_pk_bf16_f32 v52, v104, v105
v_cvt_pk_bf16_f32 v53, v106, v107
v_mfma_f32_16x16x32_bf16 v[164:167], a[200:203], v[60:63], v[164:167]
v_exp_f32 v108, v108
v_mfma_f32_16x16x32_bf16 v[164:167], a[116:119], v[56:59], v[164:167]
s_waitcnt lgkmcnt(0)
v_exp_f32 v109, v109
v_smfmac_f32_16x16x64_bf16 a[132:135], a[212:215], v[56:63], v14
buffer_load_dwordx4 v1, s[32:35], s60 offen offset:0 sc1 lds
v_mfma_f32_16x16x32_bf16 v[168:171], a[120:123], v[56:59], v[168:171]
s_add_u32 s62, s62, s0
v_exp_f32 v110, v110
v_mfma_f32_16x16x32_bf16 v[168:171], a[204:207], v[60:63], v[168:171]
s_and_b32 s62, s62, 0x18000
v_exp_f32 v111, v111
v_mfma_f32_16x16x32_bf16 v[172:175], a[208:211], v[60:63], v[172:175]
v_cvt_pk_bf16_f32 v54, v108, v109
v_cvt_pk_bf16_f32 v55, v110, v111
v_mfma_f32_16x16x32_bf16 v[172:175], a[124:127], v[56:59], v[172:175]
buffer_load_dwordx2 a[236:237], v248, s[96:99], s52 offen offset:96
v_mfma_f32_16x16x32_bf16 v[176:179], a[96:99], v[80:83], v[176:179]
ds_read_b128 a[64:67], v2 offset:24576
ds_read_b128 a[68:71], v2 offset:25600
v_mfma_f32_16x16x32_bf16 v[176:179], a[180:183], v[84:87], v[176:179]
buffer_load_dwordx4 v1, s[32:35], s60 offen offset:1024 sc1 lds
v_mfma_f32_16x16x32_bf16 v[208:211], a[180:183], v[52:55], v[208:211]
ds_read_b128 a[72:75], v2 offset:26624
ds_read_b128 a[76:79], v2 offset:27648
v_mfma_f32_16x16x32_bf16 v[208:211], a[96:99], v[48:51], v[208:211]
v_exp_f32 v64, v64
v_mfma_f32_16x16x32_bf16 v[212:215], a[100:103], v[48:51], v[212:215]
ds_read_b128 a[80:83], v2 offset:28672
ds_read_b128 a[84:87], v2 offset:29696
v_mfma_f32_16x16x32_bf16 v[212:215], a[184:187], v[52:55], v[212:215]
v_exp_f32 v65, v65
v_mfma_f32_16x16x32_bf16 v[180:183], a[184:187], v[84:87], v[180:183]
v_cndmask_b32 v40, v4, v24, s[80:81]
v_cndmask_b32 v41, v4, v24, s[82:83]
v_mfma_f32_16x16x32_bf16 v[180:183], a[100:103], v[80:83], v[180:183]
v_exp_f32 v66, v66
v_mfma_f32_16x16x32_bf16 v[184:187], a[104:107], v[80:83], v[184:187]
buffer_load_dwordx2 a[238:239], v248, s[96:99], s53 offen offset:0
v_mfma_f32_16x16x32_bf16 v[184:187], a[188:191], v[84:87], v[184:187]
v_cndmask_b32 v42, v4, v24, s[84:85]
v_cndmask_b32 v43, v4, v24, s[86:87]
v_mfma_f32_16x16x32_bf16 v[216:219], a[188:191], v[52:55], v[216:219]
ds_read_b128 a[88:91], v2 offset:30720
ds_read_b128 a[92:95], v2 offset:31744
v_mfma_f32_16x16x32_bf16 v[216:219], a[104:107], v[48:51], v[216:219]
v_exp_f32 v67, v67
v_mfma_f32_16x16x32_bf16 v[220:223], a[108:111], v[48:51], v[220:223]
v_cndmask_b32 v44, v4, v24, s[88:89]
v_cndmask_b32 v45, v4, v24, s[90:91]
v_mfma_f32_16x16x32_bf16 v[220:223], a[192:195], v[52:55], v[220:223]
v_cvt_pk_bf16_f32 v64, v64, v65
v_cvt_pk_bf16_f32 v65, v66, v67
v_mfma_f32_16x16x32_bf16 v[188:191], a[192:195], v[84:87], v[188:191]
v_cndmask_b32 v46, v4, v24, s[92:93]
v_cndmask_b32 v47, v4, v24, s[94:95]
v_mfma_f32_16x16x32_bf16 v[188:191], a[108:111], v[80:83], v[188:191]
buffer_load_dwordx4 v1, s[32:35], s60 offen offset:2048 sc1 lds
v_mfma_f32_16x16x32_bf16 v[192:195], a[112:115], v[80:83], v[192:195]
v_exp_f32 v72, v72
v_mfma_f32_16x16x32_bf16 v[192:195], a[196:199], v[84:87], v[192:195]
v_mul_u32_u24 v249, 1280, v251
v_lshl_add_u32 v249, v252, 4, v249
v_mfma_f32_16x16x32_bf16 v[224:227], a[196:199], v[52:55], v[224:227]
v_exp_f32 v73, v73
v_mfma_f32_16x16x32_bf16 v[224:227], a[112:115], v[48:51], v[224:227]
v_lshl_add_u32 v240, v250, 6, v249
v_add_u32 v241, 20480, v240
v_mfma_f32_16x16x32_bf16 v[228:231], a[116:119], v[48:51], v[228:231]
v_exp_f32 v74, v74
v_smfmac_f32_16x16x64_bf16 a[140:143], a[212:215], v[48:55], v14
v_add_u32 v242, 10240, v240
v_add_u32 v243, 30720, v240
v_mfma_f32_16x16x32_bf16 v[228:231], a[200:203], v[52:55], v[228:231]
buffer_load_dwordx4 v1, s[32:35], s60 offen offset:3072 sc1 lds
v_mfma_f32_16x16x32_bf16 v[196:199], a[200:203], v[84:87], v[196:199]
s_add_u32 s60, s60, 28672
v_exp_f32 v75, v75
v_mfma_f32_16x16x32_bf16 v[196:199], a[116:119], v[80:83], v[196:199]
s_add_u32 s61, s61, s0
v_mov_b32 v253, 704
v_mul_u32_u24 v253, s8, v253
v_mfma_f32_16x16x32_bf16 v[200:203], a[120:123], v[80:83], v[200:203]
s_and_b32 s61, s61, 0x1ffff
v_cvt_pk_bf16_f32 v72, v72, v73
v_cvt_pk_bf16_f32 v73, v74, v75
v_mfma_f32_16x16x32_bf16 v[200:203], a[204:207], v[84:87], v[200:203]
s_mov_b32 m0, s61
v_and_b32 v253, 0xf80, v253
v_add_u32 v244, v253, v1
v_mfma_f32_16x16x32_bf16 v[232:235], a[204:207], v[52:55], v[232:235]
v_or_b32 v2, s62, v1
v_mfma_f32_16x16x32_bf16 v[232:235], a[120:123], v[48:51], v[232:235]
v_exp_f32 v68, v68
v_smfmac_f32_16x16x64_bf16 a[136:139], a[212:215], v[80:87], v14
v_and_b32 v13, 3, v0
v_lshlrev_b32 v13, 7, v13
v_mfma_f32_16x16x32_bf16 v[236:239], a[124:127], v[48:51], v[236:239]
v_exp_f32 v69, v69
v_mfma_f32_16x16x32_bf16 v[236:239], a[208:211], v[52:55], v[236:239]
v_mov_b32 v5, 163824
v_mfma_f32_16x16x32_bf16 v[204:207], a[208:211], v[84:87], v[204:207]
s_cmp_eq_u32 s3, 7
s_cbranch_scc1 Lt32n
Lt32r:
v_mfma_f32_16x16x32_bf16 v[204:207], a[124:127], v[80:83], v[204:207]
s_add_u32 s96, s28, 0x5000000
s_addc_u32 s97, s29, 0
s_mov_b32 s98, 0x21c000
s_mov_b32 s99, 0x20000
s_lshl_b32 s63, s3, 2
s_sub_u32 s63, 28, s63
v_accvgpr_read_b32 v8, a128
v_accvgpr_read_b32 v10, a132
v_accvgpr_read_b32 v9, a129
v_accvgpr_read_b32 v11, a133
v_add_f32 v8, v8, v9
v_add_f32 v10, v10, v11
s_mov_b32 s52, 0x53800000
v_min_f32 v6, v8, v10
v_add_f32 v7, v8, v10
v_cmp_nle_f32 vcc, 0x30800000, v6
v_cmp_nge_f32 s[54:55], s52, v7
v_rcp_f32 v8, v8
v_rcp_f32 v10, v10
s_or_b64 vcc, vcc, s[54:55]
s_cselect_b32 s27, 1, s27
v_pk_mul_f32 v[112:113], v[112:113], v[8:9] op_sel_hi:[1,0]
v_pk_mul_f32 v[114:115], v[114:115], v[8:9] op_sel_hi:[1,0]
v_pk_mul_f32 v[116:117], v[116:117], v[8:9] op_sel_hi:[1,0]
v_pk_mul_f32 v[118:119], v[118:119], v[8:9] op_sel_hi:[1,0]
s_add_u32 s52, s58, 0
v_cvt_pk_bf16_f32 v112, v112, v113
v_cvt_pk_bf16_f32 v113, v114, v115
v_cvt_pk_bf16_f32 v114, v116, v117
v_cvt_pk_bf16_f32 v115, v118, v119
buffer_store_dwordx4 v[112:115], v1, s[40:43], s52 offen sc1
v_pk_mul_f32 v[120:121], v[120:121], v[8:9] op_sel_hi:[1,0]
v_pk_mul_f32 v[122:123], v[122:123], v[8:9] op_sel_hi:[1,0]
v_pk_mul_f32 v[124:125], v[124:125], v[8:9] op_sel_hi:[1,0]
v_pk_mul_f32 v[126:127], v[126:127], v[8:9] op_sel_hi:[1,0]
s_add_u32 s52, s58, 8192
v_cvt_pk_bf16_f32 v120, v120, v121
v_cvt_pk_bf16_f32 v121, v122, v123
v_cvt_pk_bf16_f32 v122, v124, v125
v_cvt_pk_bf16_f32 v123, v126, v127
buffer_store_dwordx4 v[120:123], v1, s[40:43], s52 offen sc1
v_pk_mul_f32 v[128:129], v[128:129], v[8:9] op_sel_hi:[1,0]
v_pk_mul_f32 v[130:131], v[130:131], v[8:9] op_sel_hi:[1,0]
v_pk_mul_f32 v[132:133], v[132:133], v[8:9] op_sel_hi:[1,0]
v_pk_mul_f32 v[134:135], v[134:135], v[8:9] op_sel_hi:[1,0]
s_add_u32 s52, s58, 16384
v_cvt_pk_bf16_f32 v128, v128, v129
v_cvt_pk_bf16_f32 v129, v130, v131
v_cvt_pk_bf16_f32 v130, v132, v133
v_cvt_pk_bf16_f32 v131, v134, v135
buffer_store_dwordx4 v[128:131], v1, s[40:43], s52 offen sc1
v_pk_mul_f32 v[136:137], v[136:137], v[8:9] op_sel_hi:[1,0]
v_pk_mul_f32 v[138:139], v[138:139], v[8:9] op_sel_hi:[1,0]
v_pk_mul_f32 v[140:141], v[140:141], v[8:9] op_sel_hi:[1,0]
v_pk_mul_f32 v[142:143], v[142:143], v[8:9] op_sel_hi:[1,0]
s_add_u32 s52, s58, 24576
v_cvt_pk_bf16_f32 v136, v136, v137
v_cvt_pk_bf16_f32 v137, v138, v139
v_cvt_pk_bf16_f32 v138, v140, v141
v_cvt_pk_bf16_f32 v139, v142, v143
buffer_store_dwordx4 v[136:139], v1, s[40:43], s52 offen sc1
v_pk_mul_f32 v[144:145], v[144:145], v[10:11] op_sel_hi:[1,0]
v_pk_mul_f32 v[146:147], v[146:147], v[10:11] op_sel_hi:[1,0]
v_pk_mul_f32 v[148:149], v[148:149], v[10:11] op_sel_hi:[1,0]
v_pk_mul_f32 v[150:151], v[150:151], v[10:11] op_sel_hi:[1,0]
s_add_u32 s52, s58, 4096
v_cvt_pk_bf16_f32 v144, v144, v145
v_cvt_pk_bf16_f32 v145, v146, v147
v_cvt_pk_bf16_f32 v146, v148, v149
v_cvt_pk_bf16_f32 v147, v150, v151
buffer_store_dwordx4 v[144:147], v1, s[40:43], s52 offen sc1
v_pk_mul_f32 v[152:153], v[152:153], v[10:11] op_sel_hi:[1,0]
v_pk_mul_f32 v[154:155], v[154:155], v[10:11] op_sel_hi:[1,0]
v_pk_mul_f32 v[156:157], v[156:157], v[10:11] op_sel_hi:[1,0]
v_pk_mul_f32 v[158:159], v[158:159], v[10:11] op_sel_hi:[1,0]
s_add_u32 s52, s58, 12288
v_cvt_pk_bf16_f32 v152, v152, v153
v_cvt_pk_bf16_f32 v153, v154, v155
v_cvt_pk_bf16_f32 v154, v156, v157
v_cvt_pk_bf16_f32 v155, v158, v159
buffer_store_dwordx4 v[152:155], v1, s[40:43], s52 offen sc1
v_pk_mul_f32 v[160:161], v[160:161], v[10:11] op_sel_hi:[1,0]
v_pk_mul_f32 v[162:163], v[162:163], v[10:11] op_sel_hi:[1,0]
v_pk_mul_f32 v[164:165], v[164:165], v[10:11] op_sel_hi:[1,0]
v_pk_mul_f32 v[166:167], v[166:167], v[10:11] op_sel_hi:[1,0]
s_add_u32 s52, s58, 20480
v_cvt_pk_bf16_f32 v160, v160, v161
v_cvt_pk_bf16_f32 v161, v162, v163
v_cvt_pk_bf16_f32 v162, v164, v165
v_cvt_pk_bf16_f32 v163, v166, v167
buffer_store_dwordx4 v[160:163], v1, s[40:43], s52 offen sc1
v_pk_mul_f32 v[168:169], v[168:169], v[10:11] op_sel_hi:[1,0]
v_pk_mul_f32 v[170:171], v[170:171], v[10:11] op_sel_hi:[1,0]
v_pk_mul_f32 v[172:173], v[172:173], v[10:11] op_sel_hi:[1,0]
v_pk_mul_f32 v[174:175], v[174:175], v[10:11] op_sel_hi:[1,0]
s_add_u32 s52, s58, 28672
v_cvt_pk_bf16_f32 v168, v168, v169
v_cvt_pk_bf16_f32 v169, v170, v171
v_cvt_pk_bf16_f32 v170, v172, v173
v_cvt_pk_bf16_f32 v171, v174, v175
buffer_store_dwordx4 v[168:171], v1, s[40:43], s52 offen sc1
s_or_b32 s52, s3, s30
v_mov_b32 v8, 1
s_waitcnt vmcnt(30) lgkmcnt(0)
s_barrier
s_cbranch_scc1 Lpg_np
s_mov_b64 exec, 1
buffer_store_dword v8, off, s[48:51], s17 offset:1024 sc1
s_mov_b64 exec, -1
Lpg_np:
s_cmp_eq_u32 s63, 0
s_cbranch_scc1 Lt21m
.p2align 6
Lt22:
v_mfma_f32_16x16x32_bf16 v[96:99], a[64:67], a[32:35], v[24:27]
ds_read_b128 a[148:151], v2 offset:16384
ds_read_b128 a[152:155], v2 offset:17408
v_mfma_f32_16x16x32_bf16 v[96:99], a[68:71], a[36:39], v[96:99]
buffer_load_dwordx4 v1, s[32:35], s60 offen offset:0 sc1 lds
v_mfma_f32_16x16x32_bf16 v[96:99], a[72:75], a[40:43], v[96:99]
ds_read_b128 a[156:159], v2 offset:18432
ds_read_b128 a[160:163], v2 offset:19456
v_mfma_f32_16x16x32_bf16 v[96:99], a[76:79], a[44:47], v[96:99]
ds_read_b128 a[164:167], v2 offset:20480
ds_read_b128 a[168:171], v2 offset:21504
v_mfma_f32_16x16x32_bf16 v[104:107], a[76:79], a[60:63], v[28:31]
buffer_load_dwordx4 v1, s[32:35], s60 offen offset:1024 sc1 lds
v_mfma_f32_16x16x32_bf16 v[104:107], a[72:75], a[56:59], v[104:107]
ds_read_b128 a[172:175], v2 offset:22528
ds_read_b128 a[176:179], v2 offset:23552
v_mfma_f32_16x16x32_bf16 v[104:107], a[68:71], a[52:55], v[104:107]
ds_read_b128 a[96:99], v2 offset:0
ds_read_b128 a[180:183], v2 offset:8192
v_mfma_f32_16x16x32_bf16 v[104:107], a[64:67], a[48:51], v[104:107]
v_exp_f32 v76, v76
v_mfma_f32_16x16x32_bf16 v[108:111], a[80:83], a[48:51], v[28:31]
v_exp_f32 v77, v77
v_mfma_f32_16x16x32_bf16 v[108:111], a[84:87], a[52:55], v[108:111]
v_exp_f32 v78, v78
v_mfma_f32_16x16x32_bf16 v[108:111], a[88:91], a[56:59], v[108:111]
ds_read_b128 a[100:103], v2 offset:1024
ds_read_b128 a[184:187], v2 offset:9216
v_mfma_f32_16x16x32_bf16 v[108:111], a[92:95], a[60:63], v[108:111]
v_exp_f32 v79, v79
v_mfma_f32_16x16x32_bf16 v[100:103], a[92:95], a[44:47], v[24:27]
buffer_load_dwordx4 v1, s[32:35], s60 offen offset:2048 sc1 lds
v_mfma_f32_16x16x32_bf16 v[100:103], a[88:91], a[40:43], v[100:103]
v_cvt_pk_bf16_f32 v74, v76, v77
v_cvt_pk_bf16_f32 v75, v78, v79
v_mfma_f32_16x16x32_bf16 v[100:103], a[84:87], a[36:39], v[100:103]
s_waitcnt lgkmcnt(2)
v_exp_f32 v104, v104
v_mfma_f32_16x16x32_bf16 v[100:103], a[80:83], a[32:35], v[100:103]
ds_read_b128 a[104:107], v2 offset:2048
ds_read_b128 a[188:191], v2 offset:10240
v_mfma_f32_16x16x32_bf16 v[48:51], a[148:151], a[32:35], v[32:35]
v_exp_f32 v105, v105
v_mfma_f32_16x16x32_bf16 v[48:51], a[152:155], a[36:39], v[48:51]
v_exp_f32 v106, v106
v_mfma_f32_16x16x32_bf16 v[48:51], a[156:159], a[40:43], v[48:51]
v_exp_f32 v107, v107
v_mfma_f32_16x16x32_bf16 v[48:51], a[160:163], a[44:47], v[48:51]
buffer_load_dwordx4 v1, s[32:35], s60 offen offset:3072 sc1 lds
v_mfma_f32_16x16x32_bf16 v[56:59], a[160:163], a[60:63], v[28:31]
s_add_u32 s60, s60, 4096
v_cvt_pk_bf16_f32 v76, v104, v105
v_cvt_pk_bf16_f32 v77, v106, v107
v_mfma_f32_16x16x32_bf16 v[56:59], a[156:159], a[56:59], v[56:59]
s_add_u32 m0, s61, 4096
v_exp_f32 v108, v108
v_mfma_f32_16x16x32_bf16 v[56:59], a[152:155], a[52:55], v[56:59]
v_exp_f32 v109, v109
v_mfma_f32_16x16x32_bf16 v[56:59], a[148:151], a[48:51], v[56:59]
ds_read_b128 a[108:111], v2 offset:3072
ds_read_b128 a[192:195], v2 offset:11264
v_mfma_f32_16x16x32_bf16 v[60:63], a[164:167], a[48:51], v[28:31]
v_exp_f32 v110, v110
v_mfma_f32_16x16x32_bf16 v[60:63], a[168:171], a[52:55], v[60:63]
v_exp_f32 v111, v111
v_mfma_f32_16x16x32_bf16 v[60:63], a[172:175], a[56:59], v[60:63]
ds_read_b128 a[112:115], v2 offset:4096
ds_read_b128 a[196:199], v2 offset:12288
v_mfma_f32_16x16x32_bf16 v[60:63], a[176:179], a[60:63], v[60:63]
v_cvt_pk_bf16_f32 v78, v108, v109
v_cvt_pk_bf16_f32 v79, v110, v111
v_mfma_f32_16x16x32_bf16 v[52:55], a[176:179], a[44:47], v[36:39]
v_exp_f32 v70, v70
v_mfma_f32_16x16x32_bf16 v[52:55], a[172:175], a[40:43], v[52:55]
v_exp_f32 v71, v71
v_mfma_f32_16x16x32_bf16 v[52:55], a[168:171], a[36:39], v[52:55]
ds_read_b128 a[116:119], v2 offset:5120
ds_read_b128 a[200:203], v2 offset:13312
v_mfma_f32_16x16x32_bf16 v[52:55], a[164:167], a[32:35], v[52:55]
v_cvt_pk_bf16_f32 v66, v68, v69
v_cvt_pk_bf16_f32 v67, v70, v71
v_mfma_f32_16x16x32_bf16 v[208:211], a[96:99], v[72:75], v[208:211]
buffer_load_dwordx4 v1, s[32:35], s60 offen offset:0 sc1 lds
v_mfma_f32_16x16x32_bf16 v[208:211], a[180:183], v[76:79], v[208:211]
s_waitcnt lgkmcnt(2)
v_exp_f32 v96, v96
v_mfma_f32_16x16x32_bf16 v[212:215], a[184:187], v[76:79], v[212:215]
ds_read_b128 a[120:123], v2 offset:6144
ds_read_b128 a[204:207], v2 offset:14336
v_mfma_f32_16x16x32_bf16 v[212:215], a[100:103], v[72:75], v[212:215]
v_exp_f32 v97, v97
v_mfma_f32_16x16x32_bf16 v[216:219], a[104:107], v[72:75], v[216:219]
v_exp_f32 v98, v98
v_mfma_f32_16x16x32_bf16 v[216:219], a[188:191], v[76:79], v[216:219]
ds_read_b128 a[124:127], v2 offset:7168
ds_read_b128 a[208:211], v2 offset:15360
v_mfma_f32_16x16x32_bf16 v[220:223], a[192:195], v[76:79], v[220:223]
v_exp_f32 v99, v99
v_mfma_f32_16x16x32_bf16 v[220:223], a[108:111], v[72:75], v[220:223]
v_cvt_pk_bf16_f32 v68, v96, v97
v_cvt_pk_bf16_f32 v69, v98, v99
v_mfma_f32_16x16x32_bf16 v[224:227], a[112:115], v[72:75], v[224:227]
s_waitcnt lgkmcnt(4)
v_exp_f32 v100, v100
v_mfma_f32_16x16x32_bf16 v[224:227], a[196:199], v[76:79], v[224:227]
buffer_load_dwordx4 v1, s[32:35], s60 offen offset:1024 sc1 lds
v_mfma_f32_16x16x32_bf16 v[228:231], a[200:203], v[76:79], v[228:231]
s_add_u32 s62, s62, s0
v_exp_f32 v101, v101
v_mfma_f32_16x16x32_bf16 v[228:231], a[116:119], v[72:75], v[228:231]
s_waitcnt lgkmcnt(2)
v_exp_f32 v102, v102
v_smfmac_f32_16x16x64_bf16 a[140:143], a[212:215], v[72:79], v14
ds_read_b128 a[64:67], v2 offset:24576
ds_read_b128 a[68:71], v2 offset:25600
v_mfma_f32_16x16x32_bf16 v[232:235], a[120:123], v[72:75], v[232:235]
s_and_b32 s62, s62, 0x18000
v_exp_f32 v103, v103
v_mfma_f32_16x16x32_bf16 v[232:235], a[204:207], v[76:79], v[232:235]
s_waitcnt lgkmcnt(2)
v_cvt_pk_bf16_f32 v70, v100, v101
v_cvt_pk_bf16_f32 v71, v102, v103
v_mfma_f32_16x16x32_bf16 v[236:239], a[208:211], v[76:79], v[236:239]
v_exp_f32 v48, v48
v_mfma_f32_16x16x32_bf16 v[236:239], a[124:127], v[72:75], v[236:239]
ds_read_b128 a[72:75], v2 offset:26624
ds_read_b128 a[76:79], v2 offset:27648
v_mfma_f32_16x16x32_bf16 v[204:207], a[124:127], v[64:67], v[204:207]
v_exp_f32 v49, v49
v_mfma_f32_16x16x32_bf16 v[204:207], a[208:211], v[68:71], v[204:207]
v_exp_f32 v50, v50
v_mfma_f32_16x16x32_bf16 v[200:203], a[204:207], v[68:71], v[200:203]
buffer_load_dwordx4 v1, s[32:35], s60 offen offset:2048 sc1 lds
v_mfma_f32_16x16x32_bf16 v[200:203], a[120:123], v[64:67], v[200:203]
v_exp_f32 v51, v51
v_mfma_f32_16x16x32_bf16 v[196:199], a[116:119], v[64:67], v[196:199]
v_cvt_pk_bf16_f32 v48, v48, v49
v_cvt_pk_bf16_f32 v49, v50, v51
v_mfma_f32_16x16x32_bf16 v[196:199], a[200:203], v[68:71], v[196:199]
ds_read_b128 a[80:83], v2 offset:28672
ds_read_b128 a[84:87], v2 offset:29696
v_mfma_f32_16x16x32_bf16 v[192:195], a[196:199], v[68:71], v[192:195]
v_exp_f32 v56, v56
v_mfma_f32_16x16x32_bf16 v[192:195], a[112:115], v[64:67], v[192:195]
v_exp_f32 v57, v57
v_mfma_f32_16x16x32_bf16 v[188:191], a[108:111], v[64:67], v[188:191]
ds_read_b128 a[88:91], v2 offset:30720
ds_read_b128 a[92:95], v2 offset:31744
v_mfma_f32_16x16x32_bf16 v[188:191], a[192:195], v[68:71], v[188:191]
v_exp_f32 v58, v58
v_mfma_f32_16x16x32_bf16 v[184:187], a[188:191], v[68:71], v[184:187]
buffer_load_dwordx4 v1, s[32:35], s60 offen offset:3072 sc1 lds
v_mfma_f32_16x16x32_bf16 v[184:187], a[104:107], v[64:67], v[184:187]
s_add_u32 s60, s60, 28672
v_exp_f32 v59, v59
v_smfmac_f32_16x16x64_bf16 a[136:139], a[212:215], v[64:71], v14
s_add_u32 s61, s61, s0
v_or_b32 v2, s62, v1
v_mfma_f32_16x16x32_bf16 v[180:183], a[100:103], v[64:67], v[180:183]
s_and_b32 s61, s61, 0x1ffff
v_cvt_pk_bf16_f32 v56, v56, v57
v_cvt_pk_bf16_f32 v57, v58, v59
v_mfma_f32_16x16x32_bf16 v[180:183], a[184:187], v[68:71], v[180:183]
s_mov_b32 m0, s61
v_exp_f32 v52, v52
v_mfma_f32_16x16x32_bf16 v[176:179], a[180:183], v[68:71], v[176:179]
v_exp_f32 v53, v53
v_mfma_f32_16x16x32_bf16 v[176:179], a[96:99], v[64:67], v[176:179]
s_waitcnt vmcnt(16) lgkmcnt(0)
s_barrier
v_mfma_f32_16x16x32_bf16 v[96:99], a[64:67], a[32:35], v[24:27]
ds_read_b128 a[148:151], v2 offset:16384
ds_read_b128 a[152:155], v2 offset:17408
v_mfma_f32_16x16x32_bf16 v[96:99], a[68:71], a[36:39], v[96:99]
buffer_load_dwordx4 v1, s[32:35], s60 offen offset:0 sc1 lds
v_mfma_f32_16x16x32_bf16 v[96:99], a[72:75], a[40:43], v[96:99]
ds_read_b128 a[156:159], v2 offset:18432
ds_read_b128 a[160:163], v2 offset:19456
v_mfma_f32_16x16x32_bf16 v[96:99], a[76:79], a[44:47], v[96:99]
ds_read_b128 a[164:167], v2 offset:20480
ds_read_b128 a[168:171], v2 offset:21504
v_mfma_f32_16x16x32_bf16 v[104:107], a[76:79], a[60:63], v[28:31]
buffer_load_dwordx4 v1, s[32:35], s60 offen offset:1024 sc1 lds
v_mfma_f32_16x16x32_bf16 v[104:107], a[72:75], a[56:59], v[104:107]
ds_read_b128 a[172:175], v2 offset:22528
ds_read_b128 a[176:179], v2 offset:23552
v_mfma_f32_16x16x32_bf16 v[104:107], a[68:71], a[52:55], v[104:107]
ds_read_b128 a[96:99], v2 offset:0
ds_read_b128 a[180:183], v2 offset:8192
v_mfma_f32_16x16x32_bf16 v[104:107], a[64:67], a[48:51], v[104:107]
s_sub_u32 s63, s63, 2
v_exp_f32 v60, v60
v_mfma_f32_16x16x32_bf16 v[108:111], a[80:83], a[48:51], v[28:31]
s_cmp_eq_u32 s63, 0
v_exp_f32 v61, v61
v_mfma_f32_16x16x32_bf16 v[108:111], a[84:87], a[52:55], v[108:111]
s_cbranch_scc1 Lt22_m
Lt22_r:
v_exp_f32 v62, v62
v_mfma_f32_16x16x32_bf16 v[108:111], a[88:91], a[56:59], v[108:111]
ds_read_b128 a[100:103], v2 offset:1024
ds_read_b128 a[184:187], v2 offset:9216
v_mfma_f32_16x16x32_bf16 v[108:111], a[92:95], a[60:63], v[108:111]
v_exp_f32 v63, v63
v_mfma_f32_16x16x32_bf16 v[100:103], a[92:95], a[44:47], v[24:27]
buffer_load_dwordx4 v1, s[32:35], s60 offen offset:2048 sc1 lds
v_mfma_f32_16x16x32_bf16 v[100:103], a[88:91], a[40:43], v[100:103]
v_cvt_pk_bf16_f32 v58, v60, v61
v_cvt_pk_bf16_f32 v59, v62, v63
v_mfma_f32_16x16x32_bf16 v[100:103], a[84:87], a[36:39], v[100:103]
s_waitcnt lgkmcnt(2)
v_exp_f32 v104, v104
v_mfma_f32_16x16x32_bf16 v[100:103], a[80:83], a[32:35], v[100:103]
ds_read_b128 a[104:107], v2 offset:2048
ds_read_b128 a[188:191], v2 offset:10240
v_mfma_f32_16x16x32_bf16 v[64:67], a[148:151], a[32:35], v[32:35]
v_exp_f32 v105, v105
v_mfma_f32_16x16x32_bf16 v[64:67], a[152:155], a[36:39], v[64:67]
v_exp_f32 v106, v106
v_mfma_f32_16x16x32_bf16 v[64:67], a[156:159], a[40:43], v[64:67]
v_exp_f32 v107, v107
v_mfma_f32_16x16x32_bf16 v[64:67], a[160:163], a[44:47], v[64:67]
buffer_load_dwordx4 v1, s[32:35], s60 offen offset:3072 sc1 lds
v_mfma_f32_16x16x32_bf16 v[72:75], a[160:163], a[60:63], v[28:31]
s_add_u32 s60, s60, 4096
v_cvt_pk_bf16_f32 v60, v104, v105
v_cvt_pk_bf16_f32 v61, v106, v107
v_mfma_f32_16x16x32_bf16 v[72:75], a[156:159], a[56:59], v[72:75]
s_add_u32 m0, s61, 4096
v_exp_f32 v108, v108
v_mfma_f32_16x16x32_bf16 v[72:75], a[152:155], a[52:55], v[72:75]
v_exp_f32 v109, v109
v_mfma_f32_16x16x32_bf16 v[72:75], a[148:151], a[48:51], v[72:75]
ds_read_b128 a[108:111], v2 offset:3072
ds_read_b128 a[192:195], v2 offset:11264
v_mfma_f32_16x16x32_bf16 v[76:79], a[164:167], a[48:51], v[28:31]
v_exp_f32 v110, v110
v_mfma_f32_16x16x32_bf16 v[76:79], a[168:171], a[52:55], v[76:79]
v_exp_f32 v111, v111
v_mfma_f32_16x16x32_bf16 v[76:79], a[172:175], a[56:59], v[76:79]
ds_read_b128 a[112:115], v2 offset:4096
ds_read_b128 a[196:199], v2 offset:12288
v_mfma_f32_16x16x32_bf16 v[76:79], a[176:179], a[60:63], v[76:79]
v_cvt_pk_bf16_f32 v62, v108, v109
v_cvt_pk_bf16_f32 v63, v110, v111
v_mfma_f32_16x16x32_bf16 v[68:71], a[176:179], a[44:47], v[36:39]
v_exp_f32 v54, v54
v_mfma_f32_16x16x32_bf16 v[68:71], a[172:175], a[40:43], v[68:71]
v_exp_f32 v55, v55
v_mfma_f32_16x16x32_bf16 v[68:71], a[168:171], a[36:39], v[68:71]
ds_read_b128 a[116:119], v2 offset:5120
ds_read_b128 a[200:203], v2 offset:13312
v_mfma_f32_16x16x32_bf16 v[68:71], a[164:167], a[32:35], v[68:71]
v_cvt_pk_bf16_f32 v50, v52, v53
v_cvt_pk_bf16_f32 v51, v54, v55
v_mfma_f32_16x16x32_bf16 v[208:211], a[96:99], v[56:59], v[208:211]
buffer_load_dwordx4 v1, s[32:35], s60 offen offset:0 sc1 lds
v_mfma_f32_16x16x32_bf16 v[208:211], a[180:183], v[60:63], v[208:211]
s_waitcnt lgkmcnt(2)
v_exp_f32 v96, v96
v_mfma_f32_16x16x32_bf16 v[212:215], a[184:187], v[60:63], v[212:215]
ds_read_b128 a[120:123], v2 offset:6144
ds_read_b128 a[204:207], v2 offset:14336
v_mfma_f32_16x16x32_bf16 v[212:215], a[100:103], v[56:59], v[212:215]
v_exp_f32 v97, v97
v_mfma_f32_16x16x32_bf16 v[216:219], a[104:107], v[56:59], v[216:219]
v_exp_f32 v98, v98
v_mfma_f32_16x16x32_bf16 v[216:219], a[188:191], v[60:63], v[216:219]
ds_read_b128 a[124:127], v2 offset:7168
ds_read_b128 a[208:211], v2 offset:15360
v_mfma_f32_16x16x32_bf16 v[220:223], a[192:195], v[60:63], v[220:223]
v_exp_f32 v99, v99
v_mfma_f32_16x16x32_bf16 v[220:223], a[108:111], v[56:59], v[220:223]
v_cvt_pk_bf16_f32 v52, v96, v97
v_cvt_pk_bf16_f32 v53, v98, v99
v_mfma_f32_16x16x32_bf16 v[224:227], a[112:115], v[56:59], v[224:227]
s_waitcnt lgkmcnt(4)
v_exp_f32 v100, v100
v_mfma_f32_16x16x32_bf16 v[224:227], a[196:199], v[60:63], v[224:227]
buffer_load_dwordx4 v1, s[32:35], s60 offen offset:1024 sc1 lds
v_mfma_f32_16x16x32_bf16 v[228:231], a[200:203], v[60:63], v[228:231]
s_add_u32 s62, s62, s0
v_exp_f32 v101, v101
v_mfma_f32_16x16x32_bf16 v[228:231], a[116:119], v[56:59], v[228:231]
s_waitcnt lgkmcnt(2)
v_exp_f32 v102, v102
v_smfmac_f32_16x16x64_bf16 a[140:143], a[212:215], v[56:63], v14
ds_read_b128 a[64:67], v2 offset:24576
ds_read_b128 a[68:71], v2 offset:25600
v_mfma_f32_16x16x32_bf16 v[232:235], a[120:123], v[56:59], v[232:235]
s_and_b32 s62, s62, 0x18000
v_exp_f32 v103, v103
v_mfma_f32_16x16x32_bf16 v[232:235], a[204:207], v[60:63], v[232:235]
s_waitcnt lgkmcnt(2)
v_cvt_pk_bf16_f32 v54, v100, v101
v_cvt_pk_bf16_f32 v55, v102, v103
v_mfma_f32_16x16x32_bf16 v[236:239], a[208:211], v[60:63], v[236:239]
v_exp_f32 v64, v64
v_mfma_f32_16x16x32_bf16 v[236:239], a[124:127], v[56:59], v[236:239]
ds_read_b128 a[72:75], v2 offset:26624
ds_read_b128 a[76:79], v2 offset:27648
v_mfma_f32_16x16x32_bf16 v[204:207], a[124:127], v[48:51], v[204:207]
v_exp_f32 v65, v65
v_mfma_f32_16x16x32_bf16 v[204:207], a[208:211], v[52:55], v[204:207]
v_exp_f32 v66, v66
v_mfma_f32_16x16x32_bf16 v[200:203], a[204:207], v[52:55], v[200:203]
buffer_load_dwordx4 v1, s[32:35], s60 offen offset:2048 sc1 lds
v_mfma_f32_16x16x32_bf16 v[200:203], a[120:123], v[48:51], v[200:203]
v_exp_f32 v67, v67
v_mfma_f32_16x16x32_bf16 v[196:199], a[116:119], v[48:51], v[196:199]
v_cvt_pk_bf16_f32 v64, v64, v65
v_cvt_pk_bf16_f32 v65, v66, v67
v_mfma_f32_16x16x32_bf16 v[196:199], a[200:203], v[52:55], v[196:199]
ds_read_b128 a[80:83], v2 offset:28672
ds_read_b128 a[84:87], v2 offset:29696
v_mfma_f32_16x16x32_bf16 v[192:195], a[196:199], v[52:55], v[192:195]
v_exp_f32 v72, v72
v_mfma_f32_16x16x32_bf16 v[192:195], a[112:115], v[48:51], v[192:195]
v_exp_f32 v73, v73
v_mfma_f32_16x16x32_bf16 v[188:191], a[108:111], v[48:51], v[188:191]
ds_read_b128 a[88:91], v2 offset:30720
ds_read_b128 a[92:95], v2 offset:31744
v_mfma_f32_16x16x32_bf16 v[188:191], a[192:195], v[52:55], v[188:191]
v_exp_f32 v74, v74
v_mfma_f32_16x16x32_bf16 v[184:187], a[188:191], v[52:55], v[184:187]
buffer_load_dwordx4 v1, s[32:35], s60 offen offset:3072 sc1 lds
v_mfma_f32_16x16x32_bf16 v[184:187], a[104:107], v[48:51], v[184:187]
s_add_u32 s60, s60, 28672
v_exp_f32 v75, v75
v_smfmac_f32_16x16x64_bf16 a[136:139], a[212:215], v[48:55], v14
s_add_u32 s61, s61, s0
v_or_b32 v2, s62, v1
v_mfma_f32_16x16x32_bf16 v[180:183], a[100:103], v[48:51], v[180:183]
s_and_b32 s61, s61, 0x1ffff
v_cvt_pk_bf16_f32 v72, v72, v73
v_cvt_pk_bf16_f32 v73, v74, v75
v_mfma_f32_16x16x32_bf16 v[180:183], a[184:187], v[52:55], v[180:183]
s_mov_b32 m0, s61
v_exp_f32 v68, v68
v_mfma_f32_16x16x32_bf16 v[176:179], a[180:183], v[52:55], v[176:179]
s_cmp_lg_u32 s63, 0
v_exp_f32 v69, v69
v_mfma_f32_16x16x32_bf16 v[176:179], a[96:99], v[48:51], v[176:179]
s_waitcnt vmcnt(16) lgkmcnt(0)
s_barrier
s_cbranch_scc1 Lt22
s_waitcnt vmcnt(6)
Lt21:
v_and_b32 v88, v88, v89
v_and_b32 v88, v88, v90
v_and_b32 v88, v88, v91
v_cmp_gt_u32 vcc, 1, v88
s_mov_b32 s55, 0x200000
s_nop 0
s_cbranch_vccnz Lfh_ld
Lfh_ok:
v_mfma_f32_16x16x32_bf16 v[96:99], a[64:67], a[32:35], v[40:43]
s_add_u32 m0, s11, 0
ds_read_b128 a[96:99], v2 offset:0
ds_read_b128 a[100:103], v2 offset:1024
v_mfma_f32_16x16x32_bf16 v[96:99], a[68:71], a[36:39], v[96:99]
buffer_load_dwordx4 v240, s[44:47], s10 offen lds
v_mfma_f32_16x16x32_bf16 v[96:99], a[72:75], a[40:43], v[96:99]
s_add_u32 m0, s11, 1024
ds_read_b128 a[104:107], v2 offset:2048
ds_read_b128 a[108:111], v2 offset:3072
v_mfma_f32_16x16x32_bf16 v[96:99], a[76:79], a[44:47], v[96:99]
buffer_load_dwordx4 v241, s[44:47], s10 offen lds
v_mfma_f32_16x16x32_bf16 v[104:107], a[76:79], a[60:63], v[28:31]
s_add_u32 m0, s11, 2048
ds_read_b128 a[112:115], v2 offset:4096
ds_read_b128 a[116:119], v2 offset:5120
v_mfma_f32_16x16x32_bf16 v[104:107], a[72:75], a[56:59], v[104:107]
buffer_load_dwordx4 v242, s[44:47], s10 offen lds
s_add_u32 m0, s11, 3072
v_mfma_f32_16x16x32_bf16 v[104:107], a[68:71], a[52:55], v[104:107]
buffer_load_dwordx4 v243, s[44:47], s10 offen lds
v_mfma_f32_16x16x32_bf16 v[104:107], a[64:67], a[48:51], v[104:107]
s_add_u32 m0, s11, 4096
ds_read_b128 a[120:123], v2 offset:6144
ds_read_b128 a[124:127], v2 offset:7168
v_mfma_f32_16x16x32_bf16 v[108:111], a[80:83], a[48:51], v[28:31]
buffer_load_dwordx4 v244, s[96:99], s10 offen sc1 lds
v_mfma_f32_16x16x32_bf16 v[108:111], a[84:87], a[52:55], v[108:111]
v_exp_f32 v70, v70
v_exp_f32 v71, v71
v_mfma_f32_16x16x32_bf16 v[108:111], a[88:91], a[56:59], v[108:111]
v_cvt_pk_bf16_f32 v66, v68, v69
v_cvt_pk_bf16_f32 v67, v70, v71
v_mfma_f32_16x16x32_bf16 v[108:111], a[92:95], a[60:63], v[108:111]
v_exp_f32 v76, v76
v_mfma_f32_16x16x32_bf16 v[100:103], a[92:95], a[44:47], v[44:47]
v_exp_f32 v77, v77
v_mfma_f32_16x16x32_bf16 v[100:103], a[88:91], a[40:43], v[100:103]
v_exp_f32 v78, v78
v_mfma_f32_16x16x32_bf16 v[100:103], a[84:87], a[36:39], v[100:103]
v_exp_f32 v79, v79
v_mfma_f32_16x16x32_bf16 v[100:103], a[80:83], a[32:35], v[100:103]
v_cvt_pk_bf16_f32 v74, v76, v77
v_cvt_pk_bf16_f32 v75, v78, v79
s_nop 0
s_waitcnt lgkmcnt(0)
v_mfma_f32_16x16x32_bf16 v[176:179], a[96:99], v[64:67], v[176:179]
ds_read_b128 a[64:67], v2 offset:16384
ds_read_b128 a[68:71], v2 offset:17408
v_exp_f32 v96, v96
v_mfma_f32_16x16x32_bf16 v[208:211], a[96:99], v[72:75], v[208:211]
v_cndmask_b32 v32, v4, v28, s[64:65]
v_cndmask_b32 v33, v4, v28, s[66:67]
v_mfma_f32_16x16x32_bf16 v[212:215], a[100:103], v[72:75], v[212:215]
v_exp_f32 v97, v97
v_mfma_f32_16x16x32_bf16 v[180:183], a[100:103], v[64:67], v[180:183]
ds_read_b128 a[72:75], v2 offset:18432
ds_read_b128 a[76:79], v2 offset:19456
v_mfma_f32_16x16x32_bf16 v[184:187], a[104:107], v[64:67], v[184:187]
v_exp_f32 v98, v98
v_mfma_f32_16x16x32_bf16 v[216:219], a[104:107], v[72:75], v[216:219]
s_add_u32 m0, s11, s18
v_cndmask_b32 v34, v4, v28, s[68:69]
v_cndmask_b32 v35, v4, v28, s[70:71]
v_mfma_f32_16x16x32_bf16 v[220:223], a[108:111], v[72:75], v[220:223]
v_exp_f32 v99, v99
buffer_load_dwordx4 v1, s[36:39], s9 offen offset:0 sc1 lds
v_mfma_f32_16x16x32_bf16 v[188:191], a[108:111], v[64:67], v[188:191]
ds_read_b128 a[80:83], v2 offset:20480
ds_read_b128 a[84:87], v2 offset:21504
v_mfma_f32_16x16x32_bf16 v[192:195], a[112:115], v[64:67], v[192:195]
v_cvt_pk_bf16_f32 v96, v96, v97
v_cvt_pk_bf16_f32 v97, v98, v99
v_mfma_f32_16x16x32_bf16 v[224:227], a[112:115], v[72:75], v[224:227]
v_exp_f32 v104, v104
v_mfma_f32_16x16x32_bf16 v[228:231], a[116:119], v[72:75], v[228:231]
s_add_u32 m0, s11, s19
v_cndmask_b32 v36, v4, v28, s[72:73]
v_cndmask_b32 v37, v4, v28, s[74:75]
v_mfma_f32_16x16x32_bf16 v[196:199], a[116:119], v[64:67], v[196:199]
buffer_load_dwordx4 v1, s[36:39], s9 offen offset:1024 sc1 lds
v_mfma_f32_16x16x32_bf16 v[200:203], a[120:123], v[64:67], v[200:203]
ds_read_b128 a[88:91], v2 offset:22528
ds_read_b128 a[92:95], v2 offset:23552
v_exp_f32 v105, v105
v_mfma_f32_16x16x32_bf16 v[232:235], a[120:123], v[72:75], v[232:235]
v_exp_f32 v106, v106
v_mfma_f32_16x16x32_bf16 v[236:239], a[124:127], v[72:75], v[236:239]
s_add_u32 m0, s11, s20
v_cndmask_b32 v38, v4, v28, s[76:77]
v_cndmask_b32 v39, v4, v28, s[78:79]
v_mfma_f32_16x16x32_bf16 v[204:207], a[124:127], v[64:67], v[204:207]
buffer_load_dwordx4 v1, s[36:39], s9 offen offset:2048 sc1 lds
v_mfma_f32_16x16x32_bf16 a[136:139], a[144:147], v[64:67], a[136:139]
v_exp_f32 v107, v107
v_mfma_f32_16x16x32_bf16 a[140:143], a[144:147], v[72:75], a[140:143]
v_cvt_pk_bf16_f32 v104, v104, v105
v_cvt_pk_bf16_f32 v105, v106, v107
s_nop 0
s_waitcnt lgkmcnt(0)
v_mfma_f32_16x16x32_bf16 v[72:75], a[64:67], a[48:51], v[32:35]
ds_read_b128 a[96:99], v2 offset:8192
ds_read_b128 a[100:103], v2 offset:9216
v_exp_f32 v100, v100
v_mfma_f32_16x16x32_bf16 v[72:75], a[68:71], a[52:55], v[72:75]
v_exp_f32 v101, v101
ds_read_b128 a[104:107], v2 offset:10240
ds_read_b128 a[108:111], v2 offset:11264
v_mfma_f32_16x16x32_bf16 v[72:75], a[72:75], a[56:59], v[72:75]
s_add_u32 s62, s62, s0
s_add_u32 m0, s11, s21
v_exp_f32 v102, v102
v_exp_f32 v103, v103
v_mfma_f32_16x16x32_bf16 v[72:75], a[76:79], a[60:63], v[72:75]
buffer_load_dwordx4 v1, s[36:39], s9 offen offset:3072 sc1 lds
ds_read_b128 a[112:115], v2 offset:12288
ds_read_b128 a[116:119], v2 offset:13312
v_mfma_f32_16x16x32_bf16 v[76:79], a[92:95], a[60:63], v[36:39]
s_and_b32 s62, s62, 0x18000
v_cvt_pk_bf16_f32 v98, v100, v101
v_cvt_pk_bf16_f32 v99, v102, v103
v_exp_f32 v108, v108
v_mfma_f32_16x16x32_bf16 v[76:79], a[88:91], a[56:59], v[76:79]
ds_read_b128 a[120:123], v2 offset:14336
ds_read_b128 a[124:127], v2 offset:15360
v_exp_f32 v109, v109
v_mfma_f32_16x16x32_bf16 v[76:79], a[84:87], a[52:55], v[76:79]
v_exp_f32 v110, v110
v_exp_f32 v111, v111
v_mfma_f32_16x16x32_bf16 v[76:79], a[80:83], a[48:51], v[76:79]
v_cvt_pk_bf16_f32 v106, v108, v109
v_cvt_pk_bf16_f32 v107, v110, v111
s_nop 0
s_waitcnt lgkmcnt(0)
v_mfma_f32_16x16x32_bf16 v[176:179], a[96:99], v[96:99], v[176:179]
ds_read_b128 a[64:67], v2 offset:24576
ds_read_b128 a[68:71], v2 offset:25600
v_exp_f32 v72, v72
v_mfma_f32_16x16x32_bf16 v[208:211], a[96:99], v[104:107], v[208:211]
s_add_u32 s9, s9, 16384
v_cndmask_b32 v40, v4, v28, s[80:81]
v_cndmask_b32 v41, v4, v28, s[82:83]
v_mfma_f32_16x16x32_bf16 v[212:215], a[100:103], v[104:107], v[212:215]
s_sub_u32 s11, s11, 36992
v_exp_f32 v73, v73
v_mfma_f32_16x16x32_bf16 v[180:183], a[100:103], v[96:99], v[180:183]
ds_read_b128 a[72:75], v2 offset:26624
ds_read_b128 a[76:79], v2 offset:27648
v_mfma_f32_16x16x32_bf16 v[184:187], a[104:107], v[96:99], v[184:187]
s_add_u32 m0, s11, s18
v_exp_f32 v74, v74
v_cndmask_b32 v42, v4, v28, s[84:85]
v_cndmask_b32 v43, v4, v28, s[86:87]
v_mfma_f32_16x16x32_bf16 v[216:219], a[104:107], v[104:107], v[216:219]
buffer_load_dwordx4 v1, s[36:39], s9 offen offset:0 sc1 lds
v_mfma_f32_16x16x32_bf16 v[220:223], a[108:111], v[104:107], v[220:223]
v_exp_f32 v75, v75
v_mfma_f32_16x16x32_bf16 v[188:191], a[108:111], v[96:99], v[188:191]
ds_read_b128 a[80:83], v2 offset:28672
ds_read_b128 a[84:87], v2 offset:29696
v_mfma_f32_16x16x32_bf16 v[192:195], a[112:115], v[96:99], v[192:195]
s_add_u32 m0, s11, s19
v_cvt_pk_bf16_f32 v72, v72, v73
v_cvt_pk_bf16_f32 v73, v74, v75
v_mfma_f32_16x16x32_bf16 v[224:227], a[112:115], v[104:107], v[224:227]
buffer_load_dwordx4 v1, s[36:39], s9 offen offset:1024 sc1 lds
v_cndmask_b32 v44, v4, v28, s[88:89]
v_cndmask_b32 v45, v4, v28, s[90:91]
v_mfma_f32_16x16x32_bf16 v[228:231], a[116:119], v[104:107], v[228:231]
s_add_u32 m0, s11, s20
v_exp_f32 v76, v76
v_mfma_f32_16x16x32_bf16 v[196:199], a[116:119], v[96:99], v[196:199]
ds_read_b128 a[88:91], v2 offset:30720
ds_read_b128 a[92:95], v2 offset:31744
v_mfma_f32_16x16x32_bf16 v[200:203], a[120:123], v[96:99], v[200:203]
buffer_load_dwordx4 v1, s[36:39], s9 offen offset:2048 sc1 lds
v_mfma_f32_16x16x32_bf16 v[232:235], a[120:123], v[104:107], v[232:235]
v_exp_f32 v77, v77
v_cndmask_b32 v46, v4, v28, s[92:93]
v_cndmask_b32 v47, v4, v28, s[94:95]
v_mfma_f32_16x16x32_bf16 v[236:239], a[124:127], v[104:107], v[236:239]
s_add_u32 m0, s11, s21
Lpad7:
s_cbranch_execz Lhopback
v_exp_f32 v78, v78
v_mfma_f32_16x16x32_bf16 v[204:207], a[124:127], v[96:99], v[204:207]
buffer_load_dwordx4 v1, s[36:39], s9 offen offset:3072 sc1 lds
v_mfma_f32_16x16x32_bf16 a[136:139], a[144:147], v[96:99], a[136:139]
s_add_u32 s10, s10, 81920
v_or_b32 v2, s62, v1
v_mfma_f32_16x16x32_bf16 a[140:143], a[144:147], v[104:107], a[140:143]
v_exp_f32 v79, v79
s_waitcnt vmcnt(13) lgkmcnt(0)
s_barrier
v_mfma_f32_16x16x32_bf16 v[104:107], a[64:67], a[48:51], v[40:43]
ds_read_b128 a[96:99], v2 offset:0
ds_read_b128 a[100:103], v2 offset:1024
v_mfma_f32_16x16x32_bf16 v[104:107], a[68:71], a[52:55], v[104:107]
s_add_u32 m0, s11, 0
s_nop 0
buffer_load_dwordx4 v240, s[44:47], s10 offen lds
v_mfma_f32_16x16x32_bf16 v[104:107], a[72:75], a[56:59], v[104:107]
ds_read_b128 a[104:107], v2 offset:2048
ds_read_b128 a[108:111], v2 offset:3072
v_mfma_f32_16x16x32_bf16 v[104:107], a[76:79], a[60:63], v[104:107]
ds_read_b128 a[112:115], v2 offset:4096
ds_read_b128 a[116:119], v2 offset:5120
v_mfma_f32_16x16x32_bf16 v[108:111], a[92:95], a[60:63], v[44:47]
ds_read_b128 a[120:123], v2 offset:6144
ds_read_b128 a[124:127], v2 offset:7168
v_mfma_f32_16x16x32_bf16 v[108:111], a[88:91], a[56:59], v[108:111]
s_add_u32 m0, s11, 1024
s_nop 0
buffer_load_dwordx4 v241, s[44:47], s10 offen lds
v_mfma_f32_16x16x32_bf16 v[108:111], a[84:87], a[52:55], v[108:111]
v_cvt_pk_bf16_f32 v74, v76, v77
v_cvt_pk_bf16_f32 v75, v78, v79
v_mfma_f32_16x16x32_bf16 v[108:111], a[80:83], a[48:51], v[108:111]
s_waitcnt lgkmcnt(0)
v_mfma_f32_16x16x32_bf16 v[208:211], a[96:99], v[72:75], v[208:211]
ds_read_b128 a[64:67], v2 offset:8192
ds_read_b128 a[68:71], v2 offset:9216
v_exp_f32 v104, v104
v_mfma_f32_16x16x32_bf16 v[212:215], a[100:103], v[72:75], v[212:215]
ds_read_b128 a[72:75], v2 offset:10240
ds_read_b128 a[76:79], v2 offset:11264
v_exp_f32 v105, v105
v_mfma_f32_16x16x32_bf16 v[216:219], a[104:107], v[72:75], v[216:219]
s_add_u32 m0, s11, 2048
s_nop 0
buffer_load_dwordx4 v242, s[44:47], s10 offen lds
v_exp_f32 v106, v106
v_exp_f32 v107, v107
v_mfma_f32_16x16x32_bf16 v[220:223], a[108:111], v[72:75], v[220:223]
ds_read_b128 a[80:83], v2 offset:12288
ds_read_b128 a[84:87], v2 offset:13312
v_exp_f32 v108, v108
v_mfma_f32_16x16x32_bf16 v[224:227], a[112:115], v[72:75], v[224:227]
ds_read_b128 a[88:91], v2 offset:14336
ds_read_b128 a[92:95], v2 offset:15360
v_cvt_pk_bf16_f32 v104, v104, v105
v_cvt_pk_bf16_f32 v105, v106, v107
v_mfma_f32_16x16x32_bf16 v[228:231], a[116:119], v[72:75], v[228:231]
s_add_u32 m0, s11, 3072
s_nop 0
buffer_load_dwordx4 v243, s[44:47], s10 offen lds
v_exp_f32 v109, v109
v_mfma_f32_16x16x32_bf16 v[232:235], a[120:123], v[72:75], v[232:235]
v_exp_f32 v110, v110
v_mfma_f32_16x16x32_bf16 v[236:239], a[124:127], v[72:75], v[236:239]
v_exp_f32 v111, v111
v_mfma_f32_16x16x32_bf16 a[140:143], a[144:147], v[72:75], a[140:143]
s_add_u32 m0, s11, 4096
s_nop 0
buffer_load_dwordx4 v244, s[96:99], s10 offen sc1 lds
s_add_u32 s10, s10, 81920
v_cvt_pk_bf16_f32 v106, v108, v109
v_cvt_pk_bf16_f32 v107, v110, v111
v_accvgpr_read_b32 v8, a136
v_accvgpr_read_b32 v9, a137
v_add_f32 v8, v8, v9
s_mov_b32 s52, 0x53800000
v_cmp_nle_f32 vcc, 0x30800000, v8
v_cmp_nge_f32 s[54:55], s52, v8
v_rcp_f32 v8, v8
s_or_b64 vcc, vcc, s[54:55]
s_cselect_b32 s27, 1, s27
v_pk_mul_f32 v[176:177], v[176:177], v[8:9] op_sel_hi:[1,0]
v_pk_mul_f32 v[178:179], v[178:179], v[8:9] op_sel_hi:[1,0]
v_pk_mul_f32 v[180:181], v[180:181], v[8:9] op_sel_hi:[1,0]
v_pk_mul_f32 v[182:183], v[182:183], v[8:9] op_sel_hi:[1,0]
s_add_u32 s9, s9, 16384
s_sub_u32 s11, s11, 36992
s_add_u32 m0, s11, s18
s_nop 0
buffer_load_dwordx4 v1, s[36:39], s9 offen offset:0 sc1 lds
s_add_u32 s52, s59, 0
v_cvt_pk_bf16_f32 v176, v176, v177
v_cvt_pk_bf16_f32 v177, v178, v179
v_cvt_pk_bf16_f32 v178, v180, v181
v_cvt_pk_bf16_f32 v179, v182, v183
buffer_store_dwordx4 v[176:179], v1, s[40:43], s52 offen sc1
v_pk_mul_f32 v[184:185], v[184:185], v[8:9] op_sel_hi:[1,0]
v_pk_mul_f32 v[186:187], v[186:187], v[8:9] op_sel_hi:[1,0]
s_add_u32 m0, s11, s19
s_nop 0
buffer_load_dwordx4 v1, s[36:39], s9 offen offset:1024 sc1 lds
v_pk_mul_f32 v[188:189], v[188:189], v[8:9] op_sel_hi:[1,0]
v_pk_mul_f32 v[190:191], v[190:191], v[8:9] op_sel_hi:[1,0]
s_add_u32 s52, s59, 8192
v_cvt_pk_bf16_f32 v184, v184, v185
v_cvt_pk_bf16_f32 v185, v186, v187
v_cvt_pk_bf16_f32 v186, v188, v189
v_cvt_pk_bf16_f32 v187, v190, v191
buffer_store_dwordx4 v[184:187], v1, s[40:43], s52 offen sc1
s_add_u32 m0, s11, s20
s_nop 0
buffer_load_dwordx4 v1, s[36:39], s9 offen offset:2048 sc1 lds
v_pk_mul_f32 v[192:193], v[192:193], v[8:9] op_sel_hi:[1,0]
v_pk_mul_f32 v[194:195], v[194:195], v[8:9] op_sel_hi:[1,0]
v_pk_mul_f32 v[196:197], v[196:197], v[8:9] op_sel_hi:[1,0]
v_pk_mul_f32 v[198:199], v[198:199], v[8:9] op_sel_hi:[1,0]
s_add_u32 s52, s59, 16384
v_cvt_pk_bf16_f32 v192, v192, v193
v_cvt_pk_bf16_f32 v193, v194, v195
v_cvt_pk_bf16_f32 v194, v196, v197
s_add_u32 m0, s11, s21
s_nop 0
buffer_load_dwordx4 v1, s[36:39], s9 offen offset:3072 sc1 lds
v_cvt_pk_bf16_f32 v195, v198, v199
buffer_store_dwordx4 v[192:195], v1, s[40:43], s52 offen sc1
v_pk_mul_f32 v[200:201], v[200:201], v[8:9] op_sel_hi:[1,0]
v_pk_mul_f32 v[202:203], v[202:203], v[8:9] op_sel_hi:[1,0]
v_pk_mul_f32 v[204:205], v[204:205], v[8:9] op_sel_hi:[1,0]
v_pk_mul_f32 v[206:207], v[206:207], v[8:9] op_sel_hi:[1,0]
s_add_u32 s52, s59, 24576
v_cvt_pk_bf16_f32 v200, v200, v201
v_cvt_pk_bf16_f32 v201, v202, v203
v_cvt_pk_bf16_f32 v202, v204, v205
v_cvt_pk_bf16_f32 v203, v206, v207
buffer_store_dwordx4 v[200:203], v1, s[40:43], s52 offen sc1
s_waitcnt vmcnt(17) lgkmcnt(0)
s_barrier
v_mfma_f32_16x16x32_bf16 a[140:143], a[144:147], v[104:107], a[140:143]
s_add_u32 m0, s11, 0
s_nop 0
buffer_load_dwordx4 v240, s[44:47], s10 offen lds
v_mfma_f32_16x16x32_bf16 v[208:211], a[64:67], v[104:107], v[208:211]
ds_read_b128 a[148:151], v245 offset:0
ds_read_b128 a[152:155], v245 offset:1024
v_mfma_f32_16x16x32_bf16 v[212:215], a[68:71], v[104:107], v[212:215]
s_add_u32 m0, s11, 1024
s_nop 0
buffer_load_dwordx4 v241, s[44:47], s10 offen lds
v_mfma_f32_16x16x32_bf16 v[216:219], a[72:75], v[104:107], v[216:219]
ds_read_b128 a[156:159], v245 offset:2048
ds_read_b128 a[160:163], v245 offset:3072
v_mfma_f32_16x16x32_bf16 v[220:223], a[76:79], v[104:107], v[220:223]
s_add_u32 m0, s11, 2048
s_nop 0
buffer_load_dwordx4 v242, s[44:47], s10 offen lds
v_mfma_f32_16x16x32_bf16 v[224:227], a[80:83], v[104:107], v[224:227]
ds_read_b64_tr_b16 a[164:165], v246 offset:0
ds_read_b64_tr_b16 a[166:167], v246 offset:1024
v_mfma_f32_16x16x32_bf16 v[228:231], a[84:87], v[104:107], v[228:231]
s_add_u32 m0, s11, 3072
s_nop 0
buffer_load_dwordx4 v243, s[44:47], s10 offen lds
v_mfma_f32_16x16x32_bf16 v[232:235], a[88:91], v[104:107], v[232:235]
ds_read_b64_tr_b16 a[168:169], v246 offset:32
ds_read_b64_tr_b16 a[170:171], v246 offset:1056
v_mfma_f32_16x16x32_bf16 v[236:239], a[92:95], v[104:107], v[236:239]
s_add_u32 m0, s11, 4096
s_nop 0
buffer_load_dwordx4 v244, s[96:99], s10 offen sc1 lds
s_add_u32 s10, s10, 81920
v_accvgpr_read_b32 v8, a140
v_accvgpr_read_b32 v9, a141
v_add_f32 v8, v8, v9
s_mov_b32 s52, 0x53800000
v_cmp_nle_f32 vcc, 0x30800000, v8
v_cmp_nge_f32 s[54:55], s52, v8
v_rcp_f32 v8, v8
s_or_b64 vcc, vcc, s[54:55]
s_cselect_b32 s27, 1, s27
ds_read_b64_tr_b16 a[172:173], v246 offset:256
ds_read_b64_tr_b16 a[174:175], v246 offset:1280
v_pk_mul_f32 v[208:209], v[208:209], v[8:9] op_sel_hi:[1,0]
v_pk_mul_f32 v[210:211], v[210:211], v[8:9] op_sel_hi:[1,0]
v_pk_mul_f32 v[212:213], v[212:213], v[8:9] op_sel_hi:[1,0]
ds_read_b64_tr_b16 a[176:177], v246 offset:288
ds_read_b64_tr_b16 a[178:179], v246 offset:1312
v_pk_mul_f32 v[214:215], v[214:215], v[8:9] op_sel_hi:[1,0]
s_add_u32 s52, s59, 4096
v_cvt_pk_bf16_f32 v208, v208, v209
ds_read_b64_tr_b16 a[180:181], v247 offset:0
ds_read_b64_tr_b16 a[182:183], v247 offset:256
v_cvt_pk_bf16_f32 v209, v210, v211
v_cvt_pk_bf16_f32 v210, v212, v213
v_cvt_pk_bf16_f32 v211, v214, v215
ds_read_b128 a[184:187], v245 offset:8192
ds_read_b128 a[188:191], v245 offset:9216
buffer_store_dwordx4 v[208:211], v1, s[40:43], s52 offen sc1
v_pk_mul_f32 v[216:217], v[216:217], v[8:9] op_sel_hi:[1,0]
v_pk_mul_f32 v[218:219], v[218:219], v[8:9] op_sel_hi:[1,0]
ds_read_b128 a[192:195], v245 offset:10240
ds_read_b128 a[196:199], v245 offset:11264
v_pk_mul_f32 v[220:221], v[220:221], v[8:9] op_sel_hi:[1,0]
v_pk_mul_f32 v[222:223], v[222:223], v[8:9] op_sel_hi:[1,0]
s_add_u32 s52, s59, 12288
v_cvt_pk_bf16_f32 v216, v216, v217
ds_read_b64_tr_b16 a[200:201], v246 offset:10304
ds_read_b64_tr_b16 a[202:203], v246 offset:11328
v_cvt_pk_bf16_f32 v217, v218, v219
v_cvt_pk_bf16_f32 v218, v220, v221
v_cvt_pk_bf16_f32 v219, v222, v223
ds_read_b64_tr_b16 a[204:205], v246 offset:10336
ds_read_b64_tr_b16 a[206:207], v246 offset:11360
buffer_store_dwordx4 v[216:219], v1, s[40:43], s52 offen sc1
v_pk_mul_f32 v[224:225], v[224:225], v[8:9] op_sel_hi:[1,0]
v_pk_mul_f32 v[226:227], v[226:227], v[8:9] op_sel_hi:[1,0]
ds_read_b64_tr_b16 a[208:209], v246 offset:10560
ds_read_b64_tr_b16 a[210:211], v246 offset:11584
v_pk_mul_f32 v[228:229], v[228:229], v[8:9] op_sel_hi:[1,0]
v_pk_mul_f32 v[230:231], v[230:231], v[8:9] op_sel_hi:[1,0]
s_add_u32 s52, s59, 20480
ds_read_b64_tr_b16 a[212:213], v246 offset:10592
ds_read_b64_tr_b16 a[214:215], v246 offset:11616
v_cvt_pk_bf16_f32 v224, v224, v225
v_cvt_pk_bf16_f32 v225, v226, v227
v_cvt_pk_bf16_f32 v226, v228, v229
ds_read_b64_tr_b16 a[216:217], v247 offset:10304
ds_read_b64_tr_b16 a[218:219], v247 offset:10560
v_cvt_pk_bf16_f32 v227, v230, v231
buffer_store_dwordx4 v[224:227], v1, s[40:43], s52 offen sc1
v_pk_mul_f32 v[232:233], v[232:233], v[8:9] op_sel_hi:[1,0]
v_pk_mul_f32 v[234:235], v[234:235], v[8:9] op_sel_hi:[1,0]
v_pk_mul_f32 v[236:237], v[236:237], v[8:9] op_sel_hi:[1,0]
v_pk_mul_f32 v[238:239], v[238:239], v[8:9] op_sel_hi:[1,0]
s_add_u32 s52, s59, 28672
v_cvt_pk_bf16_f32 v232, v232, v233
v_cvt_pk_bf16_f32 v233, v234, v235
v_cvt_pk_bf16_f32 v234, v236, v237
v_cvt_pk_bf16_f32 v235, v238, v239
buffer_store_dwordx4 v[232:235], v1, s[40:43], s52 offen sc1
v_mov_b32 v6, s27
v_lshl_add_u32 v7, s30, 2, v5
ds_write_b32 v7, v6
v_add_u32 v245, 0xffff6f80, v245
v_add_u32 v246, 0xffff6f80, v246
v_add_u32 v247, 0xffff6f80, v247
s_waitcnt vmcnt(17) lgkmcnt(0)
s_barrier
v_mfma_f32_16x16x32_bf16 v[16:19], a[164:167], a[148:151], 0
ds_read_b128 v[8:11], v5
v_mfma_f32_16x16x32_bf16 v[16:19], a[200:203], a[184:187], v[16:19]
s_add_u32 s9, s9, 16384
s_sub_u32 s11, s11, 36992
s_add_u32 m0, s11, s18
ds_read_b128 a[64:67], v245 offset:0
ds_read_b128 a[68:71], v245 offset:1024
v_mfma_f32_16x16x32_bf16 v[20:23], a[204:207], a[184:187], 0
buffer_load_dwordx4 v1, s[36:39], s9 offen offset:0 sc1 lds
v_mfma_f32_16x16x32_bf16 v[20:23], a[168:171], a[148:151], v[20:23]
s_add_u32 m0, s11, s19
ds_read_b128 a[72:75], v245 offset:2048
ds_read_b128 a[76:79], v245 offset:3072
v_mfma_f32_16x16x32_bf16 v[24:27], a[172:175], a[148:151], 0
buffer_load_dwordx4 v1, s[36:39], s9 offen offset:1024 sc1 lds
v_mfma_f32_16x16x32_bf16 v[24:27], a[208:211], a[184:187], v[24:27]
s_add_u32 m0, s11, s20
ds_read_b64_tr_b16 a[80:81], v246 offset:0
ds_read_b64_tr_b16 a[82:83], v246 offset:1024
v_mfma_f32_16x16x32_bf16 v[28:31], a[212:215], a[184:187], 0
buffer_load_dwordx4 v1, s[36:39], s9 offen offset:2048 sc1 lds
v_mfma_f32_16x16x32_bf16 v[28:31], a[176:179], a[148:151], v[28:31]
s_add_u32 m0, s11, s21
ds_read_b64_tr_b16 a[84:85], v246 offset:32
ds_read_b64_tr_b16 a[86:87], v246 offset:1056
v_mfma_f32_16x16x32_bf16 v[32:35], a[180:183], a[148:151], 0
buffer_load_dwordx4 v1, s[36:39], s9 offen offset:3072 sc1 lds
v_mfma_f32_16x16x32_bf16 v[32:35], a[216:219], a[184:187], v[32:35]
s_add_u32 m0, s11, 0
ds_read_b64_tr_b16 a[88:89], v246 offset:256
ds_read_b64_tr_b16 a[90:91], v246 offset:1280
v_mfma_f32_16x16x32_bf16 v[52:55], a[216:219], a[188:191], 0
buffer_load_dwordx4 v240, s[44:47], s10 offen lds
v_mfma_f32_16x16x32_bf16 v[52:55], a[180:183], a[152:155], v[52:55]
s_add_u32 m0, s11, 1024
ds_read_b64_tr_b16 a[92:93], v246 offset:288
ds_read_b64_tr_b16 a[94:95], v246 offset:1312
s_waitcnt lgkmcnt(12)
v_or3_b32 v8, v8, v9, v10
v_or_b32 v8, v8, v11
v_mfma_f32_16x16x32_bf16 v[48:51], a[176:179], a[152:155], 0
buffer_load_dwordx4 v241, s[44:47], s10 offen lds
v_readfirstlane_b32 s52, v8
v_mfma_f32_16x16x32_bf16 v[48:51], a[212:215], a[188:191], v[48:51]
s_add_u32 m0, s11, 2048
ds_read_b64_tr_b16 a[96:97], v247 offset:0
ds_read_b64_tr_b16 a[98:99], v247 offset:256
v_mfma_f32_16x16x32_bf16 v[44:47], a[208:211], a[188:191], 0
buffer_load_dwordx4 v242, s[44:47], s10 offen lds
s_cmp_gt_u32 s52, s26
s_cbranch_scc1 Lredo
v_mfma_f32_16x16x32_bf16 v[44:47], a[172:175], a[152:155], v[44:47]
s_add_u32 m0, s11, 3072
s_add_u32 s53, s6, 1
s_mul_i32 s83, s53, 1310720
s_lshl_b32 s82, s53, 18
s_lshl_b32 s52, s7, 20
v_mfma_f32_16x16x32_bf16 v[40:43], a[168:171], a[152:155], 0
buffer_load_dwordx4 v243, s[44:47], s10 offen lds
v_mfma_f32_16x16x32_bf16 v[40:43], a[204:207], a[188:191], v[40:43]
ds_read_b128 a[100:103], v245 offset:8192
ds_read_b128 a[104:107], v245 offset:9216
v_mfma_f32_16x16x32_bf16 v[36:39], a[200:203], a[188:191], 0
s_add_u32 m0, s11, 4096
s_add_u32 s52, s52, 0x2c00000
s_add_u32 s80, s28, s52
s_addc_u32 s81, s29, 0
s_add_u32 s84, s28, 0x5240000
s_addc_u32 s85, s29, 0
v_mfma_f32_16x16x32_bf16 v[36:39], a[164:167], a[152:155], v[36:39]
buffer_load_dwordx4 v244, s[96:99], s10 offen sc1 lds
v_mfma_f32_16x16x32_bf16 v[56:59], a[164:167], a[156:159], 0
ds_read_b128 a[108:111], v245 offset:10240
ds_read_b128 a[112:115], v245 offset:11264
v_mfma_f32_16x16x32_bf16 v[56:59], a[200:203], a[192:195], v[56:59]
s_add_u32 s10, s10, 81920
s_add_u32 s11, s11, 110976
s_add_u32 m0, s11, 0
s_mul_i32 s52, s6, 64
s_add_u32 s52, s52, s30
s_lshl_b32 s86, s52, 12
s_lshr_b32 s53, s52, 1
v_mfma_f32_16x16x32_bf16 v[60:63], a[204:207], a[192:195], 0
buffer_load_dwordx4 v240, s[44:47], s10 offen lds
v_mfma_f32_16x16x32_bf16 v[60:63], a[168:171], a[156:159], v[60:63]
ds_read_b64_tr_b16 a[116:117], v246 offset:10304
ds_read_b64_tr_b16 a[118:119], v246 offset:11328
v_mfma_f32_16x16x32_bf16 v[64:67], a[172:175], a[156:159], 0
s_add_u32 m0, s11, 1024
s_lshl_b32 s53, s53, 3
s_and_b32 s52, s30, 1
s_add_u32 s53, s53, s52
s_mul_i32 s53, s53, 5120
v_mfma_f32_16x16x32_bf16 v[64:67], a[208:211], a[192:195], v[64:67]
buffer_load_dwordx4 v241, s[44:47], s10 offen lds
v_mfma_f32_16x16x32_bf16 v[68:71], a[212:215], a[192:195], 0
ds_read_b64_tr_b16 a[120:121], v246 offset:10336
ds_read_b64_tr_b16 a[122:123], v246 offset:11360
v_mfma_f32_16x16x32_bf16 v[68:71], a[176:179], a[156:159], v[68:71]
s_add_u32 m0, s11, 2048
s_mul_i32 s52, s8, 320
s_add_u32 s52, s52, 64
s_and_b32 s52, s52, 0x780
s_add_u32 s87, s53, s52
v_mfma_f32_16x16x32_bf16 v[72:75], a[180:183], a[156:159], 0
buffer_load_dwordx4 v242, s[44:47], s10 offen lds
v_mfma_f32_16x16x32_bf16 v[72:75], a[216:219], a[192:195], v[72:75]
ds_read_b64_tr_b16 a[124:125], v246 offset:10560
ds_read_b64_tr_b16 a[126:127], v246 offset:11584
v_mfma_f32_16x16x32_bf16 v[92:95], a[216:219], a[196:199], 0
s_add_u32 m0, s11, 3072
s_lshl_b32 s52, s3, 5
s_add_u32 s52, s52, s31
s_add_u32 s52, s52, 64
s_lshl_b32 s88, s52, 7
v_mfma_f32_16x16x32_bf16 v[92:95], a[180:183], a[160:163], v[92:95]
buffer_load_dwordx4 v243, s[44:47], s10 offen lds
v_mfma_f32_16x16x32_bf16 v[88:91], a[176:179], a[160:163], 0
ds_read_b64_tr_b16 a[128:129], v246 offset:10592
ds_read_b64_tr_b16 a[130:131], v246 offset:11616
v_mfma_f32_16x16x32_bf16 v[88:91], a[212:215], a[196:199], v[88:91]
s_add_u32 m0, s11, 4096
v_mfma_f32_16x16x32_bf16 v[84:87], a[208:211], a[196:199], 0
buffer_load_dwordx4 v244, s[96:99], s10 offen sc1 lds
v_mfma_f32_16x16x32_bf16 v[84:87], a[172:175], a[160:163], v[84:87]
ds_read_b64_tr_b16 a[132:133], v247 offset:10304
ds_read_b64_tr_b16 a[134:135], v247 offset:10560
v_add_u32 v245, 0xffff6f80, v245
v_add_u32 v246, 0xffff6f80, v246
v_add_u32 v247, 0xffff6f80, v247
v_mfma_f32_16x16x32_bf16 v[80:83], a[168:171], a[160:163], 0
s_lshl_b32 s52, s6, 3
s_lshr_b32 s52, 0x2040204, s52
s_and_b32 s76, s52, 0xff
s_lshl_b32 s64, 0x101, s76
v_mfma_f32_16x16x32_bf16 v[80:83], a[204:207], a[196:199], v[80:83]
s_lshl_b32 s75, s64, 1
s_or_b32 s64, s64, 4
s_add_u32 s77, s76, 16
s_mov_b32 s74, 110976
v_mfma_f32_16x16x32_bf16 v[76:79], a[200:203], a[196:199], 0
s_mov_b32 s63, 1
s_add_u32 s9, s9, 16384
s_add_u32 s10, s10, 81920
v_mfma_f32_16x16x32_bf16 v[76:79], a[164:167], a[160:163], v[76:79]
s_waitcnt vmcnt(18) lgkmcnt(0)
s_barrier
s_branch Lp4or
Lp4ee:
s_cmp_eq_u32 s63, 2
s_cbranch_scc0 Lp4e3
s_cmp_lg_u32 s30, 0
s_cbranch_scc1 Lpc_np
v_mov_b32 v8, 1
s_mov_b64 exec, 1
buffer_store_dword v8, off, s[48:51], s88 offset:0 sc1
s_mov_b64 exec, -1
Lpc_np:
s_cmp_lt_u32 s63, s76
s_cbranch_scc1 Lp4er
Lp4e3:
buffer_load_dword v12, v13, s[48:51], s12 offen sc1
s_cmp_eq_u32 s63, s76
s_cbranch_scc0 Lp4er
s_mov_b64 s[44:45], s[14:15]
s_mov_b32 s46, s83
s_mov_b64 s[96:97], s[84:85]
s_mov_b32 s98, s83
s_mov_b32 s10, s87
s_branch Lp4er
Lp4oe:
s_waitcnt vmcnt(9)
v_cmp_gt_u32 vcc, 1, v12
s_mov_b32 s55, 0x200000
s_nop 0
s_cbranch_vccnz Lfc_ld
Lfc_ok:
s_add_u32 s12, s12, 512
s_sub_u32 s52, s63, 1
s_cmp_eq_u32 s52, s76
s_cbranch_scc0 Lp4or
s_mov_b64 s[36:37], s[80:81]
s_mov_b32 s38, s82
s_mov_b32 s9, s86
s_branch Lp4or
.p2align 6
Lp4e:
s_bitcmp1_b32 s64, s63
s_cbranch_scc1 Lp4ee
Lp4er:
v_mfma_f32_16x16x32_bf16 v[16:19], a[164:167], a[148:151], v[16:19]
s_add_u32 m0, s11, s18
v_mfma_f32_16x16x32_bf16 v[16:19], a[200:203], a[184:187], v[16:19]
ds_read_b128 a[64:67], v245 offset:0
ds_read_b128 a[68:71], v245 offset:1024
v_mfma_f32_16x16x32_bf16 v[20:23], a[204:207], a[184:187], v[20:23]
buffer_load_dwordx4 v1, s[36:39], s9 offen offset:0 sc1 lds
v_mfma_f32_16x16x32_bf16 v[20:23], a[168:171], a[148:151], v[20:23]
ds_read_b128 a[72:75], v245 offset:2048
ds_read_b128 a[76:79], v245 offset:3072
v_mfma_f32_16x16x32_bf16 v[24:27], a[172:175], a[148:151], v[24:27]
v_mfma_f32_16x16x32_bf16 v[24:27], a[208:211], a[184:187], v[24:27]
s_add_u32 m0, s11, s19
v_mfma_f32_16x16x32_bf16 v[28:31], a[212:215], a[184:187], v[28:31]
ds_read_b64_tr_b16 a[80:81], v246 offset:0
ds_read_b64_tr_b16 a[82:83], v246 offset:1024
v_mfma_f32_16x16x32_bf16 v[28:31], a[176:179], a[148:151], v[28:31]
buffer_load_dwordx4 v1, s[36:39], s9 offen offset:1024 sc1 lds
v_mfma_f32_16x16x32_bf16 v[32:35], a[180:183], a[148:151], v[32:35]
ds_read_b64_tr_b16 a[84:85], v246 offset:32
ds_read_b64_tr_b16 a[86:87], v246 offset:1056
v_mfma_f32_16x16x32_bf16 v[32:35], a[216:219], a[184:187], v[32:35]
s_add_u32 m0, s11, s20
v_mfma_f32_16x16x32_bf16 v[52:55], a[216:219], a[188:191], v[52:55]
ds_read_b64_tr_b16 a[88:89], v246 offset:256
ds_read_b64_tr_b16 a[90:91], v246 offset:1280
v_mfma_f32_16x16x32_bf16 v[52:55], a[180:183], a[152:155], v[52:55]
buffer_load_dwordx4 v1, s[36:39], s9 offen offset:2048 sc1 lds
v_mfma_f32_16x16x32_bf16 v[48:51], a[176:179], a[152:155], v[48:51]
ds_read_b64_tr_b16 a[92:93], v246 offset:288
ds_read_b64_tr_b16 a[94:95], v246 offset:1312
v_mfma_f32_16x16x32_bf16 v[48:51], a[212:215], a[188:191], v[48:51]
v_mfma_f32_16x16x32_bf16 v[44:47], a[208:211], a[188:191], v[44:47]
s_add_u32 m0, s11, s21
v_mfma_f32_16x16x32_bf16 v[44:47], a[172:175], a[152:155], v[44:47]
ds_read_b64_tr_b16 a[96:97], v247 offset:0
ds_read_b64_tr_b16 a[98:99], v247 offset:256
v_mfma_f32_16x16x32_bf16 v[40:43], a[168:171], a[152:155], v[40:43]
buffer_load_dwordx4 v1, s[36:39], s9 offen offset:3072 sc1 lds
v_mfma_f32_16x16x32_bf16 v[40:43], a[204:207], a[188:191], v[40:43]
ds_read_b128 a[100:103], v245 offset:8192
ds_read_b128 a[104:107], v245 offset:9216
v_mfma_f32_16x16x32_bf16 v[36:39], a[200:203], a[188:191], v[36:39]
s_xor_b32 s53, s74, 0xfffede00
s_add_u32 s11, s11, s53
s_add_u32 m0, s11, 0
v_mfma_f32_16x16x32_bf16 v[36:39], a[164:167], a[152:155], v[36:39]
ds_read_b128 a[108:111], v245 offset:10240
ds_read_b128 a[112:115], v245 offset:11264
v_mfma_f32_16x16x32_bf16 v[56:59], a[164:167], a[156:159], v[56:59]
buffer_load_dwordx4 v240, s[44:47], s10 offen lds
v_mfma_f32_16x16x32_bf16 v[56:59], a[200:203], a[192:195], v[56:59]
ds_read_b64_tr_b16 a[116:117], v246 offset:10304
ds_read_b64_tr_b16 a[118:119], v246 offset:11328
v_mfma_f32_16x16x32_bf16 v[60:63], a[204:207], a[192:195], v[60:63]
v_mfma_f32_16x16x32_bf16 v[60:63], a[168:171], a[156:159], v[60:63]
s_add_u32 m0, s11, 1024
v_mfma_f32_16x16x32_bf16 v[64:67], a[172:175], a[156:159], v[64:67]
ds_read_b64_tr_b16 a[120:121], v246 offset:10336
ds_read_b64_tr_b16 a[122:123], v246 offset:11360
v_mfma_f32_16x16x32_bf16 v[64:67], a[208:211], a[192:195], v[64:67]
buffer_load_dwordx4 v241, s[44:47], s10 offen lds
v_mfma_f32_16x16x32_bf16 v[68:71], a[212:215], a[192:195], v[68:71]
ds_read_b64_tr_b16 a[124:125], v246 offset:10560
ds_read_b64_tr_b16 a[126:127], v246 offset:11584
v_mfma_f32_16x16x32_bf16 v[68:71], a[176:179], a[156:159], v[68:71]
s_add_u32 m0, s11, 2048
v_mfma_f32_16x16x32_bf16 v[72:75], a[180:183], a[156:159], v[72:75]
ds_read_b64_tr_b16 a[128:129], v246 offset:10592
ds_read_b64_tr_b16 a[130:131], v246 offset:11616
v_mfma_f32_16x16x32_bf16 v[72:75], a[216:219], a[192:195], v[72:75]
buffer_load_dwordx4 v242, s[44:47], s10 offen lds
v_mfma_f32_16x16x32_bf16 v[92:95], a[216:219], a[196:199], v[92:95]
ds_read_b64_tr_b16 a[132:133], v247 offset:10304
ds_read_b64_tr_b16 a[134:135], v247 offset:10560
v_mfma_f32_16x16x32_bf16 v[92:95], a[180:183], a[160:163], v[92:95]
s_add_u32 s9, s9, 16384
v_add_u32 v245, s74, v245
v_add_u32 v246, s74, v246
v_mfma_f32_16x16x32_bf16 v[88:91], a[176:179], a[160:163], v[88:91]
s_add_u32 m0, s11, 3072
v_mfma_f32_16x16x32_bf16 v[88:91], a[212:215], a[196:199], v[88:91]
buffer_load_dwordx4 v243, s[44:47], s10 offen lds
v_mfma_f32_16x16x32_bf16 v[84:87], a[208:211], a[196:199], v[84:87]
s_add_u32 s63, s63, 1
v_add_u32 v247, s74, v247
v_mfma_f32_16x16x32_bf16 v[84:87], a[172:175], a[160:163], v[84:87]
s_add_u32 m0, s11, 4096
v_mfma_f32_16x16x32_bf16 v[80:83], a[168:171], a[160:163], v[80:83]
buffer_load_dwordx4 v244, s[96:99], s10 offen sc1 lds
v_mfma_f32_16x16x32_bf16 v[80:83], a[204:207], a[196:199], v[80:83]
v_mfma_f32_16x16x32_bf16 v[76:79], a[200:203], a[196:199], v[76:79]
s_add_u32 s10, s10, 81920
s_mov_b32 s74, s53
s_bitcmp1_b32 s75, s63
v_mfma_f32_16x16x32_bf16 v[76:79], a[164:167], a[160:163], v[76:79]
s_waitcnt vmcnt(14) lgkmcnt(0)
s_barrier
s_cbranch_scc1 Lp4oe
Lp4or:
v_mfma_f32_16x16x32_bf16 v[16:19], a[80:83], a[64:67], v[16:19]
s_add_u32 m0, s11, s18
v_mfma_f32_16x16x32_bf16 v[16:19], a[116:119], a[100:103], v[16:19]
ds_read_b128 a[148:151], v245 offset:0
ds_read_b128 a[152:155], v245 offset:1024
v_mfma_f32_16x16x32_bf16 v[20:23], a[120:123], a[100:103], v[20:23]
buffer_load_dwordx4 v1, s[36:39], s9 offen offset:0 sc1 lds
v_mfma_f32_16x16x32_bf16 v[20:23], a[84:87], a[64:67], v[20:23]
ds_read_b128 a[156:159], v245 offset:2048
ds_read_b128 a[160:163], v245 offset:3072
v_mfma_f32_16x16x32_bf16 v[24:27], a[88:91], a[64:67], v[24:27]
v_mfma_f32_16x16x32_bf16 v[24:27], a[124:127], a[100:103], v[24:27]
s_add_u32 m0, s11, s19
v_mfma_f32_16x16x32_bf16 v[28:31], a[128:131], a[100:103], v[28:31]
ds_read_b64_tr_b16 a[164:165], v246 offset:0
ds_read_b64_tr_b16 a[166:167], v246 offset:1024
v_mfma_f32_16x16x32_bf16 v[28:31], a[92:95], a[64:67], v[28:31]
buffer_load_dwordx4 v1, s[36:39], s9 offen offset:1024 sc1 lds
v_mfma_f32_16x16x32_bf16 v[32:35], a[96:99], a[64:67], v[32:35]
ds_read_b64_tr_b16 a[168:169], v246 offset:32
ds_read_b64_tr_b16 a[170:171], v246 offset:1056
v_mfma_f32_16x16x32_bf16 v[32:35], a[132:135], a[100:103], v[32:35]
s_add_u32 m0, s11, s20
v_mfma_f32_16x16x32_bf16 v[52:55], a[132:135], a[104:107], v[52:55]
ds_read_b64_tr_b16 a[172:173], v246 offset:256
ds_read_b64_tr_b16 a[174:175], v246 offset:1280
v_mfma_f32_16x16x32_bf16 v[52:55], a[96:99], a[68:71], v[52:55]
buffer_load_dwordx4 v1, s[36:39], s9 offen offset:2048 sc1 lds
v_mfma_f32_16x16x32_bf16 v[48:51], a[92:95], a[68:71], v[48:51]
ds_read_b64_tr_b16 a[176:177], v246 offset:288
ds_read_b64_tr_b16 a[178:179], v246 offset:1312
v_mfma_f32_16x16x32_bf16 v[48:51], a[128:131], a[104:107], v[48:51]
v_mfma_f32_16x16x32_bf16 v[44:47], a[124:127], a[104:107], v[44:47]
s_add_u32 m0, s11, s21
v_mfma_f32_16x16x32_bf16 v[44:47], a[88:91], a[68:71], v[44:47]
ds_read_b64_tr_b16 a[180:181], v247 offset:0
ds_read_b64_tr_b16 a[182:183], v247 offset:256
v_mfma_f32_16x16x32_bf16 v[40:43], a[84:87], a[68:71], v[40:43]
buffer_load_dwordx4 v1, s[36:39], s9 offen offset:3072 sc1 lds
v_mfma_f32_16x16x32_bf16 v[40:43], a[120:123], a[104:107], v[40:43]
ds_read_b128 a[184:187], v245 offset:8192
ds_read_b128 a[188:191], v245 offset:9216
v_mfma_f32_16x16x32_bf16 v[36:39], a[116:119], a[104:107], v[36:39]
s_sub_u32 s11, s11, 36992
s_add_u32 m0, s11, 0
v_mfma_f32_16x16x32_bf16 v[36:39], a[80:83], a[68:71], v[36:39]
ds_read_b128 a[192:195], v245 offset:10240
ds_read_b128 a[196:199], v245 offset:11264
v_mfma_f32_16x16x32_bf16 v[56:59], a[80:83], a[72:75], v[56:59]
buffer_load_dwordx4 v240, s[44:47], s10 offen lds
v_mfma_f32_16x16x32_bf16 v[56:59], a[116:119], a[108:111], v[56:59]
ds_read_b64_tr_b16 a[200:201], v246 offset:10304
ds_read_b64_tr_b16 a[202:203], v246 offset:11328
v_mfma_f32_16x16x32_bf16 v[60:63], a[120:123], a[108:111], v[60:63]
v_mfma_f32_16x16x32_bf16 v[60:63], a[84:87], a[72:75], v[60:63]
s_add_u32 m0, s11, 1024
v_mfma_f32_16x16x32_bf16 v[64:67], a[88:91], a[72:75], v[64:67]
ds_read_b64_tr_b16 a[204:205], v246 offset:10336
ds_read_b64_tr_b16 a[206:207], v246 offset:11360
v_mfma_f32_16x16x32_bf16 v[64:67], a[124:127], a[108:111], v[64:67]
buffer_load_dwordx4 v241, s[44:47], s10 offen lds
v_mfma_f32_16x16x32_bf16 v[68:71], a[128:131], a[108:111], v[68:71]
ds_read_b64_tr_b16 a[208:209], v246 offset:10560
ds_read_b64_tr_b16 a[210:211], v246 offset:11584
v_mfma_f32_16x16x32_bf16 v[68:71], a[92:95], a[72:75], v[68:71]
s_add_u32 m0, s11, 2048
v_mfma_f32_16x16x32_bf16 v[72:75], a[96:99], a[72:75], v[72:75]
ds_read_b64_tr_b16 a[212:213], v246 offset:10592
ds_read_b64_tr_b16 a[214:215], v246 offset:11616
v_mfma_f32_16x16x32_bf16 v[72:75], a[132:135], a[108:111], v[72:75]
buffer_load_dwordx4 v242, s[44:47], s10 offen lds
v_mfma_f32_16x16x32_bf16 v[92:95], a[132:135], a[112:115], v[92:95]
ds_read_b64_tr_b16 a[216:217], v247 offset:10304
ds_read_b64_tr_b16 a[218:219], v247 offset:10560
v_mfma_f32_16x16x32_bf16 v[92:95], a[96:99], a[76:79], v[92:95]
s_add_u32 s9, s9, 16384
v_add_u32 v245, 0xffff6f80, v245
v_add_u32 v246, 0xffff6f80, v246
v_mfma_f32_16x16x32_bf16 v[88:91], a[92:95], a[76:79], v[88:91]
s_add_u32 m0, s11, 3072
v_mfma_f32_16x16x32_bf16 v[88:91], a[128:131], a[112:115], v[88:91]
buffer_load_dwordx4 v243, s[44:47], s10 offen lds
v_mfma_f32_16x16x32_bf16 v[84:87], a[124:127], a[112:115], v[84:87]
s_add_u32 s63, s63, 1
v_add_u32 v247, 0xffff6f80, v247
v_mfma_f32_16x16x32_bf16 v[84:87], a[88:91], a[76:79], v[84:87]
s_add_u32 m0, s11, 4096
v_mfma_f32_16x16x32_bf16 v[80:83], a[84:87], a[76:79], v[80:83]
buffer_load_dwordx4 v244, s[96:99], s10 offen sc1 lds
v_mfma_f32_16x16x32_bf16 v[80:83], a[120:123], a[112:115], v[80:83]
v_mfma_f32_16x16x32_bf16 v[76:79], a[116:119], a[112:115], v[76:79]
s_add_u32 s10, s10, 81920
s_cmp_lt_u32 s63, s77
v_mfma_f32_16x16x32_bf16 v[76:79], a[80:83], a[76:79], v[76:79]
s_waitcnt vmcnt(14) lgkmcnt(0)
s_barrier
s_cbranch_scc1 Lp4e
v_mfma_f32_16x16x32_bf16 v[36:39], a[164:167], a[152:155], v[36:39]
s_add_u32 m0, s11, s18
v_mfma_f32_16x16x32_bf16 v[36:39], a[200:203], a[188:191], v[36:39]
buffer_load_dwordx4 v1, s[36:39], s9 offen offset:0 sc1 lds
v_mfma_f32_16x16x32_bf16 v[40:43], a[204:207], a[188:191], v[40:43]
ds_read_b128 a[0:3], v245 offset:0
ds_read_b128 a[4:7], v245 offset:1024
v_mfma_f32_16x16x32_bf16 v[40:43], a[168:171], a[152:155], v[40:43]
s_add_u32 m0, s11, s19
v_mfma_f32_16x16x32_bf16 v[44:47], a[172:175], a[152:155], v[44:47]
buffer_load_dwordx4 v1, s[36:39], s9 offen offset:1024 sc1 lds
v_mfma_f32_16x16x32_bf16 v[44:47], a[208:211], a[188:191], v[44:47]
ds_read_b128 a[8:11], v245 offset:2048
ds_read_b128 a[12:15], v245 offset:3072
v_mfma_f32_16x16x32_bf16 v[48:51], a[212:215], a[188:191], v[48:51]
s_add_u32 m0, s11, s20
v_mfma_f32_16x16x32_bf16 v[48:51], a[176:179], a[152:155], v[48:51]
buffer_load_dwordx4 v1, s[36:39], s9 offen offset:2048 sc1 lds
v_mfma_f32_16x16x32_bf16 v[52:55], a[180:183], a[152:155], v[52:55]
ds_read_b64_tr_b16 a[16:17], v246 offset:0
ds_read_b64_tr_b16 a[18:19], v246 offset:1024
v_mfma_f32_16x16x32_bf16 v[52:55], a[216:219], a[188:191], v[52:55]
s_add_u32 m0, s11, s21
v_mfma_f32_16x16x32_bf16 v[72:75], a[216:219], a[192:195], v[72:75]
buffer_load_dwordx4 v1, s[36:39], s9 offen offset:3072 sc1 lds
v_mfma_f32_16x16x32_bf16 v[72:75], a[180:183], a[156:159], v[72:75]
ds_read_b64_tr_b16 a[20:21], v246 offset:32
ds_read_b64_tr_b16 a[22:23], v246 offset:1056
v_mfma_f32_16x16x32_bf16 v[68:71], a[176:179], a[156:159], v[68:71]
ds_read_b64_tr_b16 a[24:25], v246 offset:256
ds_read_b64_tr_b16 a[26:27], v246 offset:1280
v_mfma_f32_16x16x32_bf16 v[68:71], a[212:215], a[192:195], v[68:71]
ds_read_b64_tr_b16 a[28:29], v246 offset:288
ds_read_b64_tr_b16 a[30:31], v246 offset:1312
v_mfma_f32_16x16x32_bf16 v[64:67], a[208:211], a[192:195], v[64:67]
v_mfma_f32_16x16x32_bf16 v[64:67], a[172:175], a[156:159], v[64:67]
ds_read_b64_tr_b16 a[32:33], v247 offset:0
ds_read_b64_tr_b16 a[34:35], v247 offset:256
v_mfma_f32_16x16x32_bf16 v[60:63], a[168:171], a[156:159], v[60:63]
ds_read_b128 a[36:39], v245 offset:8192
ds_read_b128 a[40:43], v245 offset:9216
v_mfma_f32_16x16x32_bf16 v[60:63], a[204:207], a[192:195], v[60:63]
ds_read_b128 a[44:47], v245 offset:10240
ds_read_b128 a[48:51], v245 offset:11264
v_mfma_f32_16x16x32_bf16 v[56:59], a[200:203], a[192:195], v[56:59]
v_mfma_f32_16x16x32_bf16 v[56:59], a[164:167], a[156:159], v[56:59]
ds_read_b64_tr_b16 a[52:53], v246 offset:10304
ds_read_b64_tr_b16 a[54:55], v246 offset:11328
v_mfma_f32_16x16x32_bf16 v[76:79], a[164:167], a[160:163], v[76:79]
ds_read_b64_tr_b16 a[56:57], v246 offset:10336
ds_read_b64_tr_b16 a[58:59], v246 offset:11360
v_mfma_f32_16x16x32_bf16 v[76:79], a[200:203], a[196:199], v[76:79]
ds_read_b64_tr_b16 a[60:61], v246 offset:10560
ds_read_b64_tr_b16 a[62:63], v246 offset:11584
v_mfma_f32_16x16x32_bf16 v[80:83], a[204:207], a[196:199], v[80:83]
v_mfma_f32_16x16x32_bf16 v[80:83], a[168:171], a[160:163], v[80:83]
ds_read_b64_tr_b16 a[64:65], v246 offset:10592
ds_read_b64_tr_b16 a[66:67], v246 offset:11616
v_mfma_f32_16x16x32_bf16 v[84:87], a[172:175], a[160:163], v[84:87]
ds_read_b64_tr_b16 a[68:69], v247 offset:10304
ds_read_b64_tr_b16 a[70:71], v247 offset:10560
v_mfma_f32_16x16x32_bf16 v[84:87], a[208:211], a[196:199], v[84:87]
v_mfma_f32_16x16x32_bf16 v[88:91], a[212:215], a[196:199], v[88:91]
v_add_u32 v245, s74, v245
v_add_u32 v246, s74, v246
v_mfma_f32_16x16x32_bf16 v[88:91], a[176:179], a[160:163], v[88:91]
v_add_u32 v247, s74, v247
v_mfma_f32_16x16x32_bf16 v[92:95], a[180:183], a[160:163], v[92:95]
v_mfma_f32_16x16x32_bf16 v[92:95], a[216:219], a[196:199], v[92:95]
s_waitcnt vmcnt(9) lgkmcnt(0)
s_barrier
v_mfma_f32_16x16x32_bf16 v[52:55], a[68:71], a[40:43], v[52:55]
ds_read_b128 a[72:75], v245 offset:0
ds_read_b128 a[76:79], v245 offset:1024
v_mfma_f32_16x16x32_bf16 v[52:55], a[32:35], a[4:7], v[52:55]
ds_read_b128 a[80:83], v245 offset:2048
ds_read_b128 a[84:87], v245 offset:3072
v_mfma_f32_16x16x32_bf16 v[48:51], a[28:31], a[4:7], v[48:51]
s_add_u32 s32, s28, 0x3c00000
s_addc_u32 s33, s29, 0
s_mov_b32 s34, 0xc00000
v_mfma_f32_16x16x32_bf16 v[48:51], a[64:67], a[40:43], v[48:51]
ds_read_b64_tr_b16 a[88:89], v246 offset:0
ds_read_b64_tr_b16 a[90:91], v246 offset:1024
v_mfma_f32_16x16x32_bf16 v[44:47], a[60:63], a[40:43], v[44:47]
ds_read_b64_tr_b16 a[92:93], v246 offset:32
ds_read_b64_tr_b16 a[94:95], v246 offset:1056
v_mfma_f32_16x16x32_bf16 v[44:47], a[24:27], a[4:7], v[44:47]
s_mov_b32 s35, 0x20000
s_mov_b32 s40, s24
s_mov_b32 s41, s25
v_mfma_f32_16x16x32_bf16 v[40:43], a[20:23], a[4:7], v[40:43]
ds_read_b64_tr_b16 a[96:97], v246 offset:256
ds_read_b64_tr_b16 a[98:99], v246 offset:1280
v_mfma_f32_16x16x32_bf16 v[40:43], a[56:59], a[40:43], v[40:43]
ds_read_b64_tr_b16 a[100:101], v246 offset:288
ds_read_b64_tr_b16 a[102:103], v246 offset:1312
v_mfma_f32_16x16x32_bf16 v[36:39], a[52:55], a[40:43], v[36:39]
s_mov_b32 s42, 0x280000
s_mov_b32 s43, 0x20000
s_add_u32 s52, s17, s30
v_mfma_f32_16x16x32_bf16 v[36:39], a[16:19], a[4:7], v[36:39]
ds_read_b64_tr_b16 a[104:105], v247 offset:0
ds_read_b64_tr_b16 a[106:107], v247 offset:256
v_mfma_f32_16x16x32_bf16 v[56:59], a[16:19], a[8:11], v[56:59]
ds_read_b128 a[108:111], v245 offset:8192
ds_read_b128 a[112:115], v245 offset:9216
v_mfma_f32_16x16x32_bf16 v[56:59], a[52:55], a[44:47], v[56:59]
s_mul_i32 s65, s52, 12288
s_add_u32 s66, s65, 4096
s_add_u32 s67, s65, 8192
v_mfma_f32_16x16x32_bf16 v[60:63], a[56:59], a[44:47], v[60:63]
ds_read_b128 a[116:119], v245 offset:10240
ds_read_b128 a[120:123], v245 offset:11264
v_mfma_f32_16x16x32_bf16 v[60:63], a[20:23], a[8:11], v[60:63]
ds_read_b64_tr_b16 a[124:125], v246 offset:10304
ds_read_b64_tr_b16 a[126:127], v246 offset:11328
v_mfma_f32_16x16x32_bf16 v[64:67], a[24:27], a[8:11], v[64:67]
s_xor_b32 s53, s52, 4
s_mul_i32 s53, s53, 12288
s_add_u32 s68, s53, 0
v_mfma_f32_16x16x32_bf16 v[64:67], a[60:63], a[44:47], v[64:67]
ds_read_b64_tr_b16 a[128:129], v246 offset:10336
ds_read_b64_tr_b16 a[130:131], v246 offset:11360
v_mfma_f32_16x16x32_bf16 v[68:71], a[64:67], a[44:47], v[68:71]
ds_read_b64_tr_b16 a[132:133], v246 offset:10560
ds_read_b64_tr_b16 a[134:135], v246 offset:11584
v_mfma_f32_16x16x32_bf16 v[68:71], a[28:31], a[8:11], v[68:71]
s_add_u32 s71, s53, 8192
s_xor_b32 s53, s52, 8
s_mul_i32 s53, s53, 12288
v_mfma_f32_16x16x32_bf16 v[72:75], a[32:35], a[8:11], v[72:75]
ds_read_b64_tr_b16 a[136:137], v246 offset:10592
ds_read_b64_tr_b16 a[138:139], v246 offset:11616
v_mfma_f32_16x16x32_bf16 v[72:75], a[68:71], a[44:47], v[72:75]
ds_read_b64_tr_b16 a[140:141], v247 offset:10304
ds_read_b64_tr_b16 a[142:143], v247 offset:10560
v_mfma_f32_16x16x32_bf16 v[92:95], a[68:71], a[48:51], v[92:95]
s_add_u32 s69, s53, 4096
s_add_u32 s72, s53, 8192
s_xor_b32 s53, s52, 12
v_mfma_f32_16x16x32_bf16 v[92:95], a[32:35], a[12:15], v[92:95]
s_mul_i32 s53, s53, 12288
s_add_u32 s70, s53, 8192
s_add_u32 s73, s53, 8192
v_mfma_f32_16x16x32_bf16 v[88:91], a[28:31], a[12:15], v[88:91]
s_and_b32 s79, s30, 1
s_lshl_b32 s78, s79, 7
s_lshl_b32 s79, s79, 5
v_mfma_f32_16x16x32_bf16 v[88:91], a[64:67], a[48:51], v[88:91]
s_bitcmp1_b32 s8, 0
s_cselect_b32 s54, 64, 0
s_cselect_b32 s55, 0, 0x100
v_mfma_f32_16x16x32_bf16 v[84:87], a[60:63], a[48:51], v[84:87]
v_add_u32 v245, 0xffff6f80, v245
v_add_u32 v246, 0xffff6f80, v246
v_mfma_f32_16x16x32_bf16 v[84:87], a[24:27], a[12:15], v[84:87]
v_add_u32 v247, 0xffff6f80, v247
v_lshlrev_b32 v6, 3, v0
v_mfma_f32_16x16x32_bf16 v[80:83], a[20:23], a[12:15], v[80:83]
s_add_u32 s78, s78, s54
s_add_u32 s79, s79, s55
s_sub_u32 s79, s79, 128
v_mfma_f32_16x16x32_bf16 v[80:83], a[56:59], a[48:51], v[80:83]
v_mfma_f32_16x16x32_bf16 v[76:79], a[52:55], a[48:51], v[76:79]
v_mfma_f32_16x16x32_bf16 v[76:79], a[16:19], a[12:15], v[76:79]
s_waitcnt vmcnt(0) lgkmcnt(0)
s_barrier
v_mfma_f32_16x16x32_bf16 v[36:39], a[88:91], a[76:79], v[36:39]
ds_read_b64_tr_b16 v[112:113], v246 offset:0
ds_read_b64_tr_b16 v[114:115], v246 offset:1024
v_mfma_f32_16x16x32_bf16 v[36:39], a[124:127], a[112:115], v[36:39]
ds_read_b64_tr_b16 v[148:149], v246 offset:10304
ds_read_b64_tr_b16 v[150:151], v246 offset:11328
v_mfma_f32_16x16x32_bf16 v[40:43], a[128:131], a[112:115], v[40:43]
ds_read_b128 v[96:99], v245 offset:0
ds_read_b128 v[100:103], v245 offset:1024
v_mfma_f32_16x16x32_bf16 v[40:43], a[92:95], a[76:79], v[40:43]
ds_read_b128 v[132:135], v245 offset:8192
ds_read_b128 v[136:139], v245 offset:9216
v_mfma_f32_16x16x32_bf16 v[44:47], a[96:99], a[76:79], v[44:47]
v_mfma_f32_16x16x32_bf16 v[44:47], a[132:135], a[112:115], v[44:47]
ds_read_b64_tr_b16 v[116:117], v246 offset:32
ds_read_b64_tr_b16 v[118:119], v246 offset:1056
v_mfma_f32_16x16x32_bf16 v[48:51], a[136:139], a[112:115], v[48:51]
ds_read_b64_tr_b16 v[152:153], v246 offset:10336
ds_read_b64_tr_b16 v[154:155], v246 offset:11360
v_mfma_f32_16x16x32_bf16 v[48:51], a[100:103], a[76:79], v[48:51]
ds_read_b64_tr_b16 v[120:121], v246 offset:256
ds_read_b64_tr_b16 v[122:123], v246 offset:1280
v_mfma_f32_16x16x32_bf16 v[52:55], a[104:107], a[76:79], v[52:55]
ds_read_b64_tr_b16 v[156:157], v246 offset:10560
ds_read_b64_tr_b16 v[158:159], v246 offset:11584
v_mfma_f32_16x16x32_bf16 v[52:55], a[140:143], a[112:115], v[52:55]
v_mfma_f32_16x16x32_bf16 v[72:75], a[140:143], a[116:119], v[72:75]
ds_read_b64_tr_b16 v[124:125], v246 offset:288
ds_read_b64_tr_b16 v[126:127], v246 offset:1312
v_mfma_f32_16x16x32_bf16 v[72:75], a[104:107], a[80:83], v[72:75]
ds_read_b64_tr_b16 v[160:161], v246 offset:10592
ds_read_b64_tr_b16 v[162:163], v246 offset:11616
v_mfma_f32_16x16x32_bf16 v[68:71], a[100:103], a[80:83], v[68:71]
ds_read_b64_tr_b16 v[128:129], v247 offset:0
ds_read_b64_tr_b16 v[130:131], v247 offset:256
v_mfma_f32_16x16x32_bf16 v[68:71], a[136:139], a[116:119], v[68:71]
ds_read_b64_tr_b16 v[164:165], v247 offset:10304
ds_read_b64_tr_b16 v[166:167], v247 offset:10560
v_mfma_f32_16x16x32_bf16 v[64:67], a[132:135], a[116:119], v[64:67]
v_mfma_f32_16x16x32_bf16 v[64:67], a[96:99], a[80:83], v[64:67]
ds_read_b128 v[104:107], v245 offset:2048
ds_read_b128 v[108:111], v245 offset:3072
v_mfma_f32_16x16x32_bf16 v[60:63], a[92:95], a[80:83], v[60:63]
ds_read_b128 v[140:143], v245 offset:10240
ds_read_b128 v[144:147], v245 offset:11264
v_mfma_f32_16x16x32_bf16 v[60:63], a[128:131], a[116:119], v[60:63]
v_mfma_f32_16x16x32_bf16 v[56:59], a[124:127], a[116:119], v[56:59]
v_mfma_f32_16x16x32_bf16 v[56:59], a[88:91], a[80:83], v[56:59]
s_waitcnt lgkmcnt(4)
v_mfma_f32_16x16x32_bf16 v[36:39], v[112:115], v[100:103], v[36:39]
v_mfma_f32_16x16x32_bf16 v[36:39], v[148:151], v[136:139], v[36:39]
v_mfma_f32_16x16x32_bf16 v[40:43], v[152:155], v[136:139], v[40:43]
v_mfma_f32_16x16x32_bf16 v[40:43], v[116:119], v[100:103], v[40:43]
v_mfma_f32_16x16x32_bf16 v[44:47], v[120:123], v[100:103], v[44:47]
s_waitcnt lgkmcnt(0)
v_mfma_f32_16x16x32_bf16 v[44:47], v[156:159], v[136:139], v[44:47]
v_mfma_f32_16x16x32_bf16 v[48:51], v[160:163], v[136:139], v[48:51]
v_mfma_f32_16x16x32_bf16 v[48:51], v[124:127], v[100:103], v[48:51]
v_mfma_f32_16x16x32_bf16 v[52:55], v[128:131], v[100:103], v[52:55]
v_mfma_f32_16x16x32_bf16 v[52:55], v[164:167], v[136:139], v[52:55]
v_cvt_pk_bf16_f32 v168, v36, v37
v_cvt_pk_bf16_f32 v169, v38, v39
v_mfma_f32_16x16x32_bf16 v[72:75], v[164:167], v[140:143], v[72:75]
v_min_u32 v168, -2, v168
v_min_u32 v169, -2, v169
v_mfma_f32_16x16x32_bf16 v[72:75], v[128:131], v[104:107], v[72:75]
v_cvt_pk_bf16_f32 v170, v40, v41
v_cvt_pk_bf16_f32 v171, v42, v43
v_mfma_f32_16x16x32_bf16 v[68:71], v[124:127], v[104:107], v[68:71]
v_min_u32 v170, -2, v170
v_min_u32 v171, -2, v171
v_mfma_f32_16x16x32_bf16 v[68:71], v[160:163], v[140:143], v[68:71]
buffer_store_dwordx4 v[168:171], v1, s[32:35], s65 offen sc1
v_mfma_f32_16x16x32_bf16 v[64:67], v[156:159], v[140:143], v[64:67]
v_cvt_pk_bf16_f32 v172, v44, v45
v_cvt_pk_bf16_f32 v173, v46, v47
v_mfma_f32_16x16x32_bf16 v[64:67], v[120:123], v[104:107], v[64:67]
v_min_u32 v172, -2, v172
v_min_u32 v173, -2, v173
v_mfma_f32_16x16x32_bf16 v[60:63], v[116:119], v[104:107], v[60:63]
v_cvt_pk_bf16_f32 v174, v48, v49
v_cvt_pk_bf16_f32 v175, v50, v51
v_mfma_f32_16x16x32_bf16 v[60:63], v[152:155], v[140:143], v[60:63]
v_min_u32 v174, -2, v174
v_min_u32 v175, -2, v175
v_mfma_f32_16x16x32_bf16 v[56:59], v[148:151], v[140:143], v[56:59]
buffer_store_dwordx4 v[172:175], v1, s[32:35], s65 offen offset:1024 sc1
v_mfma_f32_16x16x32_bf16 v[56:59], v[112:115], v[104:107], v[56:59]
v_cvt_pk_bf16_f32 v176, v52, v53
v_cvt_pk_bf16_f32 v177, v54, v55
v_mfma_f32_16x16x32_bf16 v[76:79], a[88:91], a[84:87], v[76:79]
v_min_u32 v176, -2, v176
v_min_u32 v177, -2, v177
v_mfma_f32_16x16x32_bf16 v[76:79], a[124:127], a[120:123], v[76:79]
buffer_store_dwordx2 v[176:177], v6, s[32:35], s67 offen offset:2048 sc1
v_mfma_f32_16x16x32_bf16 v[80:83], a[128:131], a[120:123], v[80:83]
v_cvt_pk_bf16_f32 v188, v72, v73
v_cvt_pk_bf16_f32 v189, v74, v75
v_mfma_f32_16x16x32_bf16 v[80:83], a[92:95], a[84:87], v[80:83]
v_min_u32 v188, -2, v188
v_min_u32 v189, -2, v189
v_mfma_f32_16x16x32_bf16 v[84:87], a[96:99], a[84:87], v[84:87]
buffer_store_dwordx2 v[188:189], v6, s[32:35], s67 offen offset:2560 sc1
v_mfma_f32_16x16x32_bf16 v[84:87], a[132:135], a[120:123], v[84:87]
v_cvt_pk_bf16_f32 v186, v68, v69
v_cvt_pk_bf16_f32 v187, v70, v71
v_mfma_f32_16x16x32_bf16 v[88:91], a[136:139], a[120:123], v[88:91]
v_min_u32 v186, -2, v186
v_min_u32 v187, -2, v187
v_mfma_f32_16x16x32_bf16 v[88:91], a[100:103], a[84:87], v[88:91]
v_cvt_pk_bf16_f32 v184, v64, v65
v_cvt_pk_bf16_f32 v185, v66, v67
v_mfma_f32_16x16x32_bf16 v[92:95], a[104:107], a[84:87], v[92:95]
v_min_u32 v184, -2, v184
v_min_u32 v185, -2, v185
v_mfma_f32_16x16x32_bf16 v[92:95], a[140:143], a[120:123], v[92:95]
buffer_store_dwordx4 v[184:187], v1, s[32:35], s66 offen offset:1024 sc1
v_mfma_f32_16x16x32_bf16 v[92:95], v[164:167], v[144:147], v[92:95]
v_cvt_pk_bf16_f32 v182, v60, v61
v_cvt_pk_bf16_f32 v183, v62, v63
v_mfma_f32_16x16x32_bf16 v[92:95], v[128:131], v[108:111], v[92:95]
v_min_u32 v182, -2, v182
v_min_u32 v183, -2, v183
v_mfma_f32_16x16x32_bf16 v[88:91], v[124:127], v[108:111], v[88:91]
v_cvt_pk_bf16_f32 v180, v56, v57
v_cvt_pk_bf16_f32 v181, v58, v59
v_mfma_f32_16x16x32_bf16 v[88:91], v[160:163], v[144:147], v[88:91]
v_min_u32 v180, -2, v180
v_min_u32 v181, -2, v181
v_mfma_f32_16x16x32_bf16 v[84:87], v[156:159], v[144:147], v[84:87]
buffer_store_dwordx4 v[180:183], v1, s[32:35], s66 offen sc1
v_mfma_f32_16x16x32_bf16 v[84:87], v[120:123], v[108:111], v[84:87]
v_mfma_f32_16x16x32_bf16 v[80:83], v[116:119], v[108:111], v[80:83]
v_mfma_f32_16x16x32_bf16 v[80:83], v[152:155], v[144:147], v[80:83]
v_mfma_f32_16x16x32_bf16 v[76:79], v[148:151], v[144:147], v[76:79]
v_mfma_f32_16x16x32_bf16 v[76:79], v[112:115], v[108:111], v[76:79]
v_cvt_pk_bf16_f32 v200, v92, v93
v_cvt_pk_bf16_f32 v201, v94, v95
v_mfma_f32_16x16x32_bf16 v[16:19], a[164:167], a[148:151], v[16:19]
v_min_u32 v200, -2, v200
v_min_u32 v201, -2, v201
v_mfma_f32_16x16x32_bf16 v[16:19], a[200:203], a[184:187], v[16:19]
buffer_store_dwordx2 v[200:201], v6, s[32:35], s67 offen offset:3072 sc1
v_mfma_f32_16x16x32_bf16 v[16:19], a[16:19], a[0:3], v[16:19]
v_cvt_pk_bf16_f32 v198, v88, v89
v_cvt_pk_bf16_f32 v199, v90, v91
v_mfma_f32_16x16x32_bf16 v[16:19], a[52:55], a[36:39], v[16:19]
v_min_u32 v198, -2, v198
v_min_u32 v199, -2, v199
v_mfma_f32_16x16x32_bf16 v[16:19], a[88:91], a[72:75], v[16:19]
v_cvt_pk_bf16_f32 v196, v84, v85
v_cvt_pk_bf16_f32 v197, v86, v87
v_mfma_f32_16x16x32_bf16 v[16:19], a[124:127], a[108:111], v[16:19]
v_min_u32 v196, -2, v196
v_min_u32 v197, -2, v197
v_mfma_f32_16x16x32_bf16 v[16:19], v[112:115], v[96:99], v[16:19]
buffer_store_dwordx4 v[196:199], v1, s[32:35], s67 offen offset:1024 sc1
v_mfma_f32_16x16x32_bf16 v[16:19], v[148:151], v[132:135], v[16:19]
v_cvt_pk_bf16_f32 v194, v80, v81
v_cvt_pk_bf16_f32 v195, v82, v83
v_mfma_f32_16x16x32_bf16 v[20:23], v[152:155], v[132:135], v[20:23]
v_min_u32 v194, -2, v194
v_min_u32 v195, -2, v195
v_mfma_f32_16x16x32_bf16 v[20:23], v[116:119], v[96:99], v[20:23]
v_cvt_pk_bf16_f32 v192, v76, v77
v_cvt_pk_bf16_f32 v193, v78, v79
v_mfma_f32_16x16x32_bf16 v[20:23], a[128:131], a[108:111], v[20:23]
v_min_u32 v192, -2, v192
v_min_u32 v193, -2, v193
v_mfma_f32_16x16x32_bf16 v[20:23], a[92:95], a[72:75], v[20:23]
buffer_store_dwordx4 v[192:195], v1, s[32:35], s67 offen sc1
v_mfma_f32_16x16x32_bf16 v[20:23], a[56:59], a[36:39], v[20:23]
v_accvgpr_read_b32 v205, a230
v_lshlrev_b32 v204, 16, v205
v_mfma_f32_16x16x32_bf16 v[20:23], a[20:23], a[0:3], v[20:23]
v_and_b32 v205, 0xffff0000, v205
v_accvgpr_read_b32 v207, a231
v_mfma_f32_16x16x32_bf16 v[20:23], a[204:207], a[184:187], v[20:23]
v_lshlrev_b32 v206, 16, v207
v_and_b32 v207, 0xffff0000, v207
v_mfma_f32_16x16x32_bf16 v[20:23], a[168:171], a[148:151], v[20:23]
v_accvgpr_read_b32 v209, a232
v_lshlrev_b32 v208, 16, v209
v_mfma_f32_16x16x32_bf16 v[24:27], a[172:175], a[148:151], v[24:27]
v_and_b32 v209, 0xffff0000, v209
v_accvgpr_read_b32 v211, a233
v_mfma_f32_16x16x32_bf16 v[24:27], a[208:211], a[184:187], v[24:27]
v_lshlrev_b32 v210, 16, v211
v_and_b32 v211, 0xffff0000, v211
v_mfma_f32_16x16x32_bf16 v[24:27], a[24:27], a[0:3], v[24:27]
v_accvgpr_read_b32 v213, a234
v_lshlrev_b32 v212, 16, v213
v_mfma_f32_16x16x32_bf16 v[24:27], a[60:63], a[36:39], v[24:27]
v_and_b32 v213, 0xffff0000, v213
v_accvgpr_read_b32 v215, a235
v_mfma_f32_16x16x32_bf16 v[24:27], a[96:99], a[72:75], v[24:27]
v_lshlrev_b32 v214, 16, v215
v_and_b32 v215, 0xffff0000, v215
v_mfma_f32_16x16x32_bf16 v[24:27], a[132:135], a[108:111], v[24:27]
v_accvgpr_read_b32 v217, a236
v_lshlrev_b32 v216, 16, v217
v_mfma_f32_16x16x32_bf16 v[24:27], v[120:123], v[96:99], v[24:27]
v_and_b32 v217, 0xffff0000, v217
v_accvgpr_read_b32 v219, a237
v_mfma_f32_16x16x32_bf16 v[24:27], v[156:159], v[132:135], v[24:27]
v_lshlrev_b32 v218, 16, v219
v_and_b32 v219, 0xffff0000, v219
v_mfma_f32_16x16x32_bf16 v[28:31], v[160:163], v[132:135], v[28:31]
v_accvgpr_read_b32 v221, a238
v_lshlrev_b32 v220, 16, v221
v_mfma_f32_16x16x32_bf16 v[28:31], v[124:127], v[96:99], v[28:31]
v_and_b32 v221, 0xffff0000, v221
v_accvgpr_read_b32 v223, a239
v_mfma_f32_16x16x32_bf16 v[28:31], a[136:139], a[108:111], v[28:31]
v_lshlrev_b32 v222, 16, v223
v_and_b32 v223, 0xffff0000, v223
v_mfma_f32_16x16x32_bf16 v[28:31], a[100:103], a[72:75], v[28:31]
v_and_b32 v5, 15, v0
v_mul_u32_u24 v5, 176, v5
v_mfma_f32_16x16x32_bf16 v[28:31], a[64:67], a[36:39], v[28:31]
v_lshrrev_b32 v10, 4, v0
v_lshl_add_u32 v5, v10, 3, v5
v_mfma_f32_16x16x32_bf16 v[28:31], a[28:31], a[0:3], v[28:31]
v_mov_b32 v12, s78
v_mov_b32 v13, s79
v_mfma_f32_16x16x32_bf16 v[28:31], a[212:215], a[184:187], v[28:31]
v_mov_b32 v11, 2816
v_mul_u32_u24 v11, s30, v11
v_mfma_f32_16x16x32_bf16 v[28:31], a[176:179], a[148:151], v[28:31]
v_add_u32 v5, v11, v5
v_add_u32 v10, 0, v0
v_mfma_f32_16x16x32_bf16 v[32:35], a[180:183], a[148:151], v[32:35]
v_mul_u32_u24 v7, 6554, v10
v_lshrrev_b32 v7, 16, v7
v_mfma_f32_16x16x32_bf16 v[32:35], a[216:219], a[184:187], v[32:35]
v_mul_u32_u24 v9, 10, v7
v_sub_u32 v10, v10, v9
v_mfma_f32_16x16x32_bf16 v[32:35], a[32:35], a[0:3], v[32:35]
v_lshlrev_b32 v10, 4, v10
v_cmp_gt_u32 vcc, 128, v10
v_mfma_f32_16x16x32_bf16 v[32:35], a[68:71], a[36:39], v[32:35]
v_mul_u32_u24 v9, 1280, v7
v_add_u32 v9, v9, v10
v_mfma_f32_16x16x32_bf16 v[32:35], a[104:107], a[72:75], v[32:35]
v_cndmask_b32 v8, v13, v12, vcc
v_add_u32 v224, v9, v8
v_mfma_f32_16x16x32_bf16 v[32:35], a[140:143], a[108:111], v[32:35]
v_mul_u32_u24 v9, 176, v7
v_add3_u32 v228, v9, v10, v11
v_mfma_f32_16x16x32_bf16 v[32:35], v[128:131], v[96:99], v[32:35]
v_add_u32 v10, 64, v0
v_mul_u32_u24 v7, 6554, v10
v_mfma_f32_16x16x32_bf16 v[32:35], v[164:167], v[132:135], v[32:35]
v_lshrrev_b32 v7, 16, v7
v_mul_u32_u24 v9, 10, v7
v_sub_u32 v10, v10, v9
v_lshlrev_b32 v10, 4, v10
v_cmp_gt_u32 vcc, 128, v10
v_mul_u32_u24 v9, 1280, v7
v_add_u32 v9, v9, v10
v_cndmask_b32 v8, v13, v12, vcc
v_add_u32 v225, v9, v8
v_mul_u32_u24 v9, 176, v7
v_add3_u32 v229, v9, v10, v11
v_add_u32 v10, 128, v0
v_min_u32 v10, 159, v10
v_mul_u32_u24 v7, 6554, v10
v_lshrrev_b32 v7, 16, v7
v_mul_u32_u24 v9, 10, v7
v_sub_u32 v10, v10, v9
v_lshlrev_b32 v10, 4, v10
v_cmp_gt_u32 vcc, 128, v10
v_mul_u32_u24 v9, 1280, v7
v_add_u32 v9, v9, v10
v_cndmask_b32 v8, v13, v12, vcc
v_add_u32 v226, v9, v8
v_mul_u32_u24 v9, 176, v7
v_add3_u32 v230, v9, v10, v11
s_nop 7
v_pk_add_f32 v[16:17], v[16:17], v[204:205]
v_pk_add_f32 v[18:19], v[18:19], v[206:207]
v_pk_add_f32 v[20:21], v[20:21], v[208:209]
v_pk_add_f32 v[22:23], v[22:23], v[210:211]
v_pk_add_f32 v[24:25], v[24:25], v[212:213]
v_pk_add_f32 v[26:27], v[26:27], v[214:215]
v_pk_add_f32 v[28:29], v[28:29], v[216:217]
v_pk_add_f32 v[30:31], v[30:31], v[218:219]
v_pk_add_f32 v[32:33], v[32:33], v[220:221]
v_pk_add_f32 v[34:35], v[34:35], v[222:223]
s_mov_b32 s55, 0x200000
s_waitcnt vmcnt(6)
Lfx_ld:
buffer_load_dwordx4 v[96:99], v1, s[32:35], s68 offen sc1
buffer_load_dwordx4 v[100:103], v1, s[32:35], s68 offen offset:1024 sc1
buffer_load_dwordx2 v[104:105], v6, s[32:35], s71 offen offset:2048 sc1
buffer_load_dwordx4 v[108:111], v1, s[32:35], s69 offen sc1
buffer_load_dwordx4 v[112:115], v1, s[32:35], s69 offen offset:1024 sc1
buffer_load_dwordx2 v[116:117], v6, s[32:35], s72 offen offset:2560 sc1
buffer_load_dwordx4 v[120:123], v1, s[32:35], s70 offen sc1
buffer_load_dwordx4 v[124:127], v1, s[32:35], s70 offen offset:1024 sc1
buffer_load_dwordx2 v[128:129], v6, s[32:35], s73 offen offset:3072 sc1
s_waitcnt vmcnt(6)
v_max_u32 v12, v96, v97
v_max3_u32 v12, v12, v98, v99
v_max3_u32 v12, v12, v100, v101
v_max3_u32 v12, v12, v102, v103
v_max3_u32 v12, v12, v104, v105
v_lshlrev_b32 v136, 16, v96
v_and_b32 v137, 0xffff0000, v96
v_lshlrev_b32 v138, 16, v97
v_and_b32 v139, 0xffff0000, v97
v_lshlrev_b32 v140, 16, v98
v_and_b32 v141, 0xffff0000, v98
v_lshlrev_b32 v142, 16, v99
v_and_b32 v143, 0xffff0000, v99
v_lshlrev_b32 v144, 16, v100
v_and_b32 v145, 0xffff0000, v100
v_pk_add_f32 v[60:61], v[16:17], v[136:137]
v_pk_add_f32 v[62:63], v[18:19], v[138:139]
v_pk_add_f32 v[64:65], v[20:21], v[140:141]
v_pk_add_f32 v[66:67], v[22:23], v[142:143]
v_pk_add_f32 v[68:69], v[24:25], v[144:145]
v_lshlrev_b32 v136, 16, v101
v_and_b32 v137, 0xffff0000, v101
v_lshlrev_b32 v138, 16, v102
v_and_b32 v139, 0xffff0000, v102
v_lshlrev_b32 v140, 16, v103
v_and_b32 v141, 0xffff0000, v103
v_lshlrev_b32 v142, 16, v104
v_and_b32 v143, 0xffff0000, v104
v_lshlrev_b32 v144, 16, v105
v_and_b32 v145, 0xffff0000, v105
v_pk_add_f32 v[70:71], v[26:27], v[136:137]
v_pk_add_f32 v[72:73], v[28:29], v[138:139]
v_pk_add_f32 v[74:75], v[30:31], v[140:141]
v_pk_add_f32 v[76:77], v[32:33], v[142:143]
v_pk_add_f32 v[78:79], v[34:35], v[144:145]
s_waitcnt vmcnt(3)
v_max3_u32 v12, v12, v108, v109
v_max3_u32 v12, v12, v110, v111
v_max3_u32 v12, v12, v112, v113
v_max3_u32 v12, v12, v114, v115
v_max3_u32 v12, v12, v116, v117
v_lshlrev_b32 v136, 16, v108
v_and_b32 v137, 0xffff0000, v108
v_lshlrev_b32 v138, 16, v109
v_and_b32 v139, 0xffff0000, v109
v_lshlrev_b32 v140, 16, v110
v_and_b32 v141, 0xffff0000, v110
v_lshlrev_b32 v142, 16, v111
v_and_b32 v143, 0xffff0000, v111
v_lshlrev_b32 v144, 16, v112
v_and_b32 v145, 0xffff0000, v112
v_pk_add_f32 v[60:61], v[60:61], v[136:137]
v_pk_add_f32 v[62:63], v[62:63], v[138:139]
v_pk_add_f32 v[64:65], v[64:65], v[140:141]
v_pk_add_f32 v[66:67], v[66:67], v[142:143]
v_pk_add_f32 v[68:69], v[68:69], v[144:145]
v_lshlrev_b32 v136, 16, v113
v_and_b32 v137, 0xffff0000, v113
v_lshlrev_b32 v138, 16, v114
v_and_b32 v139, 0xffff0000, v114
v_lshlrev_b32 v140, 16, v115
v_and_b32 v141, 0xffff0000, v115
v_lshlrev_b32 v142, 16, v116
v_and_b32 v143, 0xffff0000, v116
v_lshlrev_b32 v144, 16, v117
v_and_b32 v145, 0xffff0000, v117
v_pk_add_f32 v[70:71], v[70:71], v[136:137]
v_pk_add_f32 v[72:73], v[72:73], v[138:139]
v_pk_add_f32 v[74:75], v[74:75], v[140:141]
v_pk_add_f32 v[76:77], v[76:77], v[142:143]
v_pk_add_f32 v[78:79], v[78:79], v[144:145]
s_waitcnt vmcnt(0)
v_max3_u32 v12, v12, v120, v121
v_max3_u32 v12, v12, v122, v123
v_max3_u32 v12, v12, v124, v125
v_max3_u32 v12, v12, v126, v127
v_max3_u32 v12, v12, v128, v129
v_cmp_eq_u32 vcc, -1, v12
s_sub_u32 s55, s55, 1
s_cbranch_scc1 Lfx_ok
s_cbranch_vccnz Lfx_ld
Lfx_ok:
v_lshlrev_b32 v136, 16, v120
v_and_b32 v137, 0xffff0000, v120
v_lshlrev_b32 v138, 16, v121
v_and_b32 v139, 0xffff0000, v121
v_lshlrev_b32 v140, 16, v122
v_and_b32 v141, 0xffff0000, v122
v_lshlrev_b32 v142, 16, v123
v_and_b32 v143, 0xffff0000, v123
v_lshlrev_b32 v144, 16, v124
v_and_b32 v145, 0xffff0000, v124
v_pk_add_f32 v[16:17], v[60:61], v[136:137]
v_pk_add_f32 v[18:19], v[62:63], v[138:139]
v_pk_add_f32 v[20:21], v[64:65], v[140:141]
v_pk_add_f32 v[22:23], v[66:67], v[142:143]
v_pk_add_f32 v[24:25], v[68:69], v[144:145]
v_lshlrev_b32 v136, 16, v125
v_and_b32 v137, 0xffff0000, v125
v_lshlrev_b32 v138, 16, v126
v_and_b32 v139, 0xffff0000, v126
v_lshlrev_b32 v140, 16, v127
v_and_b32 v141, 0xffff0000, v127
v_lshlrev_b32 v142, 16, v128
v_and_b32 v143, 0xffff0000, v128
v_lshlrev_b32 v144, 16, v129
v_and_b32 v145, 0xffff0000, v129
v_pk_add_f32 v[26:27], v[70:71], v[136:137]
v_pk_add_f32 v[28:29], v[72:73], v[138:139]
v_pk_add_f32 v[30:31], v[74:75], v[140:141]
v_pk_add_f32 v[32:33], v[76:77], v[142:143]
v_pk_add_f32 v[34:35], v[78:79], v[144:145]
v_cvt_pk_bf16_f32 v36, v16, v17
v_cvt_pk_bf16_f32 v37, v18, v19
ds_write_b64 v5, v[36:37] offset:0
v_cvt_pk_bf16_f32 v38, v20, v21
v_cvt_pk_bf16_f32 v39, v22, v23
ds_write_b64 v5, v[38:39] offset:32
v_cvt_pk_bf16_f32 v40, v24, v25
v_cvt_pk_bf16_f32 v41, v26, v27
ds_write_b64 v5, v[40:41] offset:64
v_cvt_pk_bf16_f32 v42, v28, v29
v_cvt_pk_bf16_f32 v43, v30, v31
ds_write_b64 v5, v[42:43] offset:96
v_cvt_pk_bf16_f32 v44, v32, v33
v_cvt_pk_bf16_f32 v45, v34, v35
ds_write_b64 v5, v[44:45] offset:128
ds_read_b128 v[48:51], v228
ds_read_b128 v[52:55], v229
ds_read_b128 v[56:59], v230
s_waitcnt lgkmcnt(2)
buffer_store_dwordx4 v[48:51], v224, s[40:43], s13 offen
s_waitcnt lgkmcnt(1)
buffer_store_dwordx4 v[52:55], v225, s[40:43], s13 offen
s_waitcnt lgkmcnt(0)
s_mov_b32 exec_hi, 0
buffer_store_dwordx4 v[56:59], v226, s[40:43], s13 offen
Lend:
s_endpgm
Lredo:
s_mov_b32 s26, 1
s_waitcnt vmcnt(0) lgkmcnt(0)
s_barrier
v_and_b32 v8, 15, v0
v_lshrrev_b32 v9, 4, v0
v_lshlrev_b32 v9, 2, v9
v_sub_u32 v8, v8, v9
s_lshl_b32 s52, s30, 4
v_add_u32 v8, s52, v8
s_lshl_b32 s52, s3, 7
s_sub_u32 s53, 1920, s52
s_add_u32 s54, s52, 0
v_add_u32 v240, s54, v8
v_mov_b32 v244, v4
s_add_u32 s54, s52, 64
v_add_u32 v241, s54, v8
v_mov_b32 v245, v4
s_add_u32 s54, s53, 0
v_add_u32 v242, s54, v8
v_mov_b32 v246, v4
s_add_u32 s54, s53, 64
v_add_u32 v243, s54, v8
v_mov_b32 v247, v4
s_mov_b32 s63, 0
Lmx:
s_lshr_b32 s52, s63, 6
s_lshl_b32 s52, s52, 15
s_and_b32 s53, s63, 63
s_lshl_b32 s53, s53, 8
s_add_u32 s52, s52, s53
buffer_load_dwordx4 a[64:67], v1, s[32:35], s52 offen offset:0 sc1
buffer_load_dwordx4 a[68:71], v1, s[32:35], s52 offen offset:1024 sc1
buffer_load_dwordx4 a[72:75], v1, s[32:35], s52 offen offset:2048 sc1
buffer_load_dwordx4 a[76:79], v1, s[32:35], s52 offen offset:3072 sc1
s_waitcnt vmcnt(0)
v_mfma_f32_16x16x32_bf16 v[48:51], a[64:67], a[0:3], 0
v_mfma_f32_16x16x32_bf16 v[48:51], a[68:71], a[4:7], v[48:51]
v_mfma_f32_16x16x32_bf16 v[48:51], a[72:75], a[8:11], v[48:51]
v_mfma_f32_16x16x32_bf16 v[48:51], a[76:79], a[12:15], v[48:51]
v_mfma_f32_16x16x32_bf16 v[56:59], a[64:67], a[16:19], 0
v_mfma_f32_16x16x32_bf16 v[56:59], a[68:71], a[20:23], v[56:59]
v_mfma_f32_16x16x32_bf16 v[56:59], a[72:75], a[24:27], v[56:59]
v_mfma_f32_16x16x32_bf16 v[56:59], a[76:79], a[28:31], v[56:59]
v_mfma_f32_16x16x32_bf16 v[64:67], a[64:67], a[32:35], 0
v_mfma_f32_16x16x32_bf16 v[64:67], a[68:71], a[36:39], v[64:67]
v_mfma_f32_16x16x32_bf16 v[64:67], a[72:75], a[40:43], v[64:67]
v_mfma_f32_16x16x32_bf16 v[64:67], a[76:79], a[44:47], v[64:67]
v_mfma_f32_16x16x32_bf16 v[72:75], a[64:67], a[48:51], 0
v_mfma_f32_16x16x32_bf16 v[72:75], a[68:71], a[52:55], v[72:75]
v_mfma_f32_16x16x32_bf16 v[72:75], a[72:75], a[56:59], v[72:75]
v_mfma_f32_16x16x32_bf16 v[72:75], a[76:79], a[60:63], v[72:75]
s_nop 7
s_add_u32 s52, s63, 0
v_cmp_le_i32 vcc, s52, v240
s_nop 1
v_cndmask_b32 v9, v4, v48, vcc
v_max_f32 v244, v244, v9
v_cmp_le_i32 vcc, s52, v241
s_nop 1
v_cndmask_b32 v9, v4, v56, vcc
v_max_f32 v245, v245, v9
v_cmp_le_i32 vcc, s52, v242
s_nop 1
v_cndmask_b32 v9, v4, v64, vcc
v_max_f32 v246, v246, v9
v_cmp_le_i32 vcc, s52, v243
s_nop 1
v_cndmask_b32 v9, v4, v72, vcc
v_max_f32 v247, v247, v9
s_add_u32 s52, s63, 1
v_cmp_le_i32 vcc, s52, v240
s_nop 1
v_cndmask_b32 v9, v4, v49, vcc
v_max_f32 v244, v244, v9
v_cmp_le_i32 vcc, s52, v241
s_nop 1
v_cndmask_b32 v9, v4, v57, vcc
v_max_f32 v245, v245, v9
v_cmp_le_i32 vcc, s52, v242
s_nop 1
v_cndmask_b32 v9, v4, v65, vcc
v_max_f32 v246, v246, v9
v_cmp_le_i32 vcc, s52, v243
s_nop 1
v_cndmask_b32 v9, v4, v73, vcc
v_max_f32 v247, v247, v9
s_add_u32 s52, s63, 2
v_cmp_le_i32 vcc, s52, v240
s_nop 1
v_cndmask_b32 v9, v4, v50, vcc
v_max_f32 v244, v244, v9
v_cmp_le_i32 vcc, s52, v241
s_nop 1
v_cndmask_b32 v9, v4, v58, vcc
v_max_f32 v245, v245, v9
v_cmp_le_i32 vcc, s52, v242
s_nop 1
v_cndmask_b32 v9, v4, v66, vcc
v_max_f32 v246, v246, v9
v_cmp_le_i32 vcc, s52, v243
s_nop 1
v_cndmask_b32 v9, v4, v74, vcc
v_max_f32 v247, v247, v9
s_add_u32 s52, s63, 3
v_cmp_le_i32 vcc, s52, v240
s_nop 1
v_cndmask_b32 v9, v4, v51, vcc
v_max_f32 v244, v244, v9
v_cmp_le_i32 vcc, s52, v241
s_nop 1
v_cndmask_b32 v9, v4, v59, vcc
v_max_f32 v245, v245, v9
v_cmp_le_i32 vcc, s52, v242
s_nop 1
v_cndmask_b32 v9, v4, v67, vcc
v_max_f32 v246, v246, v9
v_cmp_le_i32 vcc, s52, v243
s_nop 1
v_cndmask_b32 v9, v4, v75, vcc
v_max_f32 v247, v247, v9
s_add_u32 s63, s63, 16
s_lshr_b32 s52, s34, 9
s_cmp_lt_u32 s63, s52
s_cbranch_scc1 Lmx
v_mov_b32 v9, v244
s_nop 1
v_permlane16_swap_b32 v244, v9
v_max_f32 v244, v244, v9
v_mov_b32 v9, v244
s_nop 1
v_permlane32_swap_b32 v244, v9
v_max_f32 v244, v244, v9
v_sub_f32 v16, 0, v244
v_sub_f32 v17, 0, v244
v_sub_f32 v18, 0, v244
v_sub_f32 v19, 0, v244
v_mov_b32 v9, v245
s_nop 1
v_permlane16_swap_b32 v245, v9
v_max_f32 v245, v245, v9
v_mov_b32 v9, v245
s_nop 1
v_permlane32_swap_b32 v245, v9
v_max_f32 v245, v245, v9
v_sub_f32 v20, 0, v245
v_sub_f32 v21, 0, v245
v_sub_f32 v22, 0, v245
v_sub_f32 v23, 0, v245
v_mov_b32 v9, v246
s_nop 1
v_permlane16_swap_b32 v246, v9
v_max_f32 v246, v246, v9
v_mov_b32 v9, v246
s_nop 1
v_permlane32_swap_b32 v246, v9
v_max_f32 v246, v246, v9
v_sub_f32 v24, 0, v246
v_sub_f32 v25, 0, v246
v_sub_f32 v26, 0, v246
v_sub_f32 v27, 0, v246
v_mov_b32 v9, v247
s_nop 1
v_permlane16_swap_b32 v247, v9
v_max_f32 v247, v247, v9
v_mov_b32 v9, v247
s_nop 1
v_permlane32_swap_b32 v247, v9
v_max_f32 v247, v247, v9
v_sub_f32 v28, 0, v247
v_sub_f32 v29, 0, v247
v_sub_f32 v30, 0, v247
v_sub_f32 v31, 0, v247
s_lshl_b32 s60, s30, 12
s_add_u32 m0, s60, 135168
s_nop 0
buffer_load_dwordx4 v1, s[32:35], s60 offen offset:0 sc1 lds
buffer_load_dwordx4 v1, s[32:35], s60 offen offset:1024 sc1 lds
buffer_load_dwordx4 v1, s[32:35], s60 offen offset:2048 sc1 lds
buffer_load_dwordx4 v1, s[32:35], s60 offen offset:3072 sc1 lds
s_lshl_b32 s61, s30, 13
s_add_u32 s60, s61, 16384
s_add_u32 m0, s61, 0
s_nop 0
buffer_load_dwordx4 v1, s[32:35], s60 offen offset:0 sc1 lds
buffer_load_dwordx4 v1, s[32:35], s60 offen offset:1024 sc1 lds
buffer_load_dwordx4 v1, s[32:35], s60 offen offset:2048 sc1 lds
buffer_load_dwordx4 v1, s[32:35], s60 offen offset:3072 sc1 lds
s_add_u32 s60, s60, 4096
s_add_u32 m0, s61, 4096
s_nop 0
buffer_load_dwordx4 v1, s[32:35], s60 offen offset:0 sc1 lds
buffer_load_dwordx4 v1, s[32:35], s60 offen offset:1024 sc1 lds
buffer_load_dwordx4 v1, s[32:35], s60 offen offset:2048 sc1 lds
buffer_load_dwordx4 v1, s[32:35], s60 offen offset:3072 sc1 lds
s_add_u32 s61, s61, s0
s_and_b32 s61, s61, 0x1ffff
s_add_u32 s60, s60, 28672
s_add_u32 m0, s61, 0
s_nop 0
buffer_load_dwordx4 v1, s[32:35], s60 offen offset:0 sc1 lds
buffer_load_dwordx4 v1, s[32:35], s60 offen offset:1024 sc1 lds
buffer_load_dwordx4 v1, s[32:35], s60 offen offset:2048 sc1 lds
buffer_load_dwordx4 v1, s[32:35], s60 offen offset:3072 sc1 lds
s_add_u32 s60, s60, 4096
s_add_u32 m0, s61, 4096
s_nop 0
buffer_load_dwordx4 v1, s[32:35], s60 offen offset:0 sc1 lds
buffer_load_dwordx4 v1, s[32:35], s60 offen offset:1024 sc1 lds
buffer_load_dwordx4 v1, s[32:35], s60 offen offset:2048 sc1 lds
buffer_load_dwordx4 v1, s[32:35], s60 offen offset:3072 sc1 lds
v_accvgpr_write_b32 a128, 0
v_accvgpr_write_b32 a129, 0
v_accvgpr_write_b32 a130, 0
v_accvgpr_write_b32 a131, 0
v_accvgpr_write_b32 a132, 0
v_accvgpr_write_b32 a133, 0
v_accvgpr_write_b32 a134, 0
v_accvgpr_write_b32 a135, 0
v_accvgpr_write_b32 a136, 0
v_accvgpr_write_b32 a137, 0
v_accvgpr_write_b32 a138, 0
v_accvgpr_write_b32 a139, 0
v_accvgpr_write_b32 a140, 0
v_accvgpr_write_b32 a141, 0
v_accvgpr_write_b32 a142, 0
v_accvgpr_write_b32 a143, 0
v_add_u32 v2, 118784, v1
s_waitcnt vmcnt(8)
s_barrier
ds_read_b128 a[64:67], v2 offset:16384
ds_read_b128 a[68:71], v2 offset:17408
ds_read_b128 a[72:75], v2 offset:18432
ds_read_b128 a[76:79], v2 offset:19456
ds_read_b128 a[80:83], v2 offset:20480
ds_read_b128 a[84:87], v2 offset:21504
ds_read_b128 a[88:91], v2 offset:22528
ds_read_b128 a[92:95], v2 offset:23552
v_mfma_f32_32x32x16_bf16 v[128:143], a[128:131], a[128:131], 0
v_mfma_f32_32x32x16_bf16 v[144:159], a[128:131], a[128:131], 0
v_mfma_f32_32x32x16_bf16 v[160:175], a[128:131], a[128:131], 0
v_mfma_f32_32x32x16_bf16 v[192:207], a[128:131], a[128:131], 0
v_mfma_f32_32x32x16_bf16 v[224:239], a[128:131], a[128:131], 0
s_branch Lp3
Lt44_m:
s_cmp_eq_u32 s63, 0
s_cbranch_scc1 Lt44_z
s_mov_b32 s16, 0
buffer_load_dword a225, v3, s[96:99], 0 offen
s_mov_b32 s98, 0
s_cmp_lg_u32 s30, 0
s_cbranch_scc1 Lpf_np
v_mov_b32 v8, 1
s_mov_b64 exec, 1
buffer_store_dword v8, off, s[48:51], s17 offset:1024 sc1
s_mov_b64 exec, -1
Lpf_np:
s_branch Lt44_r
Lt44_z:
v_cndmask_b32 v32, v4, v16, s[64:65]
v_cndmask_b32 v33, v4, v16, s[66:67]
v_cndmask_b32 v34, v4, v16, s[68:69]
v_cndmask_b32 v35, v4, v16, s[70:71]
v_cndmask_b32 v36, v4, v16, s[72:73]
v_cndmask_b32 v37, v4, v16, s[74:75]
v_cndmask_b32 v38, v4, v16, s[76:77]
v_cndmask_b32 v39, v4, v16, s[78:79]
s_nop 0
s_branch Lt44_r
Lt22_m:
v_cndmask_b32 v32, v4, v24, s[64:65]
v_cndmask_b32 v33, v4, v24, s[66:67]
v_cndmask_b32 v34, v4, v24, s[68:69]
v_cndmask_b32 v35, v4, v24, s[70:71]
v_cndmask_b32 v36, v4, v24, s[72:73]
v_cndmask_b32 v37, v4, v24, s[74:75]
v_cndmask_b32 v38, v4, v24, s[76:77]
v_cndmask_b32 v39, v4, v24, s[78:79]
v_accvgpr_read_b32 v6, a226
v_accvgpr_read_b32 v7, a227
global_load_dword a228, v[6:7], off
buffer_load_dwordx4 v[88:91], v1, s[48:51], 0 offen offset:1024 sc1
s_branch Lt22_r
Lcl_ld:
buffer_load_dword v12, off, s[44:47], 0 sc1
s_waitcnt vmcnt(0)
v_cmp_gt_u32 vcc, 1, v12
s_sub_u32 s55, s55, 1
s_cbranch_scc1 Lcl_ok
s_cbranch_vccnz Lcl_ld
s_branch Lcl_ok
Lh1_ld:
buffer_load_dword v12, v9, s[48:51], 0 offen sc1
s_waitcnt vmcnt(0)
v_cmp_gt_u32 vcc, 1, v12
s_sub_u32 s55, s55, 1
s_cbranch_scc1 Lh1_ok
s_cbranch_vccnz Lh1_ld
s_branch Lh1_ok
Lkv_ld:
buffer_load_dword v14, v5, s[48:51], 0 offen sc1
s_waitcnt vmcnt(0)
v_cmp_gt_u32 vcc, 1, v14
s_sub_u32 s55, s55, 1
s_cbranch_scc1 Lkv_ok
s_cbranch_vccnz Lkv_ld
s_branch Lkv_ok
Lnogu:
buffer_load_dwordx4 v1, s[32:35], s60 offen offset:3072 sc1 lds
s_add_u32 s60, s60, 4096
s_add_u32 m0, s61, 4096
s_nop 0
buffer_load_dwordx4 v1, s[32:35], s60 offen offset:0 sc1 lds
buffer_load_dwordx4 v1, s[32:35], s60 offen offset:1024 sc1 lds
buffer_load_dwordx4 v1, s[32:35], s60 offen offset:2048 sc1 lds
buffer_load_dwordx4 v1, s[32:35], s60 offen offset:3072 sc1 lds
v_mfma_f32_32x32x16_bf16 v[128:143], a[128:131], a[128:131], 0
v_mfma_f32_32x32x16_bf16 v[144:159], a[128:131], a[128:131], 0
v_mfma_f32_32x32x16_bf16 v[160:175], a[128:131], a[128:131], 0
v_mfma_f32_32x32x16_bf16 v[192:207], a[128:131], a[128:131], 0
v_mfma_f32_32x32x16_bf16 v[224:239], a[128:131], a[128:131], 0
s_waitcnt vmcnt(8)
s_branch Lgud
Lt32m:
v_cndmask_b32 v32, v4, v24, s[64:65]
v_cndmask_b32 v33, v4, v24, s[66:67]
v_cndmask_b32 v34, v4, v24, s[68:69]
v_cndmask_b32 v35, v4, v24, s[70:71]
v_cndmask_b32 v36, v4, v24, s[72:73]
v_cndmask_b32 v37, v4, v24, s[74:75]
v_cndmask_b32 v38, v4, v24, s[76:77]
v_cndmask_b32 v39, v4, v24, s[78:79]
v_accvgpr_read_b32 v6, a226
v_accvgpr_read_b32 v7, a227
global_load_dword a228, v[6:7], off
s_branch Lt32
Lt32n:
buffer_load_dwordx4 v[88:91], v1, s[48:51], 0 offen offset:1024 sc1
s_branch Lt32r
Lt21m:
s_waitcnt vmcnt(8)
s_branch Lt21
Lfh_ld:
buffer_load_dwordx4 v[88:91], v1, s[48:51], 0 offen offset:1024 sc1
s_waitcnt vmcnt(0)
v_and_b32 v88, v88, v89
v_and_b32 v88, v88, v90
v_and_b32 v88, v88, v91
v_cmp_gt_u32 vcc, 1, v88
s_sub_u32 s55, s55, 1
s_cbranch_scc1 Lfh_ok
s_cbranch_vccnz Lfh_ld
s_branch Lfh_ok
Lfc_ld:
buffer_load_dword v12, v13, s[48:51], s12 offen sc1
s_waitcnt vmcnt(0)
v_cmp_gt_u32 vcc, 1, v12
s_sub_u32 s55, s55, 1
s_cbranch_scc1 Lfc_ok
s_cbranch_vccnz Lfc_ld
s_branch Lfc_ok
.section .rodata,"a"
.p2align 6
.amdhsa_kernel parallel_sum__compressed_kv_cla__geglu_ffn__prompt_kernel
  .amdhsa_next_free_vgpr 512
  .amdhsa_next_free_sgpr 102
  .amdhsa_accum_offset 256
  .amdhsa_group_segment_fixed_size 0
  .amdhsa_kernarg_size 104
  .amdhsa_user_sgpr_count 2
  .amdhsa_user_sgpr_kernarg_segment_ptr 1
  .amdhsa_system_sgpr_workgroup_id_x 1
.end_amdhsa_kernel
```
